```python
import torch

def _softmax(x, axis=-1):
    return torch.softmax(x, dim=axis)
def _gelu(x):
    return torch.nn.functional.gelu(x, approximate="tanh")
def _silu(x):
    return torch.nn.functional.silu(x)
def _sigmoid(x):
    return torch.sigmoid(x)
def _layernorm(x, axis=-1, eps=1e-5):
    m = x.mean(dim=axis, keepdim=True)
    v = x.var(dim=axis, keepdim=True, unbiased=False)
    return (x - m) / torch.sqrt(v + eps)
def _scatter_add(tgt, idx, src, axis=0):
    return tgt.clone().index_add_(axis, idx, src)
def _segment_sum(src, seg, n):
    out = torch.zeros((n,) + src.shape[1:], dtype=src.dtype)
    return out.index_add_(0, seg, src)
def _pad(x, pw):
    flat = tuple(v for pair in reversed(pw) for v in pair)
    return torch.nn.functional.pad(x, flat)

kernel_name = 'concat_heads__linear_kernel_hedgehog__spectral_fnet__prompt'

def setup_inputs():

    _w = (lambda a: (lambda t: t.to(torch.bfloat16) if t.is_floating_point() else t)(torch.as_tensor(a)))
    def _A_setup():
        B, S, D, H = 1, 2048, 640, 32
        Dh = D // H
        return {
            "x": _w((lambda *s: torch.randn(*s, dtype=torch.bfloat16) * 0.2)(B, S, D)),
            "wqkv": _w((lambda *s: torch.randn(*s, dtype=torch.bfloat16) * 1.6)(D, 3 * D)),
            "w_phi": _w((lambda *s: torch.randn(*s, dtype=torch.bfloat16) * 1.6)(H, Dh, Dh) * (Dh ** -0.5)),
            "wo": _w((lambda *s: torch.randn(*s, dtype=torch.bfloat16) * 0.8)(D, D)),
        }
    _A_in = _A_setup()

    def _B_setup():
        B, S, D = 1, 2048, 640
        ns = torch.arange(S)[:, None] * torch.arange(S)[None, :]
        nd = torch.arange(D)[:, None] * torch.arange(D)[None, :]
        Ws_re = torch.cos(-2.0 * torch.pi * ns / S).to(float)
        Ws_im = torch.sin(-2.0 * torch.pi * ns / S).to(float)
        Wd_re = torch.cos(-2.0 * torch.pi * nd / D).to(float)
        Wd_im = torch.sin(-2.0 * torch.pi * nd / D).to(float)
        return {
            "x": _w((lambda *s: torch.randn(*s, dtype=torch.bfloat16) * 0.05)(B, S, D)),
            "dft_seq_re": _w(Ws_re),
            "dft_seq_im": _w(Ws_im),
            "dft_hid_re": _w(Wd_re),
            "dft_hid_im": _w(Wd_im),
        }
    _B_in = _B_setup()

    return {
        "A_x": _A_in["x"],
        "A_wqkv": _A_in["wqkv"],
        "A_w_phi": _A_in["w_phi"],
        "A_wo": _A_in["wo"],
        "B_x": _B_in["x"],
        "B_dft_seq_re": _B_in["dft_seq_re"],
        "B_dft_seq_im": _B_in["dft_seq_im"],
        "B_dft_hid_re": _B_in["dft_hid_re"],
        "B_dft_hid_im": _B_in["dft_hid_im"],
    }

def reference(A_x, A_wqkv, A_w_phi, A_wo, B_x, B_dft_seq_re, B_dft_seq_im, B_dft_hid_re, B_dft_hid_im):
    def _A_ref(x, wqkv, w_phi, wo):
        B, S, D = x.shape
        H = 32; Dh = D // H
        qkv = (lambda x, *d: x.permute(*d))((x @ wqkv).reshape(B, S, 3, H, Dh), 2, 0, 3, 1, 4)
        q, k, v = qkv[0], qkv[1], qkv[2]
        pq = torch.einsum("bhsd,hdf->bhsf", q, w_phi)
        pk = torch.einsum("bhsd,hdf->bhsf", k, w_phi)
        phi_q = torch.concatenate([_softmax(pq, axis=-1), _softmax(-pq, axis=-1)], axis=-1)
        phi_k = torch.concatenate([_softmax(pk, axis=-1), _softmax(-pk, axis=-1)], axis=-1)
        kv = torch.einsum("bhsf,bhsd->bhfd", phi_k, v)
        z  = torch.einsum("bhsf->bhf", phi_k)
        num = torch.einsum("bhqf,bhfd->bhqd", phi_q, kv)
        den = torch.einsum("bhqf,bhf->bhq", phi_q, z)[..., None] + 1e-6
        o = num / den
        return (lambda x, *d: x.permute(*d))(o, 0, 2, 1, 3).reshape(B, S, D) @ wo

    def _B_ref(x, dft_seq_re, dft_seq_im, dft_hid_re, dft_hid_im):
        a = torch.einsum("bsd,ed->bse", x, dft_hid_re)
        b = torch.einsum("bsd,ed->bse", x, dft_hid_im)
        y = torch.einsum("ts,bse->bte", dft_seq_re, a) - torch.einsum("ts,bse->bte", dft_seq_im, b)
        return y

    a = _A_ref(A_x, A_wqkv, A_w_phi, A_wo)
    b = _B_ref(B_x, B_dft_seq_re, B_dft_seq_im, B_dft_hid_re, B_dft_hid_im)
    return torch.concatenate([a, b], axis=-1)
```

```asm
; @launch grid=(256,1,1) block=(512,1,1) lds=163840
.amdgcn_target "amdgcn-amd-amdhsa--gfx950"
.text
.globl concat_heads__linear_kernel_hedgehog__spectral_fnet__prompt_kernel
.p2align 8
.type concat_heads__linear_kernel_hedgehog__spectral_fnet__prompt_kernel,@function
concat_heads__linear_kernel_hedgehog__spectral_fnet__prompt_kernel:
L_start:
    s_load_dwordx8 s[80:87], s[0:1], 0
    s_cmp_ge_u32 s2, 256
    s_cbranch_scc1 L_end
    s_getpc_b64 s[4:5]
    s_lshr_b32 s44, s2, 3
    s_lshl_b32 s50, s44, 11
    v_lshrrev_b32 v2, 6, v0
    v_and_b32 v1, 63, v0
    v_lshl_add_u32 v253, v2, 1, v1
    v_lshl_add_u32 v253, v253, 7, s50
    v_min_u32 v253, L_end-L_start-64, v253
    v_readfirstlane_b32 s40, v2
    s_mov_b64 exec, 3
    global_load_dword v254, v253, s[4:5]
    s_mov_b64 exec, -1
    s_and_b32 s45, s2, 7
    s_lshr_b32 s50, s44, 2
    s_and_b32 s51, s44, 3
    s_mul_i32 s43, s51, 5
    s_lshr_b32 s43, s43, 1
    s_add_u32 s43, s43, s50
    s_cmp_ge_u32 s43, 10
    s_cselect_b32 s52, 10, 0
    s_sub_u32 s56, s43, s52
    s_and_b32 s42, s45, 1
    s_lshl_b32 s42, s42, 2
    s_add_u32 s42, s42, s51
    s_cmp_eq_u32 s40, 7
    s_cbranch_scc0 L_nz
    v_lshlrev_b32 v64, 4, v1
    v_add_u32 v29, 161792, v64
    v_add_u32 v28, 152768, v64
    v_mov_b32 v24, 0
    v_mov_b32 v25, 0
    v_mov_b32 v26, 0
    v_mov_b32 v27, 0
    ds_write_b128 v29, v[24:27]
    ds_write_b128 v28, v[24:27]
    ds_write_b128 v28, v[24:27] offset:1024
    s_branch L_ld0
L_nz:
    s_barrier
    s_branch L_notld
L_ld0:
    s_setprio 3
    v_mul_u32_u24 v28, 6554, v1
    s_movk_i32 s50, 3680
    v_lshrrev_b32 v29, 16, v28
    v_mad_u32_u24 v2, v29, s50, v64
    v_add_u32 v29, 419456, v28
    v_lshrrev_b32 v29, 16, v29
    v_mad_u32_u24 v3, v29, s50, v64
    v_add_u32 v29, 838912, v28
    v_lshrrev_b32 v29, 16, v29
    v_mad_u32_u24 v4, v29, s50, v64
    v_add_u32 v29, 1258368, v28
    v_lshrrev_b32 v29, 16, v29
    v_mad_u32_u24 v5, v29, s50, v64
    v_add_u32 v29, 1677824, v28
    v_lshrrev_b32 v29, 16, v29
    v_mad_u32_u24 v6, v29, s50, v64
    v_add_u32 v6, 4096, v6
    s_lshr_b32 s41, s45, 1
    s_lshl_b32 s41, s41, 3
    s_lshr_b32 s50, s44, 2
    s_add_u32 s41, s41, s50
    s_mul_i32 s50, s41, 81920
    v_lshrrev_b32 v28, 3, v1
    v_mul_u32_u24 v28, 1280, v28
    v_and_b32 v29, 7, v1
    v_lshrrev_b32 v30, 4, v1
    v_xor_b32 v29, v29, v30
    v_lshlrev_b32 v29, 4, v29
    v_add3_u32 v19, v28, v29, s50
    v_xor_b32 v20, 64, v19
    v_add_u32 v20, 9216, v20
    s_mov_b32 s73, 0
    s_mul_i32 s74, s42, 160
    s_add_u32 s74, s74, 1280
    s_mov_b32 s76, 0
    s_mov_b32 s77, s56
    s_mov_b32 s55, 0
    v_mov_b32 v18, 0
    s_mov_b32 s35, s77
    s_mul_i32 s50, s77, 245760
    s_add_u32 s50, s50, s74
    s_mov_b32 s51, s55
    s_add_u32 s77, s77, 1
    s_cmp_eq_u32 s77, 10
    s_cselect_b32 s77, 0, s77
    s_add_u32 s55, s55, 10240
    s_cmp_eq_u32 s55, 71680
    s_cselect_b32 s55, 0, s55
    s_add_u32 s76, s76, 1
    s_mov_b32 s10, 2621440
    s_mov_b32 s11, 0x20000
    s_mov_b32 s14, 2457600
    s_mov_b32 s15, 0x20000
    s_waitcnt lgkmcnt(0)
    s_mov_b32 s8, s80
    s_and_b32 s9, s81, 0xffff
    s_mov_b32 s12, s82
    s_and_b32 s13, s83, 0xffff
    s_lshl_b32 s52, s35, 7
    s_add_u32 m0, s73, 108544
    s_add_u32 s53, s52, 0
    buffer_load_dwordx4 v19, s[8:11], s53 offen lds
    buffer_load_dwordx4 v20, s[8:11], s53 offen offset:1024 lds
    s_add_u32 m0, s73, 118784
    s_add_u32 s53, s52, 20480
    buffer_load_dwordx4 v19, s[8:11], s53 offen lds
    buffer_load_dwordx4 v20, s[8:11], s53 offen offset:1024 lds
    s_add_u32 m0, s73, 129024
    s_add_u32 s53, s52, 40960
    buffer_load_dwordx4 v19, s[8:11], s53 offen lds
    buffer_load_dwordx4 v20, s[8:11], s53 offen offset:1024 lds
    s_add_u32 m0, s73, 139264
    s_add_u32 s53, s52, 61440
    buffer_load_dwordx4 v19, s[8:11], s53 offen lds
    buffer_load_dwordx4 v20, s[8:11], s53 offen offset:1024 lds
    s_add_u32 s73, s73, 2048
    s_cmp_eq_u32 s73, 10240
    s_cselect_b32 s73, 0, s73
    s_mov_b32 m0, s51
    s_add_u32 s53, s50, 122880
    buffer_load_dwordx4 v2, s[12:15], s50 offen offset:0 lds
    buffer_load_dwordx4 v3, s[12:15], s50 offen offset:1024 lds
    buffer_load_dwordx4 v4, s[12:15], s50 offen offset:2048 lds
    buffer_load_dwordx4 v5, s[12:15], s50 offen offset:3072 lds
    s_add_u32 m0, s51, 4096
    s_nop 0
    buffer_load_dwordx4 v6, s[12:15], s50 offen lds
    s_add_u32 m0, s51, 5120
    s_nop 0
    buffer_load_dwordx4 v2, s[12:15], s53 offen offset:0 lds
    buffer_load_dwordx4 v3, s[12:15], s53 offen offset:1024 lds
    buffer_load_dwordx4 v4, s[12:15], s53 offen offset:2048 lds
    buffer_load_dwordx4 v5, s[12:15], s53 offen offset:3072 lds
    s_add_u32 m0, s51, 9216
    s_nop 0
    buffer_load_dwordx4 v6, s[12:15], s53 offen lds
    s_barrier
    s_load_dwordx2 s[88:89], s[0:1], 32
    s_load_dwordx2 s[92:93], s[0:1], 72
    s_load_dwordx2 s[90:91], s[0:1], 88
    s_mov_b32 s46, 0x200000
    s_mov_b32 s47, 0
    s_mov_b32 s48, 0
    s_mov_b32 s49, 0
    s_mov_b32 s66, -1
    s_mov_b32 s67, 0
    s_mov_b32 s43, s44
    s_and_b32 s72, s43, 1
    v_mov_b32 v17, 161792
    s_mov_b32 s35, s77
    s_mul_i32 s50, s77, 245760
    s_add_u32 s50, s50, s74
    s_mov_b32 s51, s55
    s_add_u32 s77, s77, 1
    s_cmp_eq_u32 s77, 10
    s_cselect_b32 s77, 0, s77
    s_add_u32 s55, s55, 10240
    s_cmp_eq_u32 s55, 71680
    s_cselect_b32 s55, 0, s55
    s_add_u32 s76, s76, 1
    s_lshl_b32 s52, s35, 7
    s_add_u32 m0, s73, 108544
    s_add_u32 s53, s52, 0
    buffer_load_dwordx4 v19, s[8:11], s53 offen lds
    buffer_load_dwordx4 v20, s[8:11], s53 offen offset:1024 lds
    s_add_u32 m0, s73, 118784
    s_add_u32 s53, s52, 20480
    buffer_load_dwordx4 v19, s[8:11], s53 offen lds
    buffer_load_dwordx4 v20, s[8:11], s53 offen offset:1024 lds
    s_add_u32 m0, s73, 129024
    s_add_u32 s53, s52, 40960
    buffer_load_dwordx4 v19, s[8:11], s53 offen lds
    buffer_load_dwordx4 v20, s[8:11], s53 offen offset:1024 lds
    s_add_u32 m0, s73, 139264
    s_add_u32 s53, s52, 61440
    buffer_load_dwordx4 v19, s[8:11], s53 offen lds
    buffer_load_dwordx4 v20, s[8:11], s53 offen offset:1024 lds
    s_add_u32 s73, s73, 2048
    s_cmp_eq_u32 s73, 10240
    s_cselect_b32 s73, 0, s73
    s_mov_b32 m0, s51
    s_add_u32 s53, s50, 122880
    buffer_load_dwordx4 v2, s[12:15], s50 offen offset:0 lds
    buffer_load_dwordx4 v3, s[12:15], s50 offen offset:1024 lds
    buffer_load_dwordx4 v4, s[12:15], s50 offen offset:2048 lds
    buffer_load_dwordx4 v5, s[12:15], s50 offen offset:3072 lds
    s_add_u32 m0, s51, 4096
    s_nop 0
    buffer_load_dwordx4 v6, s[12:15], s50 offen lds
    s_add_u32 m0, s51, 5120
    s_nop 0
    buffer_load_dwordx4 v2, s[12:15], s53 offen offset:0 lds
    buffer_load_dwordx4 v3, s[12:15], s53 offen offset:1024 lds
    buffer_load_dwordx4 v4, s[12:15], s53 offen offset:2048 lds
    buffer_load_dwordx4 v5, s[12:15], s53 offen offset:3072 lds
    s_add_u32 m0, s51, 9216
    s_nop 0
    buffer_load_dwordx4 v6, s[12:15], s53 offen lds
    s_waitcnt lgkmcnt(0)
    s_mov_b32 s16, s84
    s_and_b32 s17, s85, 0xffff
    s_mov_b32 s18, 25600
    s_mov_b32 s19, 0x20000
    s_mov_b32 s20, s86
    s_and_b32 s21, s87, 0xffff
    s_mov_b32 s22, 819200
    s_mov_b32 s23, 0x20000
    s_mov_b32 s24, s88
    s_and_b32 s25, s89, 0xffff
    s_mov_b32 s26, 2621440
    s_mov_b32 s27, 0x20000
    s_mov_b32 s28, s92
    s_and_b32 s29, s93, 0xffff
    s_mov_b32 s30, 5242880
    s_mov_b32 s31, 0x20000
    s_mov_b32 s36, s90
    s_and_b32 s37, s91, 0xffff
    s_mov_b32 s38, 9437184
    s_mov_b32 s39, 0x20000
    s_mul_i32 s52, s42, 3200
    v_mov_b32 v65, 9371648
    buffer_load_dword v65, v65, s[36:39], 0 offen sc1
    s_mov_b32 m0, 149504
    s_nop 0
    buffer_load_dwordx4 v64, s[16:19], s52 offen offset:0 lds
    buffer_load_dwordx4 v64, s[16:19], s52 offen offset:1024 lds
    buffer_load_dwordx4 v64, s[16:19], s52 offen offset:2048 lds
    s_mov_b64 exec, 0xff
    buffer_load_dwordx4 v64, s[16:19], s52 offen offset:3072 lds
    s_mov_b64 exec, -1
    s_waitcnt vmcnt(23)
    v_add_u32 v18, 1, v18
    ds_write_b32 v17, v18
    s_mov_b32 s35, s77
    s_mul_i32 s50, s77, 245760
    s_add_u32 s50, s50, s74
    s_mov_b32 s51, s55
    s_add_u32 s77, s77, 1
    s_cmp_eq_u32 s77, 10
    s_cselect_b32 s77, 0, s77
    s_add_u32 s55, s55, 10240
    s_cmp_eq_u32 s55, 71680
    s_cselect_b32 s55, 0, s55
    s_add_u32 s76, s76, 1
    s_lshl_b32 s52, s35, 7
    s_add_u32 m0, s73, 108544
    s_add_u32 s53, s52, 0
    buffer_load_dwordx4 v19, s[8:11], s53 offen lds
    buffer_load_dwordx4 v20, s[8:11], s53 offen offset:1024 lds
    s_add_u32 m0, s73, 118784
    s_add_u32 s53, s52, 20480
    buffer_load_dwordx4 v19, s[8:11], s53 offen lds
    buffer_load_dwordx4 v20, s[8:11], s53 offen offset:1024 lds
    s_add_u32 m0, s73, 129024
    s_add_u32 s53, s52, 40960
    buffer_load_dwordx4 v19, s[8:11], s53 offen lds
    buffer_load_dwordx4 v20, s[8:11], s53 offen offset:1024 lds
    s_add_u32 m0, s73, 139264
    s_add_u32 s53, s52, 61440
    buffer_load_dwordx4 v19, s[8:11], s53 offen lds
    buffer_load_dwordx4 v20, s[8:11], s53 offen offset:1024 lds
    s_add_u32 s73, s73, 2048
    s_cmp_eq_u32 s73, 10240
    s_cselect_b32 s73, 0, s73
    s_mov_b32 m0, s51
    s_add_u32 s53, s50, 122880
    buffer_load_dwordx4 v2, s[12:15], s50 offen offset:0 lds
    buffer_load_dwordx4 v3, s[12:15], s50 offen offset:1024 lds
    buffer_load_dwordx4 v4, s[12:15], s50 offen offset:2048 lds
    buffer_load_dwordx4 v5, s[12:15], s50 offen offset:3072 lds
    s_add_u32 m0, s51, 4096
    s_nop 0
    buffer_load_dwordx4 v6, s[12:15], s50 offen lds
    s_add_u32 m0, s51, 5120
    s_nop 0
    buffer_load_dwordx4 v2, s[12:15], s53 offen offset:0 lds
    buffer_load_dwordx4 v3, s[12:15], s53 offen offset:1024 lds
    buffer_load_dwordx4 v4, s[12:15], s53 offen offset:2048 lds
    buffer_load_dwordx4 v5, s[12:15], s53 offen offset:3072 lds
    s_add_u32 m0, s51, 9216
    s_nop 0
    buffer_load_dwordx4 v6, s[12:15], s53 offen lds
    s_waitcnt vmcnt(23)
    v_add_u32 v18, 1, v18
    ds_write_b32 v17, v18
    s_mov_b32 s35, s77
    s_mul_i32 s50, s77, 245760
    s_add_u32 s50, s50, s74
    s_mov_b32 s51, s55
    s_add_u32 s77, s77, 1
    s_cmp_eq_u32 s77, 10
    s_cselect_b32 s77, 0, s77
    s_add_u32 s55, s55, 10240
    s_cmp_eq_u32 s55, 71680
    s_cselect_b32 s55, 0, s55
    s_add_u32 s76, s76, 1
    s_lshl_b32 s52, s35, 7
    s_add_u32 m0, s73, 108544
    s_add_u32 s53, s52, 0
    buffer_load_dwordx4 v19, s[8:11], s53 offen lds
    buffer_load_dwordx4 v20, s[8:11], s53 offen offset:1024 lds
    s_add_u32 m0, s73, 118784
    s_add_u32 s53, s52, 20480
    buffer_load_dwordx4 v19, s[8:11], s53 offen lds
    buffer_load_dwordx4 v20, s[8:11], s53 offen offset:1024 lds
    s_add_u32 m0, s73, 129024
    s_add_u32 s53, s52, 40960
    buffer_load_dwordx4 v19, s[8:11], s53 offen lds
    buffer_load_dwordx4 v20, s[8:11], s53 offen offset:1024 lds
    s_add_u32 m0, s73, 139264
    s_add_u32 s53, s52, 61440
    buffer_load_dwordx4 v19, s[8:11], s53 offen lds
    buffer_load_dwordx4 v20, s[8:11], s53 offen offset:1024 lds
    s_add_u32 s73, s73, 2048
    s_cmp_eq_u32 s73, 10240
    s_cselect_b32 s73, 0, s73
    s_mov_b32 m0, s51
    s_add_u32 s53, s50, 122880
    buffer_load_dwordx4 v2, s[12:15], s50 offen offset:0 lds
    buffer_load_dwordx4 v3, s[12:15], s50 offen offset:1024 lds
    buffer_load_dwordx4 v4, s[12:15], s50 offen offset:2048 lds
    buffer_load_dwordx4 v5, s[12:15], s50 offen offset:3072 lds
    s_add_u32 m0, s51, 4096
    s_nop 0
    buffer_load_dwordx4 v6, s[12:15], s50 offen lds
    s_add_u32 m0, s51, 5120
    s_nop 0
    buffer_load_dwordx4 v2, s[12:15], s53 offen offset:0 lds
    buffer_load_dwordx4 v3, s[12:15], s53 offen offset:1024 lds
    buffer_load_dwordx4 v4, s[12:15], s53 offen offset:2048 lds
    buffer_load_dwordx4 v5, s[12:15], s53 offen offset:3072 lds
    s_add_u32 m0, s51, 9216
    s_nop 0
    buffer_load_dwordx4 v6, s[12:15], s53 offen lds
    s_waitcnt vmcnt(18)
    v_add_u32 v18, 1, v18
    ds_write_b32 v17, v18
    v_add_u32 v28, 1, v65
    v_mov_b32 v29, 1
    ds_write_b64 v17, v[28:29] offset:8
GT_1:
    ds_read_b64 v[28:29], v17 offset:8
    s_waitcnt lgkmcnt(0)
    v_readfirstlane_b32 s34, v28
    v_readfirstlane_b32 s32, v29
    s_sub_u32 s46, s46, 1
    s_cselect_b32 s46, 0, s46
    s_cbranch_scc1 GD_2
    s_cmp_eq_u32 s32, 0
    s_cbranch_scc1 GT_1
GD_2:
    s_and_b32 s32, s34, 1
    s_mul_i32 s32, s32, 0x10001
    s_mov_b32 s33, 0xfffefffe
LD_3:
    s_add_u32 s54, s76, -4
    s_cmp_ge_i32 s48, s54
    s_cbranch_scc0 LS_4
LB_5:
    ds_read_b128 v[24:27], v17 offset:16
    s_mov_b32 s35, s77
    s_mul_i32 s50, s77, 245760
    s_add_u32 s50, s50, s74
    s_mov_b32 s51, s55
    s_add_u32 s77, s77, 1
    s_cmp_eq_u32 s77, 10
    s_cselect_b32 s77, 0, s77
    s_add_u32 s55, s55, 10240
    s_cmp_eq_u32 s55, 71680
    s_cselect_b32 s55, 0, s55
    s_add_u32 s76, s76, 1
    s_lshl_b32 s52, s35, 7
    s_add_u32 m0, s73, 108544
    s_add_u32 s53, s52, 0
    buffer_load_dwordx4 v19, s[8:11], s53 offen lds
    buffer_load_dwordx4 v20, s[8:11], s53 offen offset:1024 lds
    s_add_u32 m0, s73, 118784
    s_add_u32 s53, s52, 20480
    buffer_load_dwordx4 v19, s[8:11], s53 offen lds
    buffer_load_dwordx4 v20, s[8:11], s53 offen offset:1024 lds
    s_add_u32 m0, s73, 129024
    s_add_u32 s53, s52, 40960
    buffer_load_dwordx4 v19, s[8:11], s53 offen lds
    buffer_load_dwordx4 v20, s[8:11], s53 offen offset:1024 lds
    s_add_u32 m0, s73, 139264
    s_add_u32 s53, s52, 61440
    buffer_load_dwordx4 v19, s[8:11], s53 offen lds
    buffer_load_dwordx4 v20, s[8:11], s53 offen offset:1024 lds
    s_add_u32 s73, s73, 2048
    s_cmp_eq_u32 s73, 10240
    s_cselect_b32 s73, 0, s73
    s_mov_b32 m0, s51
    s_add_u32 s53, s50, 122880
    buffer_load_dwordx4 v2, s[12:15], s50 offen offset:0 lds
    buffer_load_dwordx4 v3, s[12:15], s50 offen offset:1024 lds
    buffer_load_dwordx4 v4, s[12:15], s50 offen offset:2048 lds
    buffer_load_dwordx4 v5, s[12:15], s50 offen offset:3072 lds
    s_add_u32 m0, s51, 4096
    s_nop 0
    buffer_load_dwordx4 v6, s[12:15], s50 offen lds
    s_add_u32 m0, s51, 5120
    s_nop 0
    buffer_load_dwordx4 v2, s[12:15], s53 offen offset:0 lds
    buffer_load_dwordx4 v3, s[12:15], s53 offen offset:1024 lds
    buffer_load_dwordx4 v4, s[12:15], s53 offen offset:2048 lds
    buffer_load_dwordx4 v5, s[12:15], s53 offen offset:3072 lds
    s_add_u32 m0, s51, 9216
    s_nop 0
    buffer_load_dwordx4 v6, s[12:15], s53 offen lds
    v_add_u32 v18, 1, v18
    s_waitcnt vmcnt(18) lgkmcnt(0)
    ds_write_b32 v17, v18
    v_min3_u32 v24, v24, v25, v26
    v_min_u32 v24, v24, v27
    s_cmp_lt_u32 s76, 10
    v_readfirstlane_b32 s48, v24
    s_cbranch_scc1 LD_3
    s_add_u32 s74, s74, 1280
    s_add_u32 s54, s76, -6
    s_cmp_ge_u32 s48, s54
    s_cbranch_scc1 WD_7
WF_6:
    ds_read_b128 v[28:31], v17 offset:16
    s_waitcnt lgkmcnt(0)
    v_min3_u32 v28, v28, v29, v30
    v_min_u32 v28, v28, v31
    s_sub_u32 s46, s46, 1
    s_cselect_b32 s46, 0, s46
    s_cbranch_scc1 WD_7
    v_readfirstlane_b32 s48, v28
    s_cmp_ge_u32 s48, s54
    s_cbranch_scc0 WF_6
WD_7:
    s_mul_i32 s50, s77, 245760
    s_add_u32 s50, s50, s74
    s_mov_b32 s51, s55
    s_add_u32 s77, s77, 1
    s_cmp_eq_u32 s77, 10
    s_cselect_b32 s77, 0, s77
    s_add_u32 s55, s55, 10240
    s_cmp_eq_u32 s55, 71680
    s_cselect_b32 s55, 0, s55
    s_add_u32 s76, s76, 1
    s_mov_b32 m0, s51
    s_add_u32 s53, s50, 122880
    buffer_load_dwordx4 v2, s[12:15], s50 offen offset:0 lds
    buffer_load_dwordx4 v3, s[12:15], s50 offen offset:1024 lds
    buffer_load_dwordx4 v4, s[12:15], s50 offen offset:2048 lds
    buffer_load_dwordx4 v5, s[12:15], s50 offen offset:3072 lds
    s_add_u32 m0, s51, 4096
    s_nop 0
    buffer_load_dwordx4 v6, s[12:15], s50 offen lds
    s_add_u32 m0, s51, 5120
    s_nop 0
    buffer_load_dwordx4 v2, s[12:15], s53 offen offset:0 lds
    buffer_load_dwordx4 v3, s[12:15], s53 offen offset:1024 lds
    buffer_load_dwordx4 v4, s[12:15], s53 offen offset:2048 lds
    buffer_load_dwordx4 v5, s[12:15], s53 offen offset:3072 lds
    s_add_u32 m0, s51, 9216
    s_nop 0
    buffer_load_dwordx4 v6, s[12:15], s53 offen lds
    s_waitcnt vmcnt(10)
    v_add_u32 v18, 1, v18
    ds_write_b32 v17, v18
    s_add_u32 s54, s76, -6
    s_cmp_ge_u32 s48, s54
    s_cbranch_scc1 WD_9
WF_8:
    ds_read_b128 v[28:31], v17 offset:16
    s_waitcnt lgkmcnt(0)
    v_min3_u32 v28, v28, v29, v30
    v_min_u32 v28, v28, v31
    s_sub_u32 s46, s46, 1
    s_cselect_b32 s46, 0, s46
    s_cbranch_scc1 WD_9
    v_readfirstlane_b32 s48, v28
    s_cmp_ge_u32 s48, s54
    s_cbranch_scc0 WF_8
WD_9:
    s_mul_i32 s50, s77, 245760
    s_add_u32 s50, s50, s74
    s_mov_b32 s51, s55
    s_add_u32 s77, s77, 1
    s_cmp_eq_u32 s77, 10
    s_cselect_b32 s77, 0, s77
    s_add_u32 s55, s55, 10240
    s_cmp_eq_u32 s55, 71680
    s_cselect_b32 s55, 0, s55
    s_add_u32 s76, s76, 1
    s_mov_b32 m0, s51
    s_add_u32 s53, s50, 122880
    buffer_load_dwordx4 v2, s[12:15], s50 offen offset:0 lds
    buffer_load_dwordx4 v3, s[12:15], s50 offen offset:1024 lds
    buffer_load_dwordx4 v4, s[12:15], s50 offen offset:2048 lds
    buffer_load_dwordx4 v5, s[12:15], s50 offen offset:3072 lds
    s_add_u32 m0, s51, 4096
    s_nop 0
    buffer_load_dwordx4 v6, s[12:15], s50 offen lds
    s_add_u32 m0, s51, 5120
    s_nop 0
    buffer_load_dwordx4 v2, s[12:15], s53 offen offset:0 lds
    buffer_load_dwordx4 v3, s[12:15], s53 offen offset:1024 lds
    buffer_load_dwordx4 v4, s[12:15], s53 offen offset:2048 lds
    buffer_load_dwordx4 v5, s[12:15], s53 offen offset:3072 lds
    s_add_u32 m0, s51, 9216
    s_nop 0
    buffer_load_dwordx4 v6, s[12:15], s53 offen lds
LD_10:
    s_add_u32 s54, s76, -6
    s_cmp_ge_i32 s48, s54
    s_cbranch_scc0 LS_11
LB_12:
    ds_read_b128 v[24:27], v17 offset:16
    s_mul_i32 s50, s77, 245760
    s_add_u32 s50, s50, s74
    s_mov_b32 s51, s55
    s_add_u32 s77, s77, 1
    s_cmp_eq_u32 s77, 10
    s_cselect_b32 s77, 0, s77
    s_add_u32 s55, s55, 10240
    s_cmp_eq_u32 s55, 71680
    s_cselect_b32 s55, 0, s55
    s_add_u32 s76, s76, 1
    s_mov_b32 m0, s51
    s_add_u32 s53, s50, 122880
    buffer_load_dwordx4 v2, s[12:15], s50 offen offset:0 lds
    buffer_load_dwordx4 v3, s[12:15], s50 offen offset:1024 lds
    buffer_load_dwordx4 v4, s[12:15], s50 offen offset:2048 lds
    buffer_load_dwordx4 v5, s[12:15], s50 offen offset:3072 lds
    s_add_u32 m0, s51, 4096
    s_nop 0
    buffer_load_dwordx4 v6, s[12:15], s50 offen lds
    s_add_u32 m0, s51, 5120
    s_nop 0
    buffer_load_dwordx4 v2, s[12:15], s53 offen offset:0 lds
    buffer_load_dwordx4 v3, s[12:15], s53 offen offset:1024 lds
    buffer_load_dwordx4 v4, s[12:15], s53 offen offset:2048 lds
    buffer_load_dwordx4 v5, s[12:15], s53 offen offset:3072 lds
    s_add_u32 m0, s51, 9216
    s_nop 0
    buffer_load_dwordx4 v6, s[12:15], s53 offen lds
    v_add_u32 v18, 1, v18
    s_waitcnt vmcnt(20) lgkmcnt(0)
    ds_write_b32 v17, v18
    v_min3_u32 v24, v24, v25, v26
    v_min_u32 v24, v24, v27
    s_cmp_lt_u32 s76, 20
    v_readfirstlane_b32 s48, v24
    s_cbranch_scc1 LD_10
    s_sub_u32 s74, s74, 2560
    s_cmp_eq_u32 s72, 1
    s_cbranch_scc1 L_ldC
    v_lshrrev_b32 v28, 3, v1
    v_mul_u32_u24 v29, 81920, v28
    v_bfe_u32 v28, v28, 1, 1
    v_lshlrev_b32 v28, 2, v28
    v_and_b32 v30, 7, v1
    v_xor_b32 v28, v28, v30
    v_lshl_add_u32 v13, v28, 4, v29
    v_add_u32 v13, 2688, v13
    v_subrev_u32 v14, 896, v13
    v_subrev_u32 v15, 1792, v13
    v_subrev_u32 v16, 2688, v13
    s_sub_u32 s24, s24, 2688
    s_subb_u32 s25, s25, 0
    s_add_u32 s26, s26, 2688
    s_bfe_u32 s61, s43, 0x10001
    s_lshl_b32 s61, s61, 1
    s_lshr_b32 s50, s43, 2
    s_lshl_b32 s75, s45, 3
    s_add_u32 s75, s75, s50
    s_mul_i32 s75, s75, 1280
    s_cmp_ge_u32 s48, 10
    s_cbranch_scc1 WD_14
WF_13:
    ds_read_b128 v[28:31], v17 offset:16
    s_waitcnt lgkmcnt(0)
    v_min3_u32 v28, v28, v29, v30
    v_min_u32 v28, v28, v31
    s_sub_u32 s46, s46, 1
    s_cselect_b32 s46, 0, s46
    s_cbranch_scc1 WD_14
    v_readfirstlane_b32 s48, v28
    s_cmp_ge_u32 s48, 10
    s_cbranch_scc0 WF_13
WD_14:
    s_add_u32 s52, s61, 0
    s_and_b32 s52, s52, 3
    s_mul_i32 s52, s52, 655360
    s_add_u32 s52, s52, s75
    s_mov_b32 m0, 108544
    s_add_u32 s50, s52, 0
    buffer_load_dwordx4 v13, s[24:27], s50 offen offset:0 lds
    buffer_load_dwordx4 v14, s[24:27], s50 offen offset:1024 lds
    buffer_load_dwordx4 v15, s[24:27], s50 offen offset:2048 lds
    buffer_load_dwordx4 v16, s[24:27], s50 offen offset:3072 lds
    s_mov_b32 m0, 112640
    s_add_u32 s50, s52, 512
    buffer_load_dwordx4 v13, s[24:27], s50 offen offset:0 lds
    buffer_load_dwordx4 v14, s[24:27], s50 offen offset:1024 lds
    buffer_load_dwordx4 v15, s[24:27], s50 offen offset:2048 lds
    buffer_load_dwordx4 v16, s[24:27], s50 offen offset:3072 lds
    s_mov_b32 m0, 116736
    s_add_u32 s50, s52, 1024
    buffer_load_dwordx4 v13, s[24:27], s50 offen offset:0 lds
    buffer_load_dwordx4 v14, s[24:27], s50 offen offset:1024 lds
    s_add_u32 s52, s61, 1
    s_and_b32 s52, s52, 3
    s_mul_i32 s52, s52, 655360
    s_add_u32 s52, s52, s75
    s_mov_b32 m0, 118784
    s_add_u32 s50, s52, 0
    buffer_load_dwordx4 v13, s[24:27], s50 offen offset:0 lds
    buffer_load_dwordx4 v14, s[24:27], s50 offen offset:1024 lds
    buffer_load_dwordx4 v15, s[24:27], s50 offen offset:2048 lds
    buffer_load_dwordx4 v16, s[24:27], s50 offen offset:3072 lds
    s_mov_b32 m0, 122880
    s_add_u32 s50, s52, 512
    buffer_load_dwordx4 v13, s[24:27], s50 offen offset:0 lds
    buffer_load_dwordx4 v14, s[24:27], s50 offen offset:1024 lds
    buffer_load_dwordx4 v15, s[24:27], s50 offen offset:2048 lds
    buffer_load_dwordx4 v16, s[24:27], s50 offen offset:3072 lds
    s_mov_b32 m0, 126976
    s_add_u32 s50, s52, 1024
    buffer_load_dwordx4 v13, s[24:27], s50 offen offset:0 lds
    buffer_load_dwordx4 v14, s[24:27], s50 offen offset:1024 lds
    s_waitcnt vmcnt(30)
    v_add_u32 v18, 1, v18
    ds_write_b32 v17, v18
    s_waitcnt vmcnt(20)
    v_add_u32 v18, 1, v18
    ds_write_b32 v17, v18
    s_add_u32 s52, s61, 2
    s_and_b32 s52, s52, 3
    s_mul_i32 s52, s52, 655360
    s_add_u32 s52, s52, s75
    s_mov_b32 m0, 129024
    s_add_u32 s50, s52, 0
    buffer_load_dwordx4 v13, s[24:27], s50 offen offset:0 lds
    buffer_load_dwordx4 v14, s[24:27], s50 offen offset:1024 lds
    buffer_load_dwordx4 v15, s[24:27], s50 offen offset:2048 lds
    buffer_load_dwordx4 v16, s[24:27], s50 offen offset:3072 lds
    s_mov_b32 m0, 133120
    s_add_u32 s50, s52, 512
    buffer_load_dwordx4 v13, s[24:27], s50 offen offset:0 lds
    buffer_load_dwordx4 v14, s[24:27], s50 offen offset:1024 lds
    buffer_load_dwordx4 v15, s[24:27], s50 offen offset:2048 lds
    buffer_load_dwordx4 v16, s[24:27], s50 offen offset:3072 lds
    s_mov_b32 m0, 137216
    s_add_u32 s50, s52, 1024
    buffer_load_dwordx4 v13, s[24:27], s50 offen offset:0 lds
    buffer_load_dwordx4 v14, s[24:27], s50 offen offset:1024 lds
    s_waitcnt vmcnt(20)
    v_mov_b32 v28, 1
    ds_write_b32 v17, v28 offset:4
    s_add_u32 s52, s61, 3
    s_and_b32 s52, s52, 3
    s_mul_i32 s52, s52, 655360
    s_add_u32 s52, s52, s75
    s_mov_b32 m0, 139264
    s_add_u32 s50, s52, 0
    buffer_load_dwordx4 v13, s[24:27], s50 offen offset:0 lds
    buffer_load_dwordx4 v14, s[24:27], s50 offen offset:1024 lds
    buffer_load_dwordx4 v15, s[24:27], s50 offen offset:2048 lds
    buffer_load_dwordx4 v16, s[24:27], s50 offen offset:3072 lds
    s_mov_b32 m0, 143360
    s_add_u32 s50, s52, 512
    buffer_load_dwordx4 v13, s[24:27], s50 offen offset:0 lds
    buffer_load_dwordx4 v14, s[24:27], s50 offen offset:1024 lds
    buffer_load_dwordx4 v15, s[24:27], s50 offen offset:2048 lds
    buffer_load_dwordx4 v16, s[24:27], s50 offen offset:3072 lds
    s_mov_b32 m0, 147456
    s_add_u32 s50, s52, 1024
    buffer_load_dwordx4 v13, s[24:27], s50 offen offset:0 lds
    buffer_load_dwordx4 v14, s[24:27], s50 offen offset:1024 lds
    s_waitcnt vmcnt(20)
    v_mov_b32 v28, 2
    ds_write_b32 v17, v28 offset:4
    s_add_u32 s54, s76, -6
    s_cmp_ge_u32 s48, s54
    s_cbranch_scc1 WD_16
WF_15:
    ds_read_b128 v[28:31], v17 offset:16
    s_waitcnt lgkmcnt(0)
    v_min3_u32 v28, v28, v29, v30
    v_min_u32 v28, v28, v31
    s_sub_u32 s46, s46, 1
    s_cselect_b32 s46, 0, s46
    s_cbranch_scc1 WD_16
    v_readfirstlane_b32 s48, v28
    s_cmp_ge_u32 s48, s54
    s_cbranch_scc0 WF_15
WD_16:
    s_mul_i32 s50, s77, 245760
    s_add_u32 s50, s50, s74
    s_mov_b32 s51, s55
    s_add_u32 s77, s77, 1
    s_cmp_eq_u32 s77, 10
    s_cselect_b32 s77, 0, s77
    s_add_u32 s55, s55, 10240
    s_cmp_eq_u32 s55, 71680
    s_cselect_b32 s55, 0, s55
    s_add_u32 s76, s76, 1
    s_mov_b32 m0, s51
    s_add_u32 s53, s50, 122880
    buffer_load_dwordx4 v2, s[12:15], s50 offen offset:0 lds
    buffer_load_dwordx4 v3, s[12:15], s50 offen offset:1024 lds
    buffer_load_dwordx4 v4, s[12:15], s50 offen offset:2048 lds
    buffer_load_dwordx4 v5, s[12:15], s50 offen offset:3072 lds
    s_add_u32 m0, s51, 4096
    s_nop 0
    buffer_load_dwordx4 v6, s[12:15], s50 offen lds
    s_add_u32 m0, s51, 5120
    s_nop 0
    buffer_load_dwordx4 v2, s[12:15], s53 offen offset:0 lds
    buffer_load_dwordx4 v3, s[12:15], s53 offen offset:1024 lds
    buffer_load_dwordx4 v4, s[12:15], s53 offen offset:2048 lds
    buffer_load_dwordx4 v5, s[12:15], s53 offen offset:3072 lds
    s_add_u32 m0, s51, 9216
    s_nop 0
    buffer_load_dwordx4 v6, s[12:15], s53 offen lds
    s_add_u32 s54, s76, -6
    s_cmp_ge_u32 s48, s54
    s_cbranch_scc1 WD_18
WF_17:
    ds_read_b128 v[28:31], v17 offset:16
    s_waitcnt lgkmcnt(0)
    v_min3_u32 v28, v28, v29, v30
    v_min_u32 v28, v28, v31
    s_sub_u32 s46, s46, 1
    s_cselect_b32 s46, 0, s46
    s_cbranch_scc1 WD_18
    v_readfirstlane_b32 s48, v28
    s_cmp_ge_u32 s48, s54
    s_cbranch_scc0 WF_17
WD_18:
    s_mul_i32 s50, s77, 245760
    s_add_u32 s50, s50, s74
    s_mov_b32 s51, s55
    s_add_u32 s77, s77, 1
    s_cmp_eq_u32 s77, 10
    s_cselect_b32 s77, 0, s77
    s_add_u32 s55, s55, 10240
    s_cmp_eq_u32 s55, 71680
    s_cselect_b32 s55, 0, s55
    s_add_u32 s76, s76, 1
    s_mov_b32 m0, s51
    s_add_u32 s53, s50, 122880
    buffer_load_dwordx4 v2, s[12:15], s50 offen offset:0 lds
    buffer_load_dwordx4 v3, s[12:15], s50 offen offset:1024 lds
    buffer_load_dwordx4 v4, s[12:15], s50 offen offset:2048 lds
    buffer_load_dwordx4 v5, s[12:15], s50 offen offset:3072 lds
    s_add_u32 m0, s51, 4096
    s_nop 0
    buffer_load_dwordx4 v6, s[12:15], s50 offen lds
    s_add_u32 m0, s51, 5120
    s_nop 0
    buffer_load_dwordx4 v2, s[12:15], s53 offen offset:0 lds
    buffer_load_dwordx4 v3, s[12:15], s53 offen offset:1024 lds
    buffer_load_dwordx4 v4, s[12:15], s53 offen offset:2048 lds
    buffer_load_dwordx4 v5, s[12:15], s53 offen offset:3072 lds
    s_add_u32 m0, s51, 9216
    s_nop 0
    buffer_load_dwordx4 v6, s[12:15], s53 offen lds
    s_waitcnt vmcnt(30)
    v_mov_b32 v28, 3
    ds_write_b32 v17, v28 offset:4
    s_waitcnt vmcnt(20)
    v_mov_b32 v28, 4
    ds_write_b32 v17, v28 offset:4
LD_19:
    s_add_u32 s54, s76, -6
    s_cmp_ge_i32 s48, s54
    s_cbranch_scc0 LS_20
LB_21:
    ds_read_b128 v[24:27], v17 offset:16
    s_mul_i32 s50, s77, 245760
    s_add_u32 s50, s50, s74
    s_mov_b32 s51, s55
    s_add_u32 s77, s77, 1
    s_cmp_eq_u32 s77, 10
    s_cselect_b32 s77, 0, s77
    s_add_u32 s55, s55, 10240
    s_cmp_eq_u32 s55, 71680
    s_cselect_b32 s55, 0, s55
    s_add_u32 s76, s76, 1
    s_mov_b32 m0, s51
    s_add_u32 s53, s50, 122880
    buffer_load_dwordx4 v2, s[12:15], s50 offen offset:0 lds
    buffer_load_dwordx4 v3, s[12:15], s50 offen offset:1024 lds
    buffer_load_dwordx4 v4, s[12:15], s50 offen offset:2048 lds
    buffer_load_dwordx4 v5, s[12:15], s50 offen offset:3072 lds
    s_add_u32 m0, s51, 4096
    s_nop 0
    buffer_load_dwordx4 v6, s[12:15], s50 offen lds
    s_add_u32 m0, s51, 5120
    s_nop 0
    buffer_load_dwordx4 v2, s[12:15], s53 offen offset:0 lds
    buffer_load_dwordx4 v3, s[12:15], s53 offen offset:1024 lds
    buffer_load_dwordx4 v4, s[12:15], s53 offen offset:2048 lds
    buffer_load_dwordx4 v5, s[12:15], s53 offen offset:3072 lds
    s_add_u32 m0, s51, 9216
    s_nop 0
    buffer_load_dwordx4 v6, s[12:15], s53 offen lds
    v_add_u32 v18, 1, v18
    s_waitcnt vmcnt(20) lgkmcnt(0)
    ds_write_b32 v17, v18
    v_min3_u32 v24, v24, v25, v26
    v_min_u32 v24, v24, v27
    s_cmp_lt_u32 s76, 27
    v_readfirstlane_b32 s48, v24
    s_cbranch_scc1 LD_19
LD_22:
    s_add_u32 s54, s76, -4
    s_cmp_ge_i32 s48, s54
    s_cbranch_scc0 LS_23
LB_24:
    ds_read_b128 v[24:27], v17 offset:16
    s_mul_i32 s50, s77, 245760
    s_add_u32 s50, s50, s74
    s_mov_b32 s51, s55
    s_add_u32 s77, s77, 1
    s_cmp_eq_u32 s77, 10
    s_cselect_b32 s77, 0, s77
    s_add_u32 s55, s55, 10240
    s_cmp_eq_u32 s55, 71680
    s_cselect_b32 s55, 0, s55
    s_add_u32 s76, s76, 1
    s_mov_b32 m0, s51
    s_add_u32 s53, s50, 122880
    buffer_load_dwordx4 v2, s[12:15], s50 offen offset:0 lds
    buffer_load_dwordx4 v3, s[12:15], s50 offen offset:1024 lds
    buffer_load_dwordx4 v4, s[12:15], s50 offen offset:2048 lds
    buffer_load_dwordx4 v5, s[12:15], s50 offen offset:3072 lds
    s_add_u32 m0, s51, 4096
    s_nop 0
    buffer_load_dwordx4 v6, s[12:15], s50 offen lds
    s_add_u32 m0, s51, 5120
    s_nop 0
    buffer_load_dwordx4 v2, s[12:15], s53 offen offset:0 lds
    buffer_load_dwordx4 v3, s[12:15], s53 offen offset:1024 lds
    buffer_load_dwordx4 v4, s[12:15], s53 offen offset:2048 lds
    buffer_load_dwordx4 v5, s[12:15], s53 offen offset:3072 lds
    s_add_u32 m0, s51, 9216
    s_nop 0
    buffer_load_dwordx4 v6, s[12:15], s53 offen lds
    v_add_u32 v18, 1, v18
    s_waitcnt vmcnt(20) lgkmcnt(0)
    ds_write_b32 v17, v18
    v_min3_u32 v24, v24, v25, v26
    v_min_u32 v24, v24, v27
    s_cmp_lt_u32 s76, 30
    v_readfirstlane_b32 s48, v24
    s_cbranch_scc1 LD_22
    s_mul_i32 s74, s42, 160
    v_mul_u32_u24 v28, 6554, v1
    s_movk_i32 s50, 1120
    v_lshrrev_b32 v29, 16, v28
    v_mad_u32_u24 v8, v29, s50, v64
    v_add_u32 v29, 419456, v28
    v_lshrrev_b32 v29, 16, v29
    v_mad_u32_u24 v9, v29, s50, v64
    v_add_u32 v29, 838912, v28
    v_lshrrev_b32 v29, 16, v29
    v_mad_u32_u24 v10, v29, s50, v64
    v_add_u32 v29, 1258368, v28
    v_lshrrev_b32 v29, 16, v29
    v_mad_u32_u24 v11, v29, s50, v64
    v_add_u32 v29, 1677824, v28
    v_lshrrev_b32 v29, 16, v29
    v_mad_u32_u24 v12, v29, s50, v64
    v_add_u32 v12, 4096, v12
    s_cmp_ge_u32 s48, 22
    s_cbranch_scc1 WD_26
WF_25:
    ds_read_b128 v[28:31], v17 offset:16
    s_waitcnt lgkmcnt(0)
    v_min3_u32 v28, v28, v29, v30
    v_min_u32 v28, v28, v31
    s_sub_u32 s46, s46, 1
    s_cselect_b32 s46, 0, s46
    s_cbranch_scc1 WD_26
    v_readfirstlane_b32 s48, v28
    s_cmp_ge_u32 s48, 22
    s_cbranch_scc0 WF_25
WD_26:
    s_lshr_b32 s52, s44, 2
    s_mul_i32 s53, s52, 86
    s_lshr_b32 s53, s53, 8
    s_mul_i32 s53, s53, 3
    s_sub_u32 s53, s52, s53
    s_lshl_b32 s53, s53, 2
    s_lshr_b32 s61, 0x87987, s53
    s_bfe_u32 s53, s61, 0x40008
    s_or_b32 s62, s53, 0x10654320
    s_mov_b32 s63, s62
    s_lshl_b32 s52, s52, 2
    s_lshr_b64 s[62:63], s[62:63], s52
    s_mov_b32 s77, s62
    s_and_b32 s52, s61, 15
    s_lshr_b32 s61, s61, 4
    s_mul_i32 s50, s52, 81920
    s_add_u32 s50, s50, s74
    s_mul_i32 s51, s52, 10240
    s_mov_b32 m0, s51
    s_add_u32 s53, s50, 40960
    buffer_load_dwordx4 v8, s[20:23], s50 offen offset:0 lds
    buffer_load_dwordx4 v9, s[20:23], s50 offen offset:1024 lds
    buffer_load_dwordx4 v10, s[20:23], s50 offen offset:2048 lds
    buffer_load_dwordx4 v11, s[20:23], s50 offen offset:3072 lds
    s_add_u32 m0, s51, 4096
    s_nop 0
    buffer_load_dwordx4 v12, s[20:23], s50 offen lds
    s_add_u32 m0, s51, 5120
    s_nop 0
    buffer_load_dwordx4 v8, s[20:23], s53 offen offset:0 lds
    buffer_load_dwordx4 v9, s[20:23], s53 offen offset:1024 lds
    buffer_load_dwordx4 v10, s[20:23], s53 offen offset:2048 lds
    buffer_load_dwordx4 v11, s[20:23], s53 offen offset:3072 lds
    s_add_u32 m0, s51, 9216
    s_nop 0
    buffer_load_dwordx4 v12, s[20:23], s53 offen lds
    s_waitcnt vmcnt(20)
    v_add_u32 v18, 1, v18
    ds_write_b32 v17, v18
    s_and_b32 s52, s61, 15
    s_lshr_b32 s61, s61, 4
    s_mul_i32 s50, s52, 81920
    s_add_u32 s50, s50, s74
    s_mul_i32 s51, s52, 10240
    s_mov_b32 m0, s51
    s_add_u32 s53, s50, 40960
    buffer_load_dwordx4 v8, s[20:23], s50 offen offset:0 lds
    buffer_load_dwordx4 v9, s[20:23], s50 offen offset:1024 lds
    buffer_load_dwordx4 v10, s[20:23], s50 offen offset:2048 lds
    buffer_load_dwordx4 v11, s[20:23], s50 offen offset:3072 lds
    s_add_u32 m0, s51, 4096
    s_nop 0
    buffer_load_dwordx4 v12, s[20:23], s50 offen lds
    s_add_u32 m0, s51, 5120
    s_nop 0
    buffer_load_dwordx4 v8, s[20:23], s53 offen offset:0 lds
    buffer_load_dwordx4 v9, s[20:23], s53 offen offset:1024 lds
    buffer_load_dwordx4 v10, s[20:23], s53 offen offset:2048 lds
    buffer_load_dwordx4 v11, s[20:23], s53 offen offset:3072 lds
    s_add_u32 m0, s51, 9216
    s_nop 0
    buffer_load_dwordx4 v12, s[20:23], s53 offen lds
    s_waitcnt vmcnt(20)
    v_add_u32 v18, 1, v18
    ds_write_b32 v17, v18
    s_mov_b32 s76, 2
WO_27:
    s_cmp_lt_u32 s76, 10
    s_cbranch_scc0 WOD_28
    s_waitcnt vmcnt(20)
    s_and_b32 s52, s77, 15
    s_lshr_b32 s77, s77, 4
    s_add_u32 s54, s52, 31
    s_cmp_ge_u32 s52, 2
    s_cselect_b32 s53, 7, 0
    s_sub_u32 s54, s54, s53
    s_cmp_ge_u32 s52, 7
    s_cselect_b32 s54, 22, s54
    s_cmp_ge_u32 s48, s54
    s_cbranch_scc1 WD_30
WF_29:
    ds_read_b128 v[28:31], v17 offset:16
    s_waitcnt lgkmcnt(0)
    v_min3_u32 v28, v28, v29, v30
    v_min_u32 v28, v28, v31
    s_sub_u32 s46, s46, 1
    s_cselect_b32 s46, 0, s46
    s_cbranch_scc1 WD_30
    v_readfirstlane_b32 s48, v28
    s_cmp_ge_u32 s48, s54
    s_cbranch_scc0 WF_29
WD_30:
    s_mul_i32 s50, s52, 81920
    s_add_u32 s50, s50, s74
    s_mul_i32 s51, s52, 10240
    s_mov_b32 m0, s51
    s_add_u32 s53, s50, 40960
    buffer_load_dwordx4 v8, s[20:23], s50 offen offset:0 lds
    buffer_load_dwordx4 v9, s[20:23], s50 offen offset:1024 lds
    buffer_load_dwordx4 v10, s[20:23], s50 offen offset:2048 lds
    buffer_load_dwordx4 v11, s[20:23], s50 offen offset:3072 lds
    s_add_u32 m0, s51, 4096
    s_nop 0
    buffer_load_dwordx4 v12, s[20:23], s50 offen lds
    s_add_u32 m0, s51, 5120
    s_nop 0
    buffer_load_dwordx4 v8, s[20:23], s53 offen offset:0 lds
    buffer_load_dwordx4 v9, s[20:23], s53 offen offset:1024 lds
    buffer_load_dwordx4 v10, s[20:23], s53 offen offset:2048 lds
    buffer_load_dwordx4 v11, s[20:23], s53 offen offset:3072 lds
    s_add_u32 m0, s51, 9216
    s_nop 0
    buffer_load_dwordx4 v12, s[20:23], s53 offen lds
    s_add_u32 s76, s76, 1
    s_branch WO_27
WOD_28:
    s_mov_b32 s49, 0
    s_cmp_ge_u32 s49, 1
    s_cbranch_scc1 WD_32
WF_31:
    ds_read_b32 v28, v17 offset:80
    s_sub_u32 s46, s46, 1
    s_cselect_b32 s46, 0, s46
    s_cbranch_scc1 WD_32
    s_waitcnt lgkmcnt(0)
    v_readfirstlane_b32 s49, v28
    s_cmp_ge_u32 s49, 1
    s_cbranch_scc0 WF_31
WD_32:
    v_add_u32 v28, v17, v64
    v_lshl_add_u32 v29, v1, 2, v17
    ds_read_b128 v[12:15], v28 offset:256
    ds_read_b32 v16, v29 offset:1280
    s_mul_i32 s75, s45, 335872
    s_add_u32 s75, s75, 6291456
    s_waitcnt lgkmcnt(0)
    s_waitcnt vmcnt(0)
    v_mov_b32 v28, 40
    ds_write_b32 v17, v28 offset:0
    s_cmp_ge_u32 s48, 34
    s_cbranch_scc1 WD_34
WF_33:
    s_sleep 1
    ds_read_b128 v[28:31], v17 offset:16
    s_waitcnt lgkmcnt(0)
    v_min3_u32 v28, v28, v29, v30
    v_min_u32 v28, v28, v31
    s_sub_u32 s46, s46, 1
    s_cselect_b32 s46, 0, s46
    s_cbranch_scc1 WD_34
    v_readfirstlane_b32 s48, v28
    s_cmp_ge_u32 s48, 34
    s_cbranch_scc0 WF_33
WD_34:
    v_mov_b32 v28, 1
    ds_write_b32 v17, v28 offset:92
    s_mov_b32 m0, 108544
    s_nop 0
    buffer_load_dwordx4 v12, s[36:39], s75 offen sc1 lds
    s_mov_b32 m0, 109568
    s_nop 0
    buffer_load_dwordx4 v13, s[36:39], s75 offen sc1 lds
    s_mov_b32 m0, 110592
    s_nop 0
    buffer_load_dwordx4 v14, s[36:39], s75 offen sc1 lds
    s_mov_b32 m0, 111616
    s_nop 0
    buffer_load_dwordx4 v15, s[36:39], s75 offen sc1 lds
    s_mov_b32 m0, 112640
    s_nop 0
    buffer_load_dwordx4 v16, s[36:39], s75 offen sc1 lds
    s_mov_b32 m0, 113664
    s_add_u32 s75, s75, 41984
    buffer_load_dwordx4 v12, s[36:39], s75 offen sc1 lds
    s_mov_b32 m0, 114688
    s_nop 0
    buffer_load_dwordx4 v13, s[36:39], s75 offen sc1 lds
    s_mov_b32 m0, 115712
    s_nop 0
    buffer_load_dwordx4 v14, s[36:39], s75 offen sc1 lds
    s_mov_b32 m0, 116736
    s_nop 0
    buffer_load_dwordx4 v15, s[36:39], s75 offen sc1 lds
    s_mov_b32 m0, 117760
    s_nop 0
    buffer_load_dwordx4 v16, s[36:39], s75 offen sc1 lds
    s_mov_b32 m0, 118784
    s_add_u32 s75, s75, 41984
    buffer_load_dwordx4 v12, s[36:39], s75 offen sc1 lds
    s_mov_b32 m0, 119808
    s_nop 0
    buffer_load_dwordx4 v13, s[36:39], s75 offen sc1 lds
    s_mov_b32 m0, 120832
    s_nop 0
    buffer_load_dwordx4 v14, s[36:39], s75 offen sc1 lds
    s_mov_b32 m0, 121856
    s_nop 0
    buffer_load_dwordx4 v15, s[36:39], s75 offen sc1 lds
    s_mov_b32 m0, 122880
    s_nop 0
    buffer_load_dwordx4 v16, s[36:39], s75 offen sc1 lds
    s_mov_b32 m0, 123904
    s_add_u32 s75, s75, 41984
    buffer_load_dwordx4 v12, s[36:39], s75 offen sc1 lds
    s_mov_b32 m0, 124928
    s_nop 0
    buffer_load_dwordx4 v13, s[36:39], s75 offen sc1 lds
    s_mov_b32 m0, 125952
    s_nop 0
    buffer_load_dwordx4 v14, s[36:39], s75 offen sc1 lds
    s_mov_b32 m0, 126976
    s_nop 0
    buffer_load_dwordx4 v15, s[36:39], s75 offen sc1 lds
    s_mov_b32 m0, 128000
    s_nop 0
    buffer_load_dwordx4 v16, s[36:39], s75 offen sc1 lds
    s_mov_b32 m0, 129024
    s_add_u32 s75, s75, 41984
    buffer_load_dwordx4 v12, s[36:39], s75 offen sc1 lds
    s_mov_b32 m0, 130048
    s_nop 0
    buffer_load_dwordx4 v13, s[36:39], s75 offen sc1 lds
    s_mov_b32 m0, 131072
    s_nop 0
    buffer_load_dwordx4 v14, s[36:39], s75 offen sc1 lds
    s_mov_b32 m0, 132096
    s_nop 0
    buffer_load_dwordx4 v15, s[36:39], s75 offen sc1 lds
    s_mov_b32 m0, 133120
    s_nop 0
    buffer_load_dwordx4 v16, s[36:39], s75 offen sc1 lds
    s_mov_b32 m0, 134144
    s_add_u32 s75, s75, 41984
    buffer_load_dwordx4 v12, s[36:39], s75 offen sc1 lds
    s_mov_b32 m0, 135168
    s_nop 0
    buffer_load_dwordx4 v13, s[36:39], s75 offen sc1 lds
    s_mov_b32 m0, 136192
    s_nop 0
    buffer_load_dwordx4 v14, s[36:39], s75 offen sc1 lds
    s_mov_b32 m0, 137216
    s_nop 0
    buffer_load_dwordx4 v15, s[36:39], s75 offen sc1 lds
    s_mov_b32 m0, 138240
    s_nop 0
    buffer_load_dwordx4 v16, s[36:39], s75 offen sc1 lds
    s_mov_b32 m0, 139264
    s_add_u32 s75, s75, 41984
    buffer_load_dwordx4 v12, s[36:39], s75 offen sc1 lds
    s_mov_b32 m0, 140288
    s_nop 0
    buffer_load_dwordx4 v13, s[36:39], s75 offen sc1 lds
    s_mov_b32 m0, 141312
    s_nop 0
    buffer_load_dwordx4 v14, s[36:39], s75 offen sc1 lds
    s_mov_b32 m0, 142336
    s_nop 0
    buffer_load_dwordx4 v15, s[36:39], s75 offen sc1 lds
    s_mov_b32 m0, 143360
    s_nop 0
    buffer_load_dwordx4 v16, s[36:39], s75 offen sc1 lds
    s_mov_b32 m0, 144384
    s_add_u32 s75, s75, 41984
    buffer_load_dwordx4 v12, s[36:39], s75 offen sc1 lds
    s_mov_b32 m0, 145408
    s_nop 0
    buffer_load_dwordx4 v13, s[36:39], s75 offen sc1 lds
    s_mov_b32 m0, 146432
    s_nop 0
    buffer_load_dwordx4 v14, s[36:39], s75 offen sc1 lds
    s_mov_b32 m0, 147456
    s_nop 0
    buffer_load_dwordx4 v15, s[36:39], s75 offen sc1 lds
    s_mov_b32 m0, 148480
    s_nop 0
    buffer_load_dwordx4 v16, s[36:39], s75 offen sc1 lds
    s_waitcnt vmcnt(30)
    v_mov_b32 v28, 1
    ds_write_b32 v17, v28 offset:88
    s_waitcnt vmcnt(20)
    v_mov_b32 v28, 2
    ds_write_b32 v17, v28 offset:88
    s_waitcnt vmcnt(10)
    v_mov_b32 v28, 3
    ds_write_b32 v17, v28 offset:88
    s_waitcnt vmcnt(0)
    v_mov_b32 v28, 4
    ds_write_b32 v17, v28 offset:88
    s_waitcnt lgkmcnt(0)
    s_endpgm
L_ldC:
LD_35:
    s_add_u32 s54, s76, -6
    s_cmp_ge_i32 s48, s54
    s_cbranch_scc0 LS_36
LB_37:
    ds_read_b128 v[24:27], v17 offset:16
    s_mul_i32 s50, s77, 245760
    s_add_u32 s50, s50, s74
    s_mov_b32 s51, s55
    s_add_u32 s77, s77, 1
    s_cmp_eq_u32 s77, 10
    s_cselect_b32 s77, 0, s77
    s_add_u32 s55, s55, 10240
    s_cmp_eq_u32 s55, 71680
    s_cselect_b32 s55, 0, s55
    s_add_u32 s76, s76, 1
    s_mov_b32 m0, s51
    s_add_u32 s53, s50, 122880
    buffer_load_dwordx4 v2, s[12:15], s50 offen offset:0 lds
    buffer_load_dwordx4 v3, s[12:15], s50 offen offset:1024 lds
    buffer_load_dwordx4 v4, s[12:15], s50 offen offset:2048 lds
    buffer_load_dwordx4 v5, s[12:15], s50 offen offset:3072 lds
    s_add_u32 m0, s51, 4096
    s_nop 0
    buffer_load_dwordx4 v6, s[12:15], s50 offen lds
    s_add_u32 m0, s51, 5120
    s_nop 0
    buffer_load_dwordx4 v2, s[12:15], s53 offen offset:0 lds
    buffer_load_dwordx4 v3, s[12:15], s53 offen offset:1024 lds
    buffer_load_dwordx4 v4, s[12:15], s53 offen offset:2048 lds
    buffer_load_dwordx4 v5, s[12:15], s53 offen offset:3072 lds
    s_add_u32 m0, s51, 9216
    s_nop 0
    buffer_load_dwordx4 v6, s[12:15], s53 offen lds
    v_add_u32 v18, 1, v18
    s_waitcnt vmcnt(20) lgkmcnt(0)
    ds_write_b32 v17, v18
    v_min3_u32 v24, v24, v25, v26
    v_min_u32 v24, v24, v27
    s_cmp_lt_u32 s76, 27
    v_readfirstlane_b32 s48, v24
    s_cbranch_scc1 LD_35
LD_38:
    s_add_u32 s54, s76, -4
    s_cmp_ge_i32 s48, s54
    s_cbranch_scc0 LS_39
LB_40:
    ds_read_b128 v[24:27], v17 offset:16
    s_mul_i32 s50, s77, 245760
    s_add_u32 s50, s50, s74
    s_mov_b32 s51, s55
    s_add_u32 s77, s77, 1
    s_cmp_eq_u32 s77, 10
    s_cselect_b32 s77, 0, s77
    s_add_u32 s55, s55, 10240
    s_cmp_eq_u32 s55, 71680
    s_cselect_b32 s55, 0, s55
    s_add_u32 s76, s76, 1
    s_mov_b32 m0, s51
    s_add_u32 s53, s50, 122880
    buffer_load_dwordx4 v2, s[12:15], s50 offen offset:0 lds
    buffer_load_dwordx4 v3, s[12:15], s50 offen offset:1024 lds
    buffer_load_dwordx4 v4, s[12:15], s50 offen offset:2048 lds
    buffer_load_dwordx4 v5, s[12:15], s50 offen offset:3072 lds
    s_add_u32 m0, s51, 4096
    s_nop 0
    buffer_load_dwordx4 v6, s[12:15], s50 offen lds
    s_add_u32 m0, s51, 5120
    s_nop 0
    buffer_load_dwordx4 v2, s[12:15], s53 offen offset:0 lds
    buffer_load_dwordx4 v3, s[12:15], s53 offen offset:1024 lds
    buffer_load_dwordx4 v4, s[12:15], s53 offen offset:2048 lds
    buffer_load_dwordx4 v5, s[12:15], s53 offen offset:3072 lds
    s_add_u32 m0, s51, 9216
    s_nop 0
    buffer_load_dwordx4 v6, s[12:15], s53 offen lds
    v_add_u32 v18, 1, v18
    s_waitcnt vmcnt(20) lgkmcnt(0)
    ds_write_b32 v17, v18
    v_min3_u32 v24, v24, v25, v26
    v_min_u32 v24, v24, v27
    s_cmp_lt_u32 s76, 30
    v_readfirstlane_b32 s48, v24
    s_cbranch_scc1 LD_38
    s_mul_i32 s74, s42, 160
    v_mul_u32_u24 v28, 6554, v1
    s_movk_i32 s50, 1120
    v_lshrrev_b32 v29, 16, v28
    v_mad_u32_u24 v8, v29, s50, v64
    v_add_u32 v29, 419456, v28
    v_lshrrev_b32 v29, 16, v29
    v_mad_u32_u24 v9, v29, s50, v64
    v_add_u32 v29, 838912, v28
    v_lshrrev_b32 v29, 16, v29
    v_mad_u32_u24 v10, v29, s50, v64
    v_add_u32 v29, 1258368, v28
    v_lshrrev_b32 v29, 16, v29
    v_mad_u32_u24 v11, v29, s50, v64
    v_add_u32 v29, 1677824, v28
    v_lshrrev_b32 v29, 16, v29
    v_mad_u32_u24 v12, v29, s50, v64
    v_add_u32 v12, 4096, v12
    s_cmp_ge_u32 s48, 22
    s_cbranch_scc1 WD_42
WF_41:
    ds_read_b128 v[28:31], v17 offset:16
    s_waitcnt lgkmcnt(0)
    v_min3_u32 v28, v28, v29, v30
    v_min_u32 v28, v28, v31
    s_sub_u32 s46, s46, 1
    s_cselect_b32 s46, 0, s46
    s_cbranch_scc1 WD_42
    v_readfirstlane_b32 s48, v28
    s_cmp_ge_u32 s48, 22
    s_cbranch_scc0 WF_41
WD_42:
    s_lshr_b32 s52, s44, 2
    s_mul_i32 s53, s52, 86
    s_lshr_b32 s53, s53, 8
    s_mul_i32 s53, s53, 3
    s_sub_u32 s53, s52, s53
    s_lshl_b32 s53, s53, 2
    s_lshr_b32 s61, 0x87987, s53
    s_bfe_u32 s53, s61, 0x40008
    s_or_b32 s62, s53, 0x10654320
    s_mov_b32 s63, s62
    s_lshl_b32 s52, s52, 2
    s_lshr_b64 s[62:63], s[62:63], s52
    s_mov_b32 s77, s62
    s_and_b32 s52, s61, 15
    s_lshr_b32 s61, s61, 4
    s_mul_i32 s50, s52, 81920
    s_add_u32 s50, s50, s74
    s_mul_i32 s51, s52, 10240
    s_mov_b32 m0, s51
    s_add_u32 s53, s50, 40960
    buffer_load_dwordx4 v8, s[20:23], s50 offen offset:0 lds
    buffer_load_dwordx4 v9, s[20:23], s50 offen offset:1024 lds
    buffer_load_dwordx4 v10, s[20:23], s50 offen offset:2048 lds
    buffer_load_dwordx4 v11, s[20:23], s50 offen offset:3072 lds
    s_add_u32 m0, s51, 4096
    s_nop 0
    buffer_load_dwordx4 v12, s[20:23], s50 offen lds
    s_add_u32 m0, s51, 5120
    s_nop 0
    buffer_load_dwordx4 v8, s[20:23], s53 offen offset:0 lds
    buffer_load_dwordx4 v9, s[20:23], s53 offen offset:1024 lds
    buffer_load_dwordx4 v10, s[20:23], s53 offen offset:2048 lds
    buffer_load_dwordx4 v11, s[20:23], s53 offen offset:3072 lds
    s_add_u32 m0, s51, 9216
    s_nop 0
    buffer_load_dwordx4 v12, s[20:23], s53 offen lds
    s_waitcnt vmcnt(20)
    v_add_u32 v18, 1, v18
    ds_write_b32 v17, v18
    s_and_b32 s52, s61, 15
    s_lshr_b32 s61, s61, 4
    s_mul_i32 s50, s52, 81920
    s_add_u32 s50, s50, s74
    s_mul_i32 s51, s52, 10240
    s_mov_b32 m0, s51
    s_add_u32 s53, s50, 40960
    buffer_load_dwordx4 v8, s[20:23], s50 offen offset:0 lds
    buffer_load_dwordx4 v9, s[20:23], s50 offen offset:1024 lds
    buffer_load_dwordx4 v10, s[20:23], s50 offen offset:2048 lds
    buffer_load_dwordx4 v11, s[20:23], s50 offen offset:3072 lds
    s_add_u32 m0, s51, 4096
    s_nop 0
    buffer_load_dwordx4 v12, s[20:23], s50 offen lds
    s_add_u32 m0, s51, 5120
    s_nop 0
    buffer_load_dwordx4 v8, s[20:23], s53 offen offset:0 lds
    buffer_load_dwordx4 v9, s[20:23], s53 offen offset:1024 lds
    buffer_load_dwordx4 v10, s[20:23], s53 offen offset:2048 lds
    buffer_load_dwordx4 v11, s[20:23], s53 offen offset:3072 lds
    s_add_u32 m0, s51, 9216
    s_nop 0
    buffer_load_dwordx4 v12, s[20:23], s53 offen lds
    s_waitcnt vmcnt(20)
    v_add_u32 v18, 1, v18
    ds_write_b32 v17, v18
    s_mov_b32 s76, 2
WO_43:
    s_cmp_lt_u32 s76, 10
    s_cbranch_scc0 WOD_44
    s_waitcnt vmcnt(20)
    s_and_b32 s52, s77, 15
    s_lshr_b32 s77, s77, 4
    s_add_u32 s54, s52, 31
    s_cmp_ge_u32 s52, 2
    s_cselect_b32 s53, 7, 0
    s_sub_u32 s54, s54, s53
    s_cmp_ge_u32 s52, 7
    s_cselect_b32 s54, 22, s54
    s_cmp_ge_u32 s48, s54
    s_cbranch_scc1 WD_46
WF_45:
    ds_read_b128 v[28:31], v17 offset:16
    s_waitcnt lgkmcnt(0)
    v_min3_u32 v28, v28, v29, v30
    v_min_u32 v28, v28, v31
    s_sub_u32 s46, s46, 1
    s_cselect_b32 s46, 0, s46
    s_cbranch_scc1 WD_46
    v_readfirstlane_b32 s48, v28
    s_cmp_ge_u32 s48, s54
    s_cbranch_scc0 WF_45
WD_46:
    s_mul_i32 s50, s52, 81920
    s_add_u32 s50, s50, s74
    s_mul_i32 s51, s52, 10240
    s_mov_b32 m0, s51
    s_add_u32 s53, s50, 40960
    buffer_load_dwordx4 v8, s[20:23], s50 offen offset:0 lds
    buffer_load_dwordx4 v9, s[20:23], s50 offen offset:1024 lds
    buffer_load_dwordx4 v10, s[20:23], s50 offen offset:2048 lds
    buffer_load_dwordx4 v11, s[20:23], s50 offen offset:3072 lds
    s_add_u32 m0, s51, 4096
    s_nop 0
    buffer_load_dwordx4 v12, s[20:23], s50 offen lds
    s_add_u32 m0, s51, 5120
    s_nop 0
    buffer_load_dwordx4 v8, s[20:23], s53 offen offset:0 lds
    buffer_load_dwordx4 v9, s[20:23], s53 offen offset:1024 lds
    buffer_load_dwordx4 v10, s[20:23], s53 offen offset:2048 lds
    buffer_load_dwordx4 v11, s[20:23], s53 offen offset:3072 lds
    s_add_u32 m0, s51, 9216
    s_nop 0
    buffer_load_dwordx4 v12, s[20:23], s53 offen lds
    s_add_u32 s76, s76, 1
    s_branch WO_43
WOD_44:
    s_mov_b32 s49, 0
    s_cmp_ge_u32 s49, 1
    s_cbranch_scc1 WD_48
WF_47:
    ds_read_b32 v28, v17 offset:80
    s_sub_u32 s46, s46, 1
    s_cselect_b32 s46, 0, s46
    s_cbranch_scc1 WD_48
    s_waitcnt lgkmcnt(0)
    v_readfirstlane_b32 s49, v28
    s_cmp_ge_u32 s49, 1
    s_cbranch_scc0 WF_47
WD_48:
    v_add_u32 v28, v17, v64
    v_lshl_add_u32 v29, v1, 2, v17
    ds_read_b128 v[12:15], v28 offset:256
    ds_read_b32 v16, v29 offset:1280
    s_mul_i32 s75, s45, 335872
    s_add_u32 s75, s75, 6291456
    s_waitcnt lgkmcnt(0)
    s_waitcnt vmcnt(0)
    v_mov_b32 v28, 40
    ds_write_b32 v17, v28 offset:0
    s_cmp_ge_u32 s48, 34
    s_cbranch_scc1 WD_50
WF_49:
    s_sleep 1
    ds_read_b128 v[28:31], v17 offset:16
    s_waitcnt lgkmcnt(0)
    v_min3_u32 v28, v28, v29, v30
    v_min_u32 v28, v28, v31
    s_sub_u32 s46, s46, 1
    s_cselect_b32 s46, 0, s46
    s_cbranch_scc1 WD_50
    v_readfirstlane_b32 s48, v28
    s_cmp_ge_u32 s48, 34
    s_cbranch_scc0 WF_49
WD_50:
    v_mov_b32 v28, 1
    ds_write_b32 v17, v28 offset:92
    s_mov_b32 m0, 108544
    s_nop 0
    buffer_load_dwordx4 v12, s[36:39], s75 offen sc1 lds
    s_mov_b32 m0, 109568
    s_nop 0
    buffer_load_dwordx4 v13, s[36:39], s75 offen sc1 lds
    s_mov_b32 m0, 110592
    s_nop 0
    buffer_load_dwordx4 v14, s[36:39], s75 offen sc1 lds
    s_mov_b32 m0, 111616
    s_nop 0
    buffer_load_dwordx4 v15, s[36:39], s75 offen sc1 lds
    s_mov_b32 m0, 112640
    s_nop 0
    buffer_load_dwordx4 v16, s[36:39], s75 offen sc1 lds
    s_mov_b32 m0, 113664
    s_add_u32 s75, s75, 41984
    buffer_load_dwordx4 v12, s[36:39], s75 offen sc1 lds
    s_mov_b32 m0, 114688
    s_nop 0
    buffer_load_dwordx4 v13, s[36:39], s75 offen sc1 lds
    s_mov_b32 m0, 115712
    s_nop 0
    buffer_load_dwordx4 v14, s[36:39], s75 offen sc1 lds
    s_mov_b32 m0, 116736
    s_nop 0
    buffer_load_dwordx4 v15, s[36:39], s75 offen sc1 lds
    s_mov_b32 m0, 117760
    s_nop 0
    buffer_load_dwordx4 v16, s[36:39], s75 offen sc1 lds
    s_mov_b32 m0, 118784
    s_add_u32 s75, s75, 41984
    buffer_load_dwordx4 v12, s[36:39], s75 offen sc1 lds
    s_mov_b32 m0, 119808
    s_nop 0
    buffer_load_dwordx4 v13, s[36:39], s75 offen sc1 lds
    s_mov_b32 m0, 120832
    s_nop 0
    buffer_load_dwordx4 v14, s[36:39], s75 offen sc1 lds
    s_mov_b32 m0, 121856
    s_nop 0
    buffer_load_dwordx4 v15, s[36:39], s75 offen sc1 lds
    s_mov_b32 m0, 122880
    s_nop 0
    buffer_load_dwordx4 v16, s[36:39], s75 offen sc1 lds
    s_mov_b32 m0, 123904
    s_add_u32 s75, s75, 41984
    buffer_load_dwordx4 v12, s[36:39], s75 offen sc1 lds
    s_mov_b32 m0, 124928
    s_nop 0
    buffer_load_dwordx4 v13, s[36:39], s75 offen sc1 lds
    s_mov_b32 m0, 125952
    s_nop 0
    buffer_load_dwordx4 v14, s[36:39], s75 offen sc1 lds
    s_mov_b32 m0, 126976
    s_nop 0
    buffer_load_dwordx4 v15, s[36:39], s75 offen sc1 lds
    s_mov_b32 m0, 128000
    s_nop 0
    buffer_load_dwordx4 v16, s[36:39], s75 offen sc1 lds
    s_mov_b32 m0, 129024
    s_add_u32 s75, s75, 41984
    buffer_load_dwordx4 v12, s[36:39], s75 offen sc1 lds
    s_mov_b32 m0, 130048
    s_nop 0
    buffer_load_dwordx4 v13, s[36:39], s75 offen sc1 lds
    s_mov_b32 m0, 131072
    s_nop 0
    buffer_load_dwordx4 v14, s[36:39], s75 offen sc1 lds
    s_mov_b32 m0, 132096
    s_nop 0
    buffer_load_dwordx4 v15, s[36:39], s75 offen sc1 lds
    s_mov_b32 m0, 133120
    s_nop 0
    buffer_load_dwordx4 v16, s[36:39], s75 offen sc1 lds
    s_mov_b32 m0, 134144
    s_add_u32 s75, s75, 41984
    buffer_load_dwordx4 v12, s[36:39], s75 offen sc1 lds
    s_mov_b32 m0, 135168
    s_nop 0
    buffer_load_dwordx4 v13, s[36:39], s75 offen sc1 lds
    s_mov_b32 m0, 136192
    s_nop 0
    buffer_load_dwordx4 v14, s[36:39], s75 offen sc1 lds
    s_mov_b32 m0, 137216
    s_nop 0
    buffer_load_dwordx4 v15, s[36:39], s75 offen sc1 lds
    s_mov_b32 m0, 138240
    s_nop 0
    buffer_load_dwordx4 v16, s[36:39], s75 offen sc1 lds
    s_mov_b32 m0, 139264
    s_add_u32 s75, s75, 41984
    buffer_load_dwordx4 v12, s[36:39], s75 offen sc1 lds
    s_mov_b32 m0, 140288
    s_nop 0
    buffer_load_dwordx4 v13, s[36:39], s75 offen sc1 lds
    s_mov_b32 m0, 141312
    s_nop 0
    buffer_load_dwordx4 v14, s[36:39], s75 offen sc1 lds
    s_mov_b32 m0, 142336
    s_nop 0
    buffer_load_dwordx4 v15, s[36:39], s75 offen sc1 lds
    s_mov_b32 m0, 143360
    s_nop 0
    buffer_load_dwordx4 v16, s[36:39], s75 offen sc1 lds
    s_mov_b32 m0, 144384
    s_add_u32 s75, s75, 41984
    buffer_load_dwordx4 v12, s[36:39], s75 offen sc1 lds
    s_mov_b32 m0, 145408
    s_nop 0
    buffer_load_dwordx4 v13, s[36:39], s75 offen sc1 lds
    s_mov_b32 m0, 146432
    s_nop 0
    buffer_load_dwordx4 v14, s[36:39], s75 offen sc1 lds
    s_mov_b32 m0, 147456
    s_nop 0
    buffer_load_dwordx4 v15, s[36:39], s75 offen sc1 lds
    s_mov_b32 m0, 148480
    s_nop 0
    buffer_load_dwordx4 v16, s[36:39], s75 offen sc1 lds
    s_waitcnt vmcnt(30)
    v_mov_b32 v28, 1
    ds_write_b32 v17, v28 offset:88
    s_waitcnt vmcnt(20)
    v_mov_b32 v28, 2
    ds_write_b32 v17, v28 offset:88
    s_waitcnt vmcnt(10)
    v_mov_b32 v28, 3
    ds_write_b32 v17, v28 offset:88
    s_waitcnt vmcnt(0)
    v_mov_b32 v28, 4
    ds_write_b32 v17, v28 offset:88
    s_waitcnt lgkmcnt(0)
    s_endpgm
LS_4:
    s_cmp_ge_u32 s48, s54
    s_cbranch_scc1 WD_52
WF_51:
    s_sleep 1
    ds_read_b128 v[28:31], v17 offset:16
    s_waitcnt lgkmcnt(0)
    v_min3_u32 v28, v28, v29, v30
    v_min_u32 v28, v28, v31
    s_sub_u32 s46, s46, 1
    s_cselect_b32 s46, 0, s46
    s_cbranch_scc1 WD_52
    v_readfirstlane_b32 s48, v28
    s_cmp_ge_u32 s48, s54
    s_cbranch_scc0 WF_51
WD_52:
    s_branch LB_5
LS_11:
    s_cmp_ge_u32 s48, s54
    s_cbranch_scc1 WD_54
WF_53:
    s_sleep 1
    ds_read_b128 v[28:31], v17 offset:16
    s_waitcnt lgkmcnt(0)
    v_min3_u32 v28, v28, v29, v30
    v_min_u32 v28, v28, v31
    s_sub_u32 s46, s46, 1
    s_cselect_b32 s46, 0, s46
    s_cbranch_scc1 WD_54
    v_readfirstlane_b32 s48, v28
    s_cmp_ge_u32 s48, s54
    s_cbranch_scc0 WF_53
WD_54:
    s_branch LB_12
LS_20:
    s_cmp_ge_u32 s48, s54
    s_cbranch_scc1 WD_56
WF_55:
    s_sleep 1
    ds_read_b128 v[28:31], v17 offset:16
    s_waitcnt lgkmcnt(0)
    v_min3_u32 v28, v28, v29, v30
    v_min_u32 v28, v28, v31
    s_sub_u32 s46, s46, 1
    s_cselect_b32 s46, 0, s46
    s_cbranch_scc1 WD_56
    v_readfirstlane_b32 s48, v28
    s_cmp_ge_u32 s48, s54
    s_cbranch_scc0 WF_55
WD_56:
    s_branch LB_21
LS_23:
    s_cmp_ge_u32 s48, s54
    s_cbranch_scc1 WD_58
WF_57:
    s_sleep 1
    ds_read_b128 v[28:31], v17 offset:16
    s_waitcnt lgkmcnt(0)
    v_min3_u32 v28, v28, v29, v30
    v_min_u32 v28, v28, v31
    s_sub_u32 s46, s46, 1
    s_cselect_b32 s46, 0, s46
    s_cbranch_scc1 WD_58
    v_readfirstlane_b32 s48, v28
    s_cmp_ge_u32 s48, s54
    s_cbranch_scc0 WF_57
WD_58:
    s_branch LB_24
LS_36:
    s_cmp_ge_u32 s48, s54
    s_cbranch_scc1 WD_60
WF_59:
    s_sleep 1
    ds_read_b128 v[28:31], v17 offset:16
    s_waitcnt lgkmcnt(0)
    v_min3_u32 v28, v28, v29, v30
    v_min_u32 v28, v28, v31
    s_sub_u32 s46, s46, 1
    s_cselect_b32 s46, 0, s46
    s_cbranch_scc1 WD_60
    v_readfirstlane_b32 s48, v28
    s_cmp_ge_u32 s48, s54
    s_cbranch_scc0 WF_59
WD_60:
    s_branch LB_37
LS_39:
    s_cmp_ge_u32 s48, s54
    s_cbranch_scc1 WD_62
WF_61:
    s_sleep 1
    ds_read_b128 v[28:31], v17 offset:16
    s_waitcnt lgkmcnt(0)
    v_min3_u32 v28, v28, v29, v30
    v_min_u32 v28, v28, v31
    s_sub_u32 s46, s46, 1
    s_cselect_b32 s46, 0, s46
    s_cbranch_scc1 WD_62
    v_readfirstlane_b32 s48, v28
    s_cmp_ge_u32 s48, s54
    s_cbranch_scc0 WF_61
WD_62:
    s_branch LB_40
L_notld:
    s_cmp_ge_u32 s40, 4
    s_cbranch_scc1 L_helper
L_a_main:
    s_lshr_b32 s41, s45, 1
    s_lshl_b32 s41, s41, 3
    s_add_u32 s41, s41, s50
    s_mul_i32 s73, s40, 10240
    s_add_u32 s73, s73, 108544
    v_lshrrev_b32 v30, 4, v1
    s_waitcnt lgkmcnt(0)
    s_setprio 2
    s_load_dwordx2 s[88:89], s[0:1], 32
    s_load_dwordx2 s[92:93], s[0:1], 72
    s_load_dwordx2 s[90:91], s[0:1], 88
    s_mov_b32 s46, 0x200000
    s_mov_b32 s47, 0
    s_mov_b32 s48, 0
    s_mov_b32 s49, 0
    s_mov_b32 s66, -1
    s_mov_b32 s67, 0
    s_mov_b32 s43, s44
    s_and_b32 s72, s43, 1
    v_mov_b32 v17, 161792
    s_waitcnt lgkmcnt(0)
    s_mov_b32 s8, s80
    s_and_b32 s9, s81, 0xffff
    s_mov_b32 s10, 2621440
    s_mov_b32 s11, 0x20000
    s_mov_b32 s12, s82
    s_and_b32 s13, s83, 0xffff
    s_mov_b32 s14, 2457600
    s_mov_b32 s15, 0x20000
    s_mov_b32 s16, s84
    s_and_b32 s17, s85, 0xffff
    s_mov_b32 s18, 25600
    s_mov_b32 s19, 0x20000
    s_mov_b32 s20, s86
    s_and_b32 s21, s87, 0xffff
    s_mov_b32 s22, 819200
    s_mov_b32 s23, 0x20000
    s_mov_b32 s24, s88
    s_and_b32 s25, s89, 0xffff
    s_mov_b32 s26, 2621440
    s_mov_b32 s27, 0x20000
    s_mov_b32 s28, s92
    s_and_b32 s29, s93, 0xffff
    s_mov_b32 s30, 5242880
    s_mov_b32 s31, 0x20000
    s_mov_b32 s36, s90
    s_and_b32 s37, s91, 0xffff
    s_mov_b32 s38, 9437184
    s_mov_b32 s39, 0x20000
    s_mov_b32 s70, 0x3fb8aa3b
    s_mov_b32 s71, 0x3fb8aa3b
    v_and_b32 v29, 15, v1
    v_lshrrev_b32 v28, 1, v29
    v_lshrrev_b32 v31, 1, v30
    v_xor_b32 v28, v28, v31
    v_lshlrev_b32 v28, 4, v28
    v_and_b32 v31, 1, v30
    v_lshlrev_b32 v31, 3, v31
    v_lshl_add_u32 v31, v29, 7, v31
    v_add_u32 v31, s73, v31
    v_xor_b32 v4, 0, v28
    v_add_u32 v4, v4, v31
    v_xor_b32 v5, 32, v28
    v_add_u32 v5, v5, v31
    v_xor_b32 v6, 64, v28
    v_add_u32 v6, v6, v31
    v_xor_b32 v7, 96, v28
    v_add_u32 v7, v7, v31
    v_lshrrev_b32 v28, 2, v29
    v_lshl_add_u32 v28, v30, 2, v28
    v_mul_u32_u24 v28, 160, v28
    v_and_b32 v31, 3, v29
    v_mul_u32_u24 v31, 40, v31
    v_add_u32 v8, v28, v31
    v_add_u32 v9, 40960, v8
    v_lshlrev_b32 v15, 4, v1
    v_lshlrev_b32 v16, 3, v1
    s_lshl_b32 s50, s40, 2
    s_add_u32 s50, s50, 161808
    v_mov_b32 v18, s50
    v_lshlrev_b32 v28, 13, v30
    v_lshl_add_u32 v13, v29, 4, v28
    s_mul_i32 s74, s42, 28
    s_mul_i32 s50, s40, 7
    s_add_u32 s74, s74, s50
    s_lshl_b32 s74, s74, 13
    s_lshl_b32 s50, s41, 8
    s_add_u32 s74, s74, s50
    s_lshl_b32 s75, s41, 2
    s_add_u32 s75, s75, s40
    s_mul_i32 s75, s75, 20480
    s_add_u32 s75, s75, 3145728
    s_mul_i32 s76, s42, 2560
    s_add_u32 s76, s76, s75
    v_lshrrev_b32 v28, 2, v29
    v_mul_u32_u24 v28, 40, v28
    v_mul_u32_u24 v31, 800, v30
    v_add_u32 v28, v28, v31
    v_add_u32 v28, 149504, v28
    v_and_b32 v31, 3, v29
    v_cmp_eq_u32 vcc, v31, v30
    v_mov_b32 v19, 152768
    s_nop 0
    v_cndmask_b32 v19, v19, v28, vcc
    s_mul_i32 s50, s40, 2304
    s_add_u32 s50, s50, 71680
    v_mul_u32_u24 v28, 9216, v30
    v_mul_u32_u24 v31, 144, v29
    v_add3_u32 v20, v28, v31, s50
    v_mul_u32_u24 v12, 80, v1
    v_add_u32 v12, 154752, v12
    s_cmp_eq_u32 s40, 3
    s_cselect_b64 vcc, -1, 0
    v_cndmask_b32 v12, v20, v12, vcc
    s_mul_i32 s50, s40, 9216
    s_add_u32 s50, s50, 71680
    v_lshrrev_b32 v28, 2, v29
    v_lshl_add_u32 v28, v30, 2, v28
    v_mul_u32_u24 v28, 144, v28
    v_and_b32 v31, 3, v29
    v_lshlrev_b32 v31, 3, v31
    v_add3_u32 v21, v28, v31, s50
    s_mul_i32 s50, s40, 1680
    s_add_u32 s50, s50, 154752
    v_mul_u32_u24 v28, 80, v29
    v_lshlrev_b32 v31, 3, v30
    v_add3_u32 v23, v28, v31, s50
    v_min_u32 v28, 14, v29
    v_lshlrev_b32 v28, 4, v28
    v_mul_u32_u24 v31, 240, v30
    v_add3_u32 v22, v28, v31, s50
    v_and_b32 v28, 3, v29
    v_mul_u32_u24 v28, 80, v28
    v_mul_u32_u24 v31, 1680, v30
    v_add_u32 v28, v28, v31
    v_add_u32 v28, 154752, v28
    v_lshrrev_b32 v31, 2, v29
    v_cmp_eq_u32 vcc, v31, v30
    v_mov_b32 v24, 152768
    s_nop 0
    v_cndmask_b32 v24, v24, v28, vcc
    s_cmp_ge_u32 s47, 1
    s_cbranch_scc1 WD_64
WF_63:
    ds_read_b32 v28, v17 offset:0
    s_sub_u32 s46, s46, 1
    s_cselect_b32 s46, 0, s46
    s_cbranch_scc1 WD_64
    s_waitcnt lgkmcnt(0)
    v_readfirstlane_b32 s47, v28
    s_cmp_ge_u32 s47, 1
    s_cbranch_scc0 WF_63
WD_64:
    ds_read_b64 v[32:33], v4 offset:0
    ds_read_b64 v[34:35], v5 offset:0
    ds_read_b64 v[36:37], v6 offset:0
    ds_read_b64 v[38:39], v7 offset:0
    s_cmp_ge_u32 s47, 1
    s_cbranch_scc1 WD_66
WF_65:
    ds_read_b32 v28, v17 offset:0
    s_sub_u32 s46, s46, 1
    s_cselect_b32 s46, 0, s46
    s_cbranch_scc1 WD_66
    s_waitcnt lgkmcnt(0)
    v_readfirstlane_b32 s47, v28
    s_cmp_ge_u32 s47, 1
    s_cbranch_scc0 WF_65
WD_66:
    ds_read_b64_tr_b16 v[132:133], v8 offset:0
    ds_read_b64_tr_b16 v[134:135], v8 offset:2560
    ds_read_b64_tr_b16 v[136:137], v8 offset:8
    ds_read_b64_tr_b16 v[138:139], v8 offset:2568
    ds_read_b64_tr_b16 v[140:141], v8 offset:16
    ds_read_b64_tr_b16 v[142:143], v8 offset:2576
    ds_read_b64_tr_b16 v[144:145], v8 offset:24
    ds_read_b64_tr_b16 v[146:147], v8 offset:2584
    ds_read_b64_tr_b16 v[148:149], v8 offset:32
    ds_read_b64_tr_b16 v[150:151], v8 offset:2592
    ds_read_b64_tr_b16 v[152:153], v8 offset:5120
    s_waitcnt lgkmcnt(14)
    ds_read_b64_tr_b16 v[154:155], v8 offset:7680
    s_waitcnt lgkmcnt(14)
    ds_read_b64_tr_b16 v[156:157], v8 offset:5128
    s_waitcnt lgkmcnt(14)
    ds_read_b64_tr_b16 v[158:159], v8 offset:7688
    s_waitcnt lgkmcnt(10)
    v_mfma_f32_16x16x32_bf16 v[112:115], v[132:135], v[32:35], 0
    ds_read_b64_tr_b16 v[160:161], v8 offset:5136
    ds_read_b64_tr_b16 v[162:163], v8 offset:7696
    v_mfma_f32_16x16x32_bf16 v[116:119], v[136:139], v[32:35], 0
    ds_read_b64_tr_b16 v[164:165], v8 offset:5144
    ds_read_b64_tr_b16 v[166:167], v8 offset:7704
    s_waitcnt lgkmcnt(10)
    v_mfma_f32_16x16x32_bf16 v[120:123], v[140:143], v[32:35], 0
    ds_read_b64_tr_b16 v[168:169], v8 offset:5152
    ds_read_b64_tr_b16 v[170:171], v8 offset:7712
    v_mfma_f32_16x16x32_bf16 v[124:127], v[144:147], v[32:35], 0
    s_cmp_ge_u32 s47, 2
    s_cbranch_scc1 WD_68
WF_67:
    ds_read_b32 v28, v17 offset:0
    s_sub_u32 s46, s46, 1
    s_cselect_b32 s46, 0, s46
    s_cbranch_scc1 WD_68
    s_waitcnt lgkmcnt(0)
    v_readfirstlane_b32 s47, v28
    s_cmp_ge_u32 s47, 2
    s_cbranch_scc0 WF_67
WD_68:
    ds_read_b64 v[40:41], v4 offset:2048
    ds_read_b64 v[42:43], v5 offset:2048
    ds_read_b64 v[44:45], v6 offset:2048
    s_waitcnt lgkmcnt(14)
    ds_read_b64 v[46:47], v7 offset:2048
    s_cmp_ge_u32 s47, 2
    s_cbranch_scc1 WD_70
WF_69:
    ds_read_b32 v28, v17 offset:0
    s_sub_u32 s46, s46, 1
    s_cselect_b32 s46, 0, s46
    s_cbranch_scc1 WD_70
    s_waitcnt lgkmcnt(0)
    v_readfirstlane_b32 s47, v28
    s_cmp_ge_u32 s47, 2
    s_cbranch_scc0 WF_69
WD_70:
    s_waitcnt lgkmcnt(14)
    ds_read_b64_tr_b16 v[132:133], v8 offset:10240
    s_waitcnt lgkmcnt(14)
    ds_read_b64_tr_b16 v[134:135], v8 offset:12800
    s_waitcnt lgkmcnt(14)
    v_mfma_f32_16x16x32_bf16 v[128:131], v[148:151], v[32:35], 0
    ds_read_b64_tr_b16 v[136:137], v8 offset:10248
    s_waitcnt lgkmcnt(14)
    ds_read_b64_tr_b16 v[138:139], v8 offset:12808
    v_mfma_f32_16x16x32_bf16 v[112:115], v[152:155], v[36:39], v[112:115]
    s_waitcnt lgkmcnt(14)
    ds_read_b64_tr_b16 v[140:141], v8 offset:10256
    s_waitcnt lgkmcnt(14)
    ds_read_b64_tr_b16 v[142:143], v8 offset:12816
    s_waitcnt lgkmcnt(14)
    v_mfma_f32_16x16x32_bf16 v[116:119], v[156:159], v[36:39], v[116:119]
    ds_read_b64_tr_b16 v[144:145], v8 offset:10264
    s_waitcnt lgkmcnt(14)
    ds_read_b64_tr_b16 v[146:147], v8 offset:12824
    v_mfma_f32_16x16x32_bf16 v[120:123], v[160:163], v[36:39], v[120:123]
    s_waitcnt lgkmcnt(14)
    ds_read_b64_tr_b16 v[148:149], v8 offset:10272
    s_waitcnt lgkmcnt(14)
    ds_read_b64_tr_b16 v[150:151], v8 offset:12832
    s_waitcnt lgkmcnt(14)
    v_mfma_f32_16x16x32_bf16 v[124:127], v[164:167], v[36:39], v[124:127]
    ds_read_b64_tr_b16 v[152:153], v8 offset:15360
    s_waitcnt lgkmcnt(14)
    ds_read_b64_tr_b16 v[154:155], v8 offset:17920
    v_mfma_f32_16x16x32_bf16 v[128:131], v[168:171], v[36:39], v[128:131]
    v_mov_b32 v29, 1
    s_waitcnt lgkmcnt(14)
    ds_write_b32 v18, v29
    s_waitcnt lgkmcnt(14)
    ds_read_b64_tr_b16 v[156:157], v8 offset:15368
    s_waitcnt lgkmcnt(14)
    ds_read_b64_tr_b16 v[158:159], v8 offset:17928
    s_waitcnt lgkmcnt(11)
    v_mfma_f32_16x16x32_bf16 v[112:115], v[132:135], v[40:43], v[112:115]
    ds_read_b64_tr_b16 v[160:161], v8 offset:15376
    ds_read_b64_tr_b16 v[162:163], v8 offset:17936
    v_mfma_f32_16x16x32_bf16 v[116:119], v[136:139], v[40:43], v[116:119]
    ds_read_b64_tr_b16 v[164:165], v8 offset:15384
    ds_read_b64_tr_b16 v[166:167], v8 offset:17944
    s_waitcnt lgkmcnt(11)
    v_mfma_f32_16x16x32_bf16 v[120:123], v[140:143], v[40:43], v[120:123]
    ds_read_b64_tr_b16 v[168:169], v8 offset:15392
    ds_read_b64_tr_b16 v[170:171], v8 offset:17952
    v_mfma_f32_16x16x32_bf16 v[124:127], v[144:147], v[40:43], v[124:127]
    s_cmp_ge_u32 s47, 3
    s_cbranch_scc1 WD_72
WF_71:
    ds_read_b32 v28, v17 offset:0
    s_sub_u32 s46, s46, 1
    s_cselect_b32 s46, 0, s46
    s_cbranch_scc1 WD_72
    s_waitcnt lgkmcnt(0)
    v_readfirstlane_b32 s47, v28
    s_cmp_ge_u32 s47, 3
    s_cbranch_scc0 WF_71
WD_72:
    ds_read_b64 v[48:49], v4 offset:4096
    ds_read_b64 v[50:51], v5 offset:4096
    s_waitcnt lgkmcnt(14)
    ds_read_b64 v[52:53], v6 offset:4096
    s_waitcnt lgkmcnt(14)
    ds_read_b64 v[54:55], v7 offset:4096
    s_cmp_ge_u32 s47, 3
    s_cbranch_scc1 WD_74
WF_73:
    ds_read_b32 v28, v17 offset:0
    s_sub_u32 s46, s46, 1
    s_cselect_b32 s46, 0, s46
    s_cbranch_scc1 WD_74
    s_waitcnt lgkmcnt(0)
    v_readfirstlane_b32 s47, v28
    s_cmp_ge_u32 s47, 3
    s_cbranch_scc0 WF_73
WD_74:
    s_waitcnt lgkmcnt(14)
    ds_read_b64_tr_b16 v[132:133], v8 offset:20480
    s_waitcnt lgkmcnt(14)
    ds_read_b64_tr_b16 v[134:135], v8 offset:23040
    v_mfma_f32_16x16x32_bf16 v[128:131], v[148:151], v[40:43], v[128:131]
    s_waitcnt lgkmcnt(14)
    ds_read_b64_tr_b16 v[136:137], v8 offset:20488
    s_waitcnt lgkmcnt(14)
    ds_read_b64_tr_b16 v[138:139], v8 offset:23048
    v_mfma_f32_16x16x32_bf16 v[112:115], v[152:155], v[44:47], v[112:115]
    s_waitcnt lgkmcnt(14)
    ds_read_b64_tr_b16 v[140:141], v8 offset:20496
    s_waitcnt lgkmcnt(14)
    ds_read_b64_tr_b16 v[142:143], v8 offset:23056
    s_waitcnt lgkmcnt(14)
    v_mfma_f32_16x16x32_bf16 v[116:119], v[156:159], v[44:47], v[116:119]
    ds_read_b64_tr_b16 v[144:145], v8 offset:20504
    s_waitcnt lgkmcnt(14)
    ds_read_b64_tr_b16 v[146:147], v8 offset:23064
    v_mfma_f32_16x16x32_bf16 v[120:123], v[160:163], v[44:47], v[120:123]
    s_waitcnt lgkmcnt(14)
    ds_read_b64_tr_b16 v[148:149], v8 offset:20512
    s_waitcnt lgkmcnt(14)
    ds_read_b64_tr_b16 v[150:151], v8 offset:23072
    s_waitcnt lgkmcnt(14)
    v_mfma_f32_16x16x32_bf16 v[124:127], v[164:167], v[44:47], v[124:127]
    ds_read_b64_tr_b16 v[152:153], v8 offset:25600
    s_waitcnt lgkmcnt(14)
    ds_read_b64_tr_b16 v[154:155], v8 offset:28160
    v_mfma_f32_16x16x32_bf16 v[128:131], v[168:171], v[44:47], v[128:131]
    v_mov_b32 v29, 2
    s_waitcnt lgkmcnt(14)
    ds_write_b32 v18, v29
    s_waitcnt lgkmcnt(14)
    ds_read_b64_tr_b16 v[156:157], v8 offset:25608
    s_waitcnt lgkmcnt(14)
    ds_read_b64_tr_b16 v[158:159], v8 offset:28168
    s_waitcnt lgkmcnt(11)
    v_mfma_f32_16x16x32_bf16 v[112:115], v[132:135], v[48:51], v[112:115]
    ds_read_b64_tr_b16 v[160:161], v8 offset:25616
    ds_read_b64_tr_b16 v[162:163], v8 offset:28176
    v_mfma_f32_16x16x32_bf16 v[116:119], v[136:139], v[48:51], v[116:119]
    ds_read_b64_tr_b16 v[164:165], v8 offset:25624
    ds_read_b64_tr_b16 v[166:167], v8 offset:28184
    s_waitcnt lgkmcnt(11)
    v_mfma_f32_16x16x32_bf16 v[120:123], v[140:143], v[48:51], v[120:123]
    ds_read_b64_tr_b16 v[168:169], v8 offset:25632
    ds_read_b64_tr_b16 v[170:171], v8 offset:28192
    v_mfma_f32_16x16x32_bf16 v[124:127], v[144:147], v[48:51], v[124:127]
    s_cmp_ge_u32 s47, 4
    s_cbranch_scc1 WD_76
WF_75:
    ds_read_b32 v28, v17 offset:0
    s_sub_u32 s46, s46, 1
    s_cselect_b32 s46, 0, s46
    s_cbranch_scc1 WD_76
    s_waitcnt lgkmcnt(0)
    v_readfirstlane_b32 s47, v28
    s_cmp_ge_u32 s47, 4
    s_cbranch_scc0 WF_75
WD_76:
    ds_read_b64 v[56:57], v4 offset:6144
    ds_read_b64 v[58:59], v5 offset:6144
    s_waitcnt lgkmcnt(14)
    ds_read_b64 v[60:61], v6 offset:6144
    s_waitcnt lgkmcnt(14)
    ds_read_b64 v[62:63], v7 offset:6144
    s_cmp_ge_u32 s47, 4
    s_cbranch_scc1 WD_78
WF_77:
    ds_read_b32 v28, v17 offset:0
    s_sub_u32 s46, s46, 1
    s_cselect_b32 s46, 0, s46
    s_cbranch_scc1 WD_78
    s_waitcnt lgkmcnt(0)
    v_readfirstlane_b32 s47, v28
    s_cmp_ge_u32 s47, 4
    s_cbranch_scc0 WF_77
WD_78:
    s_waitcnt lgkmcnt(14)
    ds_read_b64_tr_b16 v[132:133], v8 offset:30720
    s_waitcnt lgkmcnt(14)
    ds_read_b64_tr_b16 v[134:135], v8 offset:33280
    v_mfma_f32_16x16x32_bf16 v[128:131], v[148:151], v[48:51], v[128:131]
    s_waitcnt lgkmcnt(14)
    ds_read_b64_tr_b16 v[136:137], v8 offset:30728
    s_waitcnt lgkmcnt(14)
    ds_read_b64_tr_b16 v[138:139], v8 offset:33288
    v_mfma_f32_16x16x32_bf16 v[112:115], v[152:155], v[52:55], v[112:115]
    s_waitcnt lgkmcnt(14)
    ds_read_b64_tr_b16 v[140:141], v8 offset:30736
    s_waitcnt lgkmcnt(14)
    ds_read_b64_tr_b16 v[142:143], v8 offset:33296
    s_waitcnt lgkmcnt(14)
    v_mfma_f32_16x16x32_bf16 v[116:119], v[156:159], v[52:55], v[116:119]
    ds_read_b64_tr_b16 v[144:145], v8 offset:30744
    s_waitcnt lgkmcnt(14)
    ds_read_b64_tr_b16 v[146:147], v8 offset:33304
    v_mfma_f32_16x16x32_bf16 v[120:123], v[160:163], v[52:55], v[120:123]
    s_waitcnt lgkmcnt(14)
    ds_read_b64_tr_b16 v[148:149], v8 offset:30752
    s_waitcnt lgkmcnt(14)
    ds_read_b64_tr_b16 v[150:151], v8 offset:33312
    s_waitcnt lgkmcnt(14)
    v_mfma_f32_16x16x32_bf16 v[124:127], v[164:167], v[52:55], v[124:127]
    ds_read_b64_tr_b16 v[152:153], v8 offset:35840
    s_waitcnt lgkmcnt(14)
    ds_read_b64_tr_b16 v[154:155], v8 offset:38400
    v_mfma_f32_16x16x32_bf16 v[128:131], v[168:171], v[52:55], v[128:131]
    v_mov_b32 v29, 3
    s_waitcnt lgkmcnt(14)
    ds_write_b32 v18, v29
    s_waitcnt lgkmcnt(14)
    ds_read_b64_tr_b16 v[156:157], v8 offset:35848
    s_waitcnt lgkmcnt(14)
    ds_read_b64_tr_b16 v[158:159], v8 offset:38408
    s_waitcnt lgkmcnt(11)
    v_mfma_f32_16x16x32_bf16 v[112:115], v[132:135], v[56:59], v[112:115]
    ds_read_b64_tr_b16 v[160:161], v8 offset:35856
    ds_read_b64_tr_b16 v[162:163], v8 offset:38416
    v_mfma_f32_16x16x32_bf16 v[116:119], v[136:139], v[56:59], v[116:119]
    ds_read_b64_tr_b16 v[164:165], v8 offset:35864
    ds_read_b64_tr_b16 v[166:167], v8 offset:38424
    s_waitcnt lgkmcnt(11)
    v_mfma_f32_16x16x32_bf16 v[120:123], v[140:143], v[56:59], v[120:123]
    ds_read_b64_tr_b16 v[168:169], v8 offset:35872
    ds_read_b64_tr_b16 v[170:171], v8 offset:38432
    v_mfma_f32_16x16x32_bf16 v[124:127], v[144:147], v[56:59], v[124:127]
    s_cmp_ge_u32 s47, 5
    s_cbranch_scc1 WD_80
WF_79:
    ds_read_b32 v28, v17 offset:0
    s_sub_u32 s46, s46, 1
    s_cselect_b32 s46, 0, s46
    s_cbranch_scc1 WD_80
    s_waitcnt lgkmcnt(0)
    v_readfirstlane_b32 s47, v28
    s_cmp_ge_u32 s47, 5
    s_cbranch_scc0 WF_79
WD_80:
    ds_read_b64 v[64:65], v4 offset:8192
    ds_read_b64 v[66:67], v5 offset:8192
    s_waitcnt lgkmcnt(14)
    ds_read_b64 v[68:69], v6 offset:8192
    s_waitcnt lgkmcnt(14)
    ds_read_b64 v[70:71], v7 offset:8192
    s_cmp_ge_u32 s47, 5
    s_cbranch_scc1 WD_82
WF_81:
    ds_read_b32 v28, v17 offset:0
    s_sub_u32 s46, s46, 1
    s_cselect_b32 s46, 0, s46
    s_cbranch_scc1 WD_82
    s_waitcnt lgkmcnt(0)
    v_readfirstlane_b32 s47, v28
    s_cmp_ge_u32 s47, 5
    s_cbranch_scc0 WF_81
WD_82:
    s_waitcnt lgkmcnt(14)
    ds_read_b64_tr_b16 v[132:133], v9 offset:0
    s_waitcnt lgkmcnt(14)
    ds_read_b64_tr_b16 v[134:135], v9 offset:2560
    v_mfma_f32_16x16x32_bf16 v[128:131], v[148:151], v[56:59], v[128:131]
    s_waitcnt lgkmcnt(14)
    ds_read_b64_tr_b16 v[136:137], v9 offset:8
    s_waitcnt lgkmcnt(14)
    ds_read_b64_tr_b16 v[138:139], v9 offset:2568
    v_mfma_f32_16x16x32_bf16 v[112:115], v[152:155], v[60:63], v[112:115]
    s_waitcnt lgkmcnt(14)
    ds_read_b64_tr_b16 v[140:141], v9 offset:16
    s_waitcnt lgkmcnt(14)
    ds_read_b64_tr_b16 v[142:143], v9 offset:2576
    s_waitcnt lgkmcnt(14)
    v_mfma_f32_16x16x32_bf16 v[116:119], v[156:159], v[60:63], v[116:119]
    ds_read_b64_tr_b16 v[144:145], v9 offset:24
    s_waitcnt lgkmcnt(14)
    ds_read_b64_tr_b16 v[146:147], v9 offset:2584
    v_mfma_f32_16x16x32_bf16 v[120:123], v[160:163], v[60:63], v[120:123]
    s_waitcnt lgkmcnt(14)
    ds_read_b64_tr_b16 v[148:149], v9 offset:32
    s_waitcnt lgkmcnt(14)
    ds_read_b64_tr_b16 v[150:151], v9 offset:2592
    s_waitcnt lgkmcnt(14)
    v_mfma_f32_16x16x32_bf16 v[124:127], v[164:167], v[60:63], v[124:127]
    ds_read_b64_tr_b16 v[152:153], v9 offset:5120
    s_waitcnt lgkmcnt(14)
    ds_read_b64_tr_b16 v[154:155], v9 offset:7680
    v_mfma_f32_16x16x32_bf16 v[128:131], v[168:171], v[60:63], v[128:131]
    v_mov_b32 v29, 4
    s_waitcnt lgkmcnt(14)
    ds_write_b32 v18, v29
    s_waitcnt lgkmcnt(14)
    ds_read_b64_tr_b16 v[156:157], v9 offset:5128
    s_waitcnt lgkmcnt(14)
    ds_read_b64_tr_b16 v[158:159], v9 offset:7688
    s_waitcnt lgkmcnt(11)
    v_mfma_f32_16x16x32_bf16 v[112:115], v[132:135], v[64:67], v[112:115]
    ds_read_b64_tr_b16 v[160:161], v9 offset:5136
    ds_read_b64_tr_b16 v[162:163], v9 offset:7696
    v_mfma_f32_16x16x32_bf16 v[116:119], v[136:139], v[64:67], v[116:119]
    ds_read_b64_tr_b16 v[164:165], v9 offset:5144
    ds_read_b64_tr_b16 v[166:167], v9 offset:7704
    s_waitcnt lgkmcnt(11)
    v_mfma_f32_16x16x32_bf16 v[120:123], v[140:143], v[64:67], v[120:123]
    ds_read_b64_tr_b16 v[168:169], v9 offset:5152
    ds_read_b64_tr_b16 v[170:171], v9 offset:7712
    v_mfma_f32_16x16x32_bf16 v[124:127], v[144:147], v[64:67], v[124:127]
GT_83:
    ds_read_b64 v[28:29], v17 offset:8
    s_waitcnt lgkmcnt(0)
    v_readfirstlane_b32 s34, v28
    v_readfirstlane_b32 s32, v29
    s_sub_u32 s46, s46, 1
    s_cselect_b32 s46, 0, s46
    s_cbranch_scc1 GD_84
    s_cmp_eq_u32 s32, 0
    s_cbranch_scc1 GT_83
GD_84:
    s_and_b32 s32, s34, 1
    s_mul_i32 s32, s32, 0x10001
    s_mov_b32 s33, 0xfffefffe
    v_mov_b32 v14, s32
    ds_read_b64_tr_b16 v[204:205], v19 offset:0
    ds_read_b64_tr_b16 v[206:207], v19 offset:160
    ds_read_b64_tr_b16 v[208:209], v19 offset:320
    ds_read_b64_tr_b16 v[210:211], v19 offset:480
    ds_read_b64_tr_b16 v[244:245], v19 offset:640
    ds_read_b64_tr_b16 v[212:213], v19 offset:8
    ds_read_b64_tr_b16 v[214:215], v19 offset:168
    ds_read_b64_tr_b16 v[216:217], v19 offset:328
    ds_read_b64_tr_b16 v[218:219], v19 offset:488
    ds_read_b64_tr_b16 v[246:247], v19 offset:648
    ds_read_b64_tr_b16 v[220:221], v19 offset:16
    ds_read_b64_tr_b16 v[222:223], v19 offset:176
    ds_read_b64_tr_b16 v[224:225], v19 offset:336
    ds_read_b64_tr_b16 v[226:227], v19 offset:496
    ds_read_b64_tr_b16 v[248:249], v19 offset:656
    s_waitcnt lgkmcnt(14)
    ds_read_b64_tr_b16 v[228:229], v19 offset:24
    s_waitcnt lgkmcnt(14)
    ds_read_b64_tr_b16 v[230:231], v19 offset:184
    s_waitcnt lgkmcnt(14)
    ds_read_b64_tr_b16 v[232:233], v19 offset:344
    s_waitcnt lgkmcnt(14)
    ds_read_b64_tr_b16 v[234:235], v19 offset:504
    s_waitcnt lgkmcnt(14)
    ds_read_b64_tr_b16 v[250:251], v19 offset:664
    s_waitcnt lgkmcnt(14)
    ds_read_b64_tr_b16 v[236:237], v19 offset:32
    s_waitcnt lgkmcnt(14)
    ds_read_b64_tr_b16 v[238:239], v19 offset:192
    s_waitcnt lgkmcnt(14)
    ds_read_b64_tr_b16 v[240:241], v19 offset:352
    s_waitcnt lgkmcnt(14)
    ds_read_b64_tr_b16 v[242:243], v19 offset:512
    s_waitcnt lgkmcnt(14)
    ds_read_b64_tr_b16 v[252:253], v19 offset:672
    s_cmp_ge_u32 s47, 6
    s_cbranch_scc1 WD_86
WF_85:
    ds_read_b32 v28, v17 offset:0
    s_sub_u32 s46, s46, 1
    s_cselect_b32 s46, 0, s46
    s_cbranch_scc1 WD_86
    s_waitcnt lgkmcnt(0)
    v_readfirstlane_b32 s47, v28
    s_cmp_ge_u32 s47, 6
    s_cbranch_scc0 WF_85
WD_86:
    s_waitcnt lgkmcnt(14)
    ds_read_b64 v[72:73], v4 offset:0
    s_waitcnt lgkmcnt(14)
    ds_read_b64 v[74:75], v5 offset:0
    s_waitcnt lgkmcnt(14)
    ds_read_b64 v[76:77], v6 offset:0
    s_waitcnt lgkmcnt(14)
    ds_read_b64 v[78:79], v7 offset:0
    s_cmp_ge_u32 s47, 6
    s_cbranch_scc1 WD_88
WF_87:
    ds_read_b32 v28, v17 offset:0
    s_sub_u32 s46, s46, 1
    s_cselect_b32 s46, 0, s46
    s_cbranch_scc1 WD_88
    s_waitcnt lgkmcnt(0)
    v_readfirstlane_b32 s47, v28
    s_cmp_ge_u32 s47, 6
    s_cbranch_scc0 WF_87
WD_88:
    s_waitcnt lgkmcnt(14)
    ds_read_b64_tr_b16 v[132:133], v9 offset:10240
    s_waitcnt lgkmcnt(14)
    ds_read_b64_tr_b16 v[134:135], v9 offset:12800
    v_mfma_f32_16x16x32_bf16 v[128:131], v[148:151], v[64:67], v[128:131]
    s_waitcnt lgkmcnt(14)
    ds_read_b64_tr_b16 v[136:137], v9 offset:10248
    s_waitcnt lgkmcnt(14)
    ds_read_b64_tr_b16 v[138:139], v9 offset:12808
    v_mfma_f32_16x16x32_bf16 v[112:115], v[152:155], v[68:71], v[112:115]
    s_waitcnt lgkmcnt(14)
    ds_read_b64_tr_b16 v[140:141], v9 offset:10256
    s_waitcnt lgkmcnt(14)
    ds_read_b64_tr_b16 v[142:143], v9 offset:12816
    v_mfma_f32_16x16x32_bf16 v[116:119], v[156:159], v[68:71], v[116:119]
    s_waitcnt lgkmcnt(14)
    ds_read_b64_tr_b16 v[144:145], v9 offset:10264
    s_waitcnt lgkmcnt(14)
    ds_read_b64_tr_b16 v[146:147], v9 offset:12824
    v_mfma_f32_16x16x32_bf16 v[120:123], v[160:163], v[68:71], v[120:123]
    s_waitcnt lgkmcnt(14)
    ds_read_b64_tr_b16 v[148:149], v9 offset:10272
    s_waitcnt lgkmcnt(14)
    ds_read_b64_tr_b16 v[150:151], v9 offset:12832
    v_mfma_f32_16x16x32_bf16 v[124:127], v[164:167], v[68:71], v[124:127]
    s_waitcnt lgkmcnt(14)
    ds_read_b64_tr_b16 v[152:153], v9 offset:15360
    s_waitcnt lgkmcnt(14)
    ds_read_b64_tr_b16 v[154:155], v9 offset:17920
    v_mfma_f32_16x16x32_bf16 v[128:131], v[168:171], v[68:71], v[128:131]
    v_mov_b32 v29, 5
    s_waitcnt lgkmcnt(14)
    ds_write_b32 v18, v29
    s_waitcnt lgkmcnt(14)
    ds_read_b64_tr_b16 v[156:157], v9 offset:15368
    s_waitcnt lgkmcnt(14)
    ds_read_b64_tr_b16 v[158:159], v9 offset:17928
    s_waitcnt lgkmcnt(11)
    v_mfma_f32_16x16x32_bf16 v[112:115], v[132:135], v[72:75], v[112:115]
    ds_read_b64_tr_b16 v[160:161], v9 offset:15376
    ds_read_b64_tr_b16 v[162:163], v9 offset:17936
    v_mfma_f32_16x16x32_bf16 v[116:119], v[136:139], v[72:75], v[116:119]
    ds_read_b64_tr_b16 v[164:165], v9 offset:15384
    ds_read_b64_tr_b16 v[166:167], v9 offset:17944
    s_waitcnt lgkmcnt(11)
    v_mfma_f32_16x16x32_bf16 v[120:123], v[140:143], v[72:75], v[120:123]
    ds_read_b64_tr_b16 v[168:169], v9 offset:15392
    ds_read_b64_tr_b16 v[170:171], v9 offset:17952
    v_mfma_f32_16x16x32_bf16 v[124:127], v[144:147], v[72:75], v[124:127]
    s_cmp_ge_u32 s47, 7
    s_cbranch_scc1 WD_90
WF_89:
    ds_read_b32 v28, v17 offset:0
    s_sub_u32 s46, s46, 1
    s_cselect_b32 s46, 0, s46
    s_cbranch_scc1 WD_90
    s_waitcnt lgkmcnt(0)
    v_readfirstlane_b32 s47, v28
    s_cmp_ge_u32 s47, 7
    s_cbranch_scc0 WF_89
WD_90:
    ds_read_b64 v[80:81], v4 offset:2048
    ds_read_b64 v[82:83], v5 offset:2048
    s_waitcnt lgkmcnt(14)
    ds_read_b64 v[84:85], v6 offset:2048
    s_waitcnt lgkmcnt(14)
    ds_read_b64 v[86:87], v7 offset:2048
    s_cmp_ge_u32 s47, 7
    s_cbranch_scc1 WD_92
WF_91:
    ds_read_b32 v28, v17 offset:0
    s_sub_u32 s46, s46, 1
    s_cselect_b32 s46, 0, s46
    s_cbranch_scc1 WD_92
    s_waitcnt lgkmcnt(0)
    v_readfirstlane_b32 s47, v28
    s_cmp_ge_u32 s47, 7
    s_cbranch_scc0 WF_91
WD_92:
    s_waitcnt lgkmcnt(14)
    ds_read_b64_tr_b16 v[132:133], v9 offset:20480
    s_waitcnt lgkmcnt(14)
    ds_read_b64_tr_b16 v[134:135], v9 offset:23040
    v_mfma_f32_16x16x32_bf16 v[128:131], v[148:151], v[72:75], v[128:131]
    s_waitcnt lgkmcnt(14)
    ds_read_b64_tr_b16 v[136:137], v9 offset:20488
    s_waitcnt lgkmcnt(14)
    ds_read_b64_tr_b16 v[138:139], v9 offset:23048
    v_mfma_f32_16x16x32_bf16 v[112:115], v[152:155], v[76:79], v[112:115]
    s_waitcnt lgkmcnt(14)
    ds_read_b64_tr_b16 v[140:141], v9 offset:20496
    s_waitcnt lgkmcnt(14)
    ds_read_b64_tr_b16 v[142:143], v9 offset:23056
    s_waitcnt lgkmcnt(14)
    v_mfma_f32_16x16x32_bf16 v[116:119], v[156:159], v[76:79], v[116:119]
    ds_read_b64_tr_b16 v[144:145], v9 offset:20504
    s_waitcnt lgkmcnt(14)
    ds_read_b64_tr_b16 v[146:147], v9 offset:23064
    v_mfma_f32_16x16x32_bf16 v[120:123], v[160:163], v[76:79], v[120:123]
    s_waitcnt lgkmcnt(14)
    ds_read_b64_tr_b16 v[148:149], v9 offset:20512
    s_waitcnt lgkmcnt(14)
    ds_read_b64_tr_b16 v[150:151], v9 offset:23072
    s_waitcnt lgkmcnt(14)
    v_mfma_f32_16x16x32_bf16 v[124:127], v[164:167], v[76:79], v[124:127]
    ds_read_b64_tr_b16 v[152:153], v9 offset:25600
    s_waitcnt lgkmcnt(14)
    ds_read_b64_tr_b16 v[154:155], v9 offset:28160
    v_mfma_f32_16x16x32_bf16 v[128:131], v[168:171], v[76:79], v[128:131]
    v_mov_b32 v29, 6
    s_waitcnt lgkmcnt(14)
    ds_write_b32 v18, v29
    s_waitcnt lgkmcnt(14)
    ds_read_b64_tr_b16 v[156:157], v9 offset:25608
    s_waitcnt lgkmcnt(14)
    ds_read_b64_tr_b16 v[158:159], v9 offset:28168
    s_waitcnt lgkmcnt(11)
    v_mfma_f32_16x16x32_bf16 v[112:115], v[132:135], v[80:83], v[112:115]
    ds_read_b64_tr_b16 v[160:161], v9 offset:25616
    ds_read_b64_tr_b16 v[162:163], v9 offset:28176
    v_mfma_f32_16x16x32_bf16 v[116:119], v[136:139], v[80:83], v[116:119]
    ds_read_b64_tr_b16 v[164:165], v9 offset:25624
    ds_read_b64_tr_b16 v[166:167], v9 offset:28184
    s_waitcnt lgkmcnt(11)
    v_mfma_f32_16x16x32_bf16 v[120:123], v[140:143], v[80:83], v[120:123]
    ds_read_b64_tr_b16 v[168:169], v9 offset:25632
    ds_read_b64_tr_b16 v[170:171], v9 offset:28192
    v_mfma_f32_16x16x32_bf16 v[124:127], v[144:147], v[80:83], v[124:127]
    s_cmp_ge_u32 s47, 8
    s_cbranch_scc1 WD_94
WF_93:
    ds_read_b32 v28, v17 offset:0
    s_sub_u32 s46, s46, 1
    s_cselect_b32 s46, 0, s46
    s_cbranch_scc1 WD_94
    s_waitcnt lgkmcnt(0)
    v_readfirstlane_b32 s47, v28
    s_cmp_ge_u32 s47, 8
    s_cbranch_scc0 WF_93
WD_94:
    ds_read_b64 v[88:89], v4 offset:4096
    ds_read_b64 v[90:91], v5 offset:4096
    s_waitcnt lgkmcnt(14)
    ds_read_b64 v[92:93], v6 offset:4096
    s_waitcnt lgkmcnt(14)
    ds_read_b64 v[94:95], v7 offset:4096
    s_cmp_ge_u32 s47, 8
    s_cbranch_scc1 WD_96
WF_95:
    ds_read_b32 v28, v17 offset:0
    s_sub_u32 s46, s46, 1
    s_cselect_b32 s46, 0, s46
    s_cbranch_scc1 WD_96
    s_waitcnt lgkmcnt(0)
    v_readfirstlane_b32 s47, v28
    s_cmp_ge_u32 s47, 8
    s_cbranch_scc0 WF_95
WD_96:
    s_waitcnt lgkmcnt(14)
    ds_read_b64_tr_b16 v[132:133], v8 offset:0
    s_waitcnt lgkmcnt(14)
    ds_read_b64_tr_b16 v[134:135], v8 offset:2560
    v_mfma_f32_16x16x32_bf16 v[128:131], v[148:151], v[80:83], v[128:131]
    s_waitcnt lgkmcnt(14)
    ds_read_b64_tr_b16 v[136:137], v8 offset:8
    s_waitcnt lgkmcnt(14)
    ds_read_b64_tr_b16 v[138:139], v8 offset:2568
    v_mfma_f32_16x16x32_bf16 v[112:115], v[152:155], v[84:87], v[112:115]
    s_waitcnt lgkmcnt(14)
    ds_read_b64_tr_b16 v[140:141], v8 offset:16
    s_waitcnt lgkmcnt(14)
    ds_read_b64_tr_b16 v[142:143], v8 offset:2576
    s_waitcnt lgkmcnt(14)
    v_mfma_f32_16x16x32_bf16 v[116:119], v[156:159], v[84:87], v[116:119]
    ds_read_b64_tr_b16 v[144:145], v8 offset:24
    s_waitcnt lgkmcnt(14)
    ds_read_b64_tr_b16 v[146:147], v8 offset:2584
    v_mfma_f32_16x16x32_bf16 v[120:123], v[160:163], v[84:87], v[120:123]
    s_waitcnt lgkmcnt(14)
    ds_read_b64_tr_b16 v[148:149], v8 offset:32
    s_waitcnt lgkmcnt(14)
    ds_read_b64_tr_b16 v[150:151], v8 offset:2592
    s_waitcnt lgkmcnt(14)
    v_mfma_f32_16x16x32_bf16 v[124:127], v[164:167], v[84:87], v[124:127]
    ds_read_b64_tr_b16 v[152:153], v8 offset:5120
    s_waitcnt lgkmcnt(14)
    ds_read_b64_tr_b16 v[154:155], v8 offset:7680
    v_mfma_f32_16x16x32_bf16 v[128:131], v[168:171], v[84:87], v[128:131]
    v_mov_b32 v29, 7
    s_waitcnt lgkmcnt(14)
    ds_write_b32 v18, v29
    s_waitcnt lgkmcnt(14)
    ds_read_b64_tr_b16 v[156:157], v8 offset:5128
    s_waitcnt lgkmcnt(14)
    ds_read_b64_tr_b16 v[158:159], v8 offset:7688
    s_waitcnt lgkmcnt(11)
    v_mfma_f32_16x16x32_bf16 v[112:115], v[132:135], v[88:91], v[112:115]
    ds_read_b64_tr_b16 v[160:161], v8 offset:5136
    ds_read_b64_tr_b16 v[162:163], v8 offset:7696
    v_mfma_f32_16x16x32_bf16 v[116:119], v[136:139], v[88:91], v[116:119]
    ds_read_b64_tr_b16 v[164:165], v8 offset:5144
    ds_read_b64_tr_b16 v[166:167], v8 offset:7704
    s_waitcnt lgkmcnt(11)
    v_mfma_f32_16x16x32_bf16 v[120:123], v[140:143], v[88:91], v[120:123]
    ds_read_b64_tr_b16 v[168:169], v8 offset:5152
    ds_read_b64_tr_b16 v[170:171], v8 offset:7712
    v_mfma_f32_16x16x32_bf16 v[124:127], v[144:147], v[88:91], v[124:127]
    s_cmp_ge_u32 s47, 9
    s_cbranch_scc1 WD_98
WF_97:
    ds_read_b32 v28, v17 offset:0
    s_sub_u32 s46, s46, 1
    s_cselect_b32 s46, 0, s46
    s_cbranch_scc1 WD_98
    s_waitcnt lgkmcnt(0)
    v_readfirstlane_b32 s47, v28
    s_cmp_ge_u32 s47, 9
    s_cbranch_scc0 WF_97
WD_98:
    ds_read_b64 v[96:97], v4 offset:6144
    ds_read_b64 v[98:99], v5 offset:6144
    s_waitcnt lgkmcnt(14)
    ds_read_b64 v[100:101], v6 offset:6144
    s_waitcnt lgkmcnt(14)
    ds_read_b64 v[102:103], v7 offset:6144
    s_cmp_ge_u32 s47, 9
    s_cbranch_scc1 WD_100
WF_99:
    ds_read_b32 v28, v17 offset:0
    s_sub_u32 s46, s46, 1
    s_cselect_b32 s46, 0, s46
    s_cbranch_scc1 WD_100
    s_waitcnt lgkmcnt(0)
    v_readfirstlane_b32 s47, v28
    s_cmp_ge_u32 s47, 9
    s_cbranch_scc0 WF_99
WD_100:
    s_waitcnt lgkmcnt(14)
    ds_read_b64_tr_b16 v[132:133], v8 offset:10240
    s_waitcnt lgkmcnt(14)
    ds_read_b64_tr_b16 v[134:135], v8 offset:12800
    v_mfma_f32_16x16x32_bf16 v[128:131], v[148:151], v[88:91], v[128:131]
    s_waitcnt lgkmcnt(14)
    ds_read_b64_tr_b16 v[136:137], v8 offset:10248
    s_waitcnt lgkmcnt(14)
    ds_read_b64_tr_b16 v[138:139], v8 offset:12808
    v_mfma_f32_16x16x32_bf16 v[112:115], v[152:155], v[92:95], v[112:115]
    s_waitcnt lgkmcnt(14)
    ds_read_b64_tr_b16 v[140:141], v8 offset:10256
    s_waitcnt lgkmcnt(14)
    ds_read_b64_tr_b16 v[142:143], v8 offset:12816
    s_waitcnt lgkmcnt(14)
    v_mfma_f32_16x16x32_bf16 v[116:119], v[156:159], v[92:95], v[116:119]
    ds_read_b64_tr_b16 v[144:145], v8 offset:10264
    s_waitcnt lgkmcnt(14)
    ds_read_b64_tr_b16 v[146:147], v8 offset:12824
    v_mfma_f32_16x16x32_bf16 v[120:123], v[160:163], v[92:95], v[120:123]
    s_waitcnt lgkmcnt(14)
    ds_read_b64_tr_b16 v[148:149], v8 offset:10272
    s_waitcnt lgkmcnt(14)
    ds_read_b64_tr_b16 v[150:151], v8 offset:12832
    s_waitcnt lgkmcnt(14)
    v_mfma_f32_16x16x32_bf16 v[124:127], v[164:167], v[92:95], v[124:127]
    ds_read_b64_tr_b16 v[152:153], v8 offset:15360
    s_waitcnt lgkmcnt(14)
    ds_read_b64_tr_b16 v[154:155], v8 offset:17920
    v_mfma_f32_16x16x32_bf16 v[128:131], v[168:171], v[92:95], v[128:131]
    v_mov_b32 v29, 8
    s_waitcnt lgkmcnt(14)
    ds_write_b32 v18, v29
    s_waitcnt lgkmcnt(14)
    ds_read_b64_tr_b16 v[156:157], v8 offset:15368
    s_waitcnt lgkmcnt(14)
    ds_read_b64_tr_b16 v[158:159], v8 offset:17928
    s_waitcnt lgkmcnt(11)
    v_mfma_f32_16x16x32_bf16 v[112:115], v[132:135], v[96:99], v[112:115]
    ds_read_b64_tr_b16 v[160:161], v8 offset:15376
    ds_read_b64_tr_b16 v[162:163], v8 offset:17936
    v_mfma_f32_16x16x32_bf16 v[116:119], v[136:139], v[96:99], v[116:119]
    ds_read_b64_tr_b16 v[164:165], v8 offset:15384
    ds_read_b64_tr_b16 v[166:167], v8 offset:17944
    s_waitcnt lgkmcnt(11)
    v_mfma_f32_16x16x32_bf16 v[120:123], v[140:143], v[96:99], v[120:123]
    ds_read_b64_tr_b16 v[168:169], v8 offset:15392
    ds_read_b64_tr_b16 v[170:171], v8 offset:17952
    v_mfma_f32_16x16x32_bf16 v[124:127], v[144:147], v[96:99], v[124:127]
    s_cmp_ge_u32 s47, 10
    s_cbranch_scc1 WD_102
WF_101:
    ds_read_b32 v28, v17 offset:0
    s_sub_u32 s46, s46, 1
    s_cselect_b32 s46, 0, s46
    s_cbranch_scc1 WD_102
    s_waitcnt lgkmcnt(0)
    v_readfirstlane_b32 s47, v28
    s_cmp_ge_u32 s47, 10
    s_cbranch_scc0 WF_101
WD_102:
    ds_read_b64 v[104:105], v4 offset:8192
    ds_read_b64 v[106:107], v5 offset:8192
    s_waitcnt lgkmcnt(14)
    ds_read_b64 v[108:109], v6 offset:8192
    s_waitcnt lgkmcnt(14)
    ds_read_b64 v[110:111], v7 offset:8192
    s_cmp_ge_u32 s47, 10
    s_cbranch_scc1 WD_104
WF_103:
    ds_read_b32 v28, v17 offset:0
    s_sub_u32 s46, s46, 1
    s_cselect_b32 s46, 0, s46
    s_cbranch_scc1 WD_104
    s_waitcnt lgkmcnt(0)
    v_readfirstlane_b32 s47, v28
    s_cmp_ge_u32 s47, 10
    s_cbranch_scc0 WF_103
WD_104:
    s_waitcnt lgkmcnt(14)
    ds_read_b64_tr_b16 v[132:133], v8 offset:20480
    s_waitcnt lgkmcnt(14)
    ds_read_b64_tr_b16 v[134:135], v8 offset:23040
    v_mfma_f32_16x16x32_bf16 v[128:131], v[148:151], v[96:99], v[128:131]
    s_waitcnt lgkmcnt(14)
    ds_read_b64_tr_b16 v[136:137], v8 offset:20488
    s_waitcnt lgkmcnt(14)
    ds_read_b64_tr_b16 v[138:139], v8 offset:23048
    v_mfma_f32_16x16x32_bf16 v[112:115], v[152:155], v[100:103], v[112:115]
    s_waitcnt lgkmcnt(14)
    ds_read_b64_tr_b16 v[140:141], v8 offset:20496
    s_waitcnt lgkmcnt(14)
    ds_read_b64_tr_b16 v[142:143], v8 offset:23056
    s_waitcnt lgkmcnt(14)
    v_mfma_f32_16x16x32_bf16 v[116:119], v[156:159], v[100:103], v[116:119]
    ds_read_b64_tr_b16 v[144:145], v8 offset:20504
    s_waitcnt lgkmcnt(14)
    ds_read_b64_tr_b16 v[146:147], v8 offset:23064
    v_mfma_f32_16x16x32_bf16 v[120:123], v[160:163], v[100:103], v[120:123]
    s_waitcnt lgkmcnt(14)
    ds_read_b64_tr_b16 v[148:149], v8 offset:20512
    s_waitcnt lgkmcnt(14)
    ds_read_b64_tr_b16 v[150:151], v8 offset:23072
    s_waitcnt lgkmcnt(14)
    v_mfma_f32_16x16x32_bf16 v[124:127], v[164:167], v[100:103], v[124:127]
    ds_read_b64_tr_b16 v[152:153], v8 offset:25600
    s_waitcnt lgkmcnt(14)
    ds_read_b64_tr_b16 v[154:155], v8 offset:28160
    v_mfma_f32_16x16x32_bf16 v[128:131], v[168:171], v[100:103], v[128:131]
    v_mov_b32 v29, 9
    s_waitcnt lgkmcnt(14)
    ds_write_b32 v18, v29
    s_waitcnt lgkmcnt(14)
    ds_read_b64_tr_b16 v[156:157], v8 offset:25608
    s_waitcnt lgkmcnt(14)
    ds_read_b64_tr_b16 v[158:159], v8 offset:28168
    s_waitcnt lgkmcnt(11)
    v_mfma_f32_16x16x32_bf16 v[112:115], v[132:135], v[104:107], v[112:115]
    ds_read_b64_tr_b16 v[160:161], v8 offset:25616
    ds_read_b64_tr_b16 v[162:163], v8 offset:28176
    v_mfma_f32_16x16x32_bf16 v[116:119], v[136:139], v[104:107], v[116:119]
    ds_read_b64_tr_b16 v[164:165], v8 offset:25624
    ds_read_b64_tr_b16 v[166:167], v8 offset:28184
    s_waitcnt lgkmcnt(11)
    v_mfma_f32_16x16x32_bf16 v[120:123], v[140:143], v[104:107], v[120:123]
    ds_read_b64_tr_b16 v[168:169], v8 offset:25632
    ds_read_b64_tr_b16 v[170:171], v8 offset:28192
    v_mfma_f32_16x16x32_bf16 v[124:127], v[144:147], v[104:107], v[124:127]
    s_waitcnt lgkmcnt(9)
    v_mfma_f32_16x16x32_bf16 v[128:131], v[148:151], v[104:107], v[128:131]
    v_mfma_f32_16x16x32_bf16 v[112:115], v[152:155], v[108:111], v[112:115]
    s_waitcnt lgkmcnt(4)
    v_mfma_f32_16x16x32_bf16 v[116:119], v[156:159], v[108:111], v[116:119]
    v_mfma_f32_16x16x32_bf16 v[120:123], v[160:163], v[108:111], v[120:123]
    s_waitcnt lgkmcnt(0)
    v_mfma_f32_16x16x32_bf16 v[124:127], v[164:167], v[108:111], v[124:127]
    v_mfma_f32_16x16x32_bf16 v[128:131], v[168:171], v[108:111], v[128:131]
    s_nop 7
    v_cvt_pk_bf16_f32 v180, v128, v129
    v_cvt_pk_bf16_f32 v181, v130, v131
    v_cvt_pk_bf16_f32 v172, v112, v113
    v_cvt_pk_bf16_f32 v173, v114, v115
    v_mfma_f32_16x16x16_bf16 v[184:187], v[244:245], v[180:181], 0
    v_mfma_f32_16x16x16_bf16 v[188:191], v[246:247], v[180:181], 0
    v_mfma_f32_16x16x16_bf16 v[192:195], v[248:249], v[180:181], 0
    v_mfma_f32_16x16x16_bf16 v[196:199], v[250:251], v[180:181], 0
    v_mfma_f32_16x16x16_bf16 v[200:203], v[252:253], v[180:181], 0
    v_cvt_pk_bf16_f32 v174, v116, v117
    v_cvt_pk_bf16_f32 v175, v118, v119
    v_cvt_pk_bf16_f32 v176, v120, v121
    v_cvt_pk_bf16_f32 v177, v122, v123
    v_cvt_pk_bf16_f32 v178, v124, v125
    v_cvt_pk_bf16_f32 v179, v126, v127
    s_nop 1
    v_mfma_f32_16x16x32_bf16 v[184:187], v[204:207], v[172:175], v[184:187]
    v_mfma_f32_16x16x32_bf16 v[188:191], v[212:215], v[172:175], v[188:191]
    v_mfma_f32_16x16x32_bf16 v[192:195], v[220:223], v[172:175], v[192:195]
    v_mfma_f32_16x16x32_bf16 v[196:199], v[228:231], v[172:175], v[196:199]
    v_mfma_f32_16x16x32_bf16 v[200:203], v[236:239], v[172:175], v[200:203]
    v_mfma_f32_16x16x32_bf16 v[184:187], v[208:211], v[176:179], v[184:187]
    v_mfma_f32_16x16x32_bf16 v[188:191], v[216:219], v[176:179], v[188:191]
    v_mfma_f32_16x16x32_bf16 v[192:195], v[224:227], v[176:179], v[192:195]
    v_mfma_f32_16x16x32_bf16 v[196:199], v[232:235], v[176:179], v[196:199]
    v_mfma_f32_16x16x32_bf16 v[200:203], v[240:243], v[176:179], v[200:203]
    s_nop 3
    ds_write_b128 v12, v[184:187] offset:0
    ds_write_b128 v12, v[188:191] offset:16
    ds_write_b128 v12, v[192:195] offset:32
    ds_write_b128 v12, v[196:199] offset:48
    ds_write_b128 v12, v[200:203] offset:64
    v_mov_b32 v29, 10
    ds_write_b32 v18, v29
    v_mov_b32 v182, 0x3f803f80
    v_mov_b32 v183, 0x3f803f80
    v_and_b32 v26, 3, v1
    v_lshl_add_u32 v26, v26, 2, v17
    v_add_u32 v26, 16, v26
    v_mov_b32 v11, 21
    v_mov_b32 v10, s34
    s_nop 0
    s_mov_b32 s68, 0x001f001f
    s_mov_b32 s69, 0x001f001f
    s_add_u32 s77, s74, 32768
    s_lshl_b32 s54, s42, 2
    s_add_u32 s54, s54, s40
    s_lshl_b32 s54, s54, 9
    s_lshr_b32 s51, s41, 3
    s_lshl_b32 s51, s51, 7
    s_add_u32 s54, s54, s51
    s_and_b32 s51, s41, 7
    s_add_u32 s54, s54, s51
    s_add_u32 s54, s54, 9043968
    v_mov_b32 v25, s54
    s_cmp_ge_u32 s47, 11
    s_cbranch_scc1 WD_106
WF_105:
    ds_read_b32 v28, v17 offset:0
    s_sub_u32 s46, s46, 1
    s_cselect_b32 s46, 0, s46
    s_cbranch_scc1 WD_106
    s_waitcnt lgkmcnt(0)
    v_readfirstlane_b32 s47, v28
    s_cmp_ge_u32 s47, 11
    s_cbranch_scc0 WF_105
WD_106:
    ds_read_b64_tr_b16 v[132:133], v8 offset:30720
    ds_read_b64_tr_b16 v[134:135], v8 offset:33280
    ds_read_b64_tr_b16 v[136:137], v8 offset:30728
    ds_read_b64_tr_b16 v[138:139], v8 offset:33288
    ds_read_b64_tr_b16 v[140:141], v8 offset:30736
    ds_read_b64_tr_b16 v[142:143], v8 offset:33296
    ds_read_b64_tr_b16 v[144:145], v8 offset:30744
    ds_read_b64_tr_b16 v[146:147], v8 offset:33304
    ds_read_b64_tr_b16 v[148:149], v8 offset:30752
    s_waitcnt lgkmcnt(14)
    ds_read_b64_tr_b16 v[150:151], v8 offset:33312
    s_waitcnt lgkmcnt(14)
    ds_read_b64_tr_b16 v[152:153], v8 offset:35840
    s_waitcnt lgkmcnt(14)
    ds_read_b64_tr_b16 v[154:155], v8 offset:38400
    s_waitcnt lgkmcnt(14)
    ds_read_b64_tr_b16 v[156:157], v8 offset:35848
    s_waitcnt lgkmcnt(14)
    ds_read_b64_tr_b16 v[158:159], v8 offset:38408
    s_waitcnt lgkmcnt(10)
    v_mfma_f32_16x16x32_bf16 v[112:115], v[132:135], v[32:35], 0
    ds_read_b64_tr_b16 v[160:161], v8 offset:35856
    ds_read_b64_tr_b16 v[162:163], v8 offset:38416
    v_mfma_f32_16x16x32_bf16 v[116:119], v[136:139], v[32:35], 0
    ds_read_b64_tr_b16 v[164:165], v8 offset:35864
    ds_read_b64_tr_b16 v[166:167], v8 offset:38424
    s_waitcnt lgkmcnt(10)
    v_mfma_f32_16x16x32_bf16 v[120:123], v[140:143], v[32:35], 0
    ds_read_b64_tr_b16 v[168:169], v8 offset:35872
    ds_read_b64_tr_b16 v[170:171], v8 offset:38432
    v_mfma_f32_16x16x32_bf16 v[124:127], v[144:147], v[32:35], 0
    s_cmp_ge_u32 s47, 12
    s_cbranch_scc1 WD_108
WF_107:
    ds_read_b32 v28, v17 offset:0
    s_sub_u32 s46, s46, 1
    s_cselect_b32 s46, 0, s46
    s_cbranch_scc1 WD_108
    s_waitcnt lgkmcnt(0)
    v_readfirstlane_b32 s47, v28
    s_cmp_ge_u32 s47, 12
    s_cbranch_scc0 WF_107
WD_108:
    ds_read_b64_tr_b16 v[132:133], v9 offset:0
    ds_read_b64_tr_b16 v[134:135], v9 offset:2560
    s_waitcnt lgkmcnt(10)
    v_mfma_f32_16x16x32_bf16 v[128:131], v[148:151], v[32:35], 0
    ds_read_b64_tr_b16 v[136:137], v9 offset:8
    ds_read_b64_tr_b16 v[138:139], v9 offset:2568
    v_mfma_f32_16x16x32_bf16 v[112:115], v[152:155], v[36:39], v[112:115]
    ds_read_b64_tr_b16 v[140:141], v9 offset:16
    ds_read_b64_tr_b16 v[142:143], v9 offset:2576
    s_waitcnt lgkmcnt(10)
    v_mfma_f32_16x16x32_bf16 v[116:119], v[156:159], v[36:39], v[116:119]
    ds_read_b64_tr_b16 v[144:145], v9 offset:24
    ds_read_b64_tr_b16 v[146:147], v9 offset:2584
    v_mfma_f32_16x16x32_bf16 v[120:123], v[160:163], v[36:39], v[120:123]
    ds_read_b64_tr_b16 v[148:149], v9 offset:32
    ds_read_b64_tr_b16 v[150:151], v9 offset:2592
    s_waitcnt lgkmcnt(10)
    v_mfma_f32_16x16x32_bf16 v[124:127], v[164:167], v[36:39], v[124:127]
    ds_read_b64_tr_b16 v[152:153], v9 offset:5120
    ds_read_b64_tr_b16 v[154:155], v9 offset:7680
    v_mfma_f32_16x16x32_bf16 v[128:131], v[168:171], v[36:39], v[128:131]
    v_mov_b32 v29, 11
    ds_write_b32 v18, v29
    ds_read_b64_tr_b16 v[156:157], v9 offset:5128
    ds_read_b64_tr_b16 v[158:159], v9 offset:7688
    s_waitcnt lgkmcnt(11)
    v_mfma_f32_16x16x32_bf16 v[112:115], v[132:135], v[40:43], v[112:115]
    ds_read_b64_tr_b16 v[160:161], v9 offset:5136
    ds_read_b64_tr_b16 v[162:163], v9 offset:7696
    v_mfma_f32_16x16x32_bf16 v[116:119], v[136:139], v[40:43], v[116:119]
    ds_read_b64_tr_b16 v[164:165], v9 offset:5144
    ds_read_b64_tr_b16 v[166:167], v9 offset:7704
    s_waitcnt lgkmcnt(11)
    v_mfma_f32_16x16x32_bf16 v[120:123], v[140:143], v[40:43], v[120:123]
    ds_read_b64_tr_b16 v[168:169], v9 offset:5152
    ds_read_b64_tr_b16 v[170:171], v9 offset:7712
    v_mfma_f32_16x16x32_bf16 v[124:127], v[144:147], v[40:43], v[124:127]
    s_cmp_ge_u32 s47, 13
    s_cbranch_scc1 WD_110
WF_109:
    ds_read_b32 v28, v17 offset:0
    s_sub_u32 s46, s46, 1
    s_cselect_b32 s46, 0, s46
    s_cbranch_scc1 WD_110
    s_waitcnt lgkmcnt(0)
    v_readfirstlane_b32 s47, v28
    s_cmp_ge_u32 s47, 13
    s_cbranch_scc0 WF_109
WD_110:
    ds_read_b64_tr_b16 v[132:133], v9 offset:10240
    ds_read_b64_tr_b16 v[134:135], v9 offset:12800
    s_waitcnt lgkmcnt(11)
    v_mfma_f32_16x16x32_bf16 v[128:131], v[148:151], v[40:43], v[128:131]
    ds_read_b64_tr_b16 v[136:137], v9 offset:10248
    ds_read_b64_tr_b16 v[138:139], v9 offset:12808
    v_mfma_f32_16x16x32_bf16 v[112:115], v[152:155], v[44:47], v[112:115]
    ds_read_b64_tr_b16 v[140:141], v9 offset:10256
    ds_read_b64_tr_b16 v[142:143], v9 offset:12816
    s_waitcnt lgkmcnt(10)
    v_mfma_f32_16x16x32_bf16 v[116:119], v[156:159], v[44:47], v[116:119]
    ds_read_b64_tr_b16 v[144:145], v9 offset:10264
    ds_read_b64_tr_b16 v[146:147], v9 offset:12824
    v_mfma_f32_16x16x32_bf16 v[120:123], v[160:163], v[44:47], v[120:123]
    ds_read_b64_tr_b16 v[148:149], v9 offset:10272
    ds_read_b64_tr_b16 v[150:151], v9 offset:12832
    s_waitcnt lgkmcnt(10)
    v_mfma_f32_16x16x32_bf16 v[124:127], v[164:167], v[44:47], v[124:127]
    ds_read_b64_tr_b16 v[152:153], v9 offset:15360
    ds_read_b64_tr_b16 v[154:155], v9 offset:17920
    v_mfma_f32_16x16x32_bf16 v[128:131], v[168:171], v[44:47], v[128:131]
    v_mov_b32 v29, 12
    ds_write_b32 v18, v29
    ds_read_b64_tr_b16 v[156:157], v9 offset:15368
    ds_read_b64_tr_b16 v[158:159], v9 offset:17928
    s_waitcnt lgkmcnt(11)
    v_mfma_f32_16x16x32_bf16 v[112:115], v[132:135], v[48:51], v[112:115]
    ds_read_b64_tr_b16 v[160:161], v9 offset:15376
    ds_read_b64_tr_b16 v[162:163], v9 offset:17936
    v_mfma_f32_16x16x32_bf16 v[116:119], v[136:139], v[48:51], v[116:119]
    ds_read_b64_tr_b16 v[164:165], v9 offset:15384
    ds_read_b64_tr_b16 v[166:167], v9 offset:17944
    s_waitcnt lgkmcnt(11)
    v_mfma_f32_16x16x32_bf16 v[120:123], v[140:143], v[48:51], v[120:123]
    ds_read_b64_tr_b16 v[168:169], v9 offset:15392
    ds_read_b64_tr_b16 v[170:171], v9 offset:17952
    v_mfma_f32_16x16x32_bf16 v[124:127], v[144:147], v[48:51], v[124:127]
    s_cmp_ge_u32 s47, 14
    s_cbranch_scc1 WD_112
WF_111:
    ds_read_b32 v28, v17 offset:0
    s_sub_u32 s46, s46, 1
    s_cselect_b32 s46, 0, s46
    s_cbranch_scc1 WD_112
    s_waitcnt lgkmcnt(0)
    v_readfirstlane_b32 s47, v28
    s_cmp_ge_u32 s47, 14
    s_cbranch_scc0 WF_111
WD_112:
    ds_read_b64_tr_b16 v[132:133], v9 offset:20480
    ds_read_b64_tr_b16 v[134:135], v9 offset:23040
    s_waitcnt lgkmcnt(11)
    v_mfma_f32_16x16x32_bf16 v[128:131], v[148:151], v[48:51], v[128:131]
    ds_read_b64_tr_b16 v[136:137], v9 offset:20488
    ds_read_b64_tr_b16 v[138:139], v9 offset:23048
    v_mfma_f32_16x16x32_bf16 v[112:115], v[152:155], v[52:55], v[112:115]
    ds_read_b64_tr_b16 v[140:141], v9 offset:20496
    ds_read_b64_tr_b16 v[142:143], v9 offset:23056
    s_waitcnt lgkmcnt(10)
    v_mfma_f32_16x16x32_bf16 v[116:119], v[156:159], v[52:55], v[116:119]
    ds_read_b64_tr_b16 v[144:145], v9 offset:20504
    ds_read_b64_tr_b16 v[146:147], v9 offset:23064
    v_mfma_f32_16x16x32_bf16 v[120:123], v[160:163], v[52:55], v[120:123]
    ds_read_b64_tr_b16 v[148:149], v9 offset:20512
    ds_read_b64_tr_b16 v[150:151], v9 offset:23072
    s_waitcnt lgkmcnt(10)
    v_mfma_f32_16x16x32_bf16 v[124:127], v[164:167], v[52:55], v[124:127]
    ds_read_b64_tr_b16 v[152:153], v9 offset:25600
    ds_read_b64_tr_b16 v[154:155], v9 offset:28160
    v_mfma_f32_16x16x32_bf16 v[128:131], v[168:171], v[52:55], v[128:131]
    v_mov_b32 v29, 13
    ds_write_b32 v18, v29
    ds_read_b64_tr_b16 v[156:157], v9 offset:25608
    ds_read_b64_tr_b16 v[158:159], v9 offset:28168
    s_waitcnt lgkmcnt(11)
    v_mfma_f32_16x16x32_bf16 v[112:115], v[132:135], v[56:59], v[112:115]
    ds_read_b64_tr_b16 v[160:161], v9 offset:25616
    ds_read_b64_tr_b16 v[162:163], v9 offset:28176
    v_mfma_f32_16x16x32_bf16 v[116:119], v[136:139], v[56:59], v[116:119]
    ds_read_b64_tr_b16 v[164:165], v9 offset:25624
    ds_read_b64_tr_b16 v[166:167], v9 offset:28184
    s_waitcnt lgkmcnt(11)
    v_mfma_f32_16x16x32_bf16 v[120:123], v[140:143], v[56:59], v[120:123]
    ds_read_b64_tr_b16 v[168:169], v9 offset:25632
    ds_read_b64_tr_b16 v[170:171], v9 offset:28192
    v_mfma_f32_16x16x32_bf16 v[124:127], v[144:147], v[56:59], v[124:127]
    s_cmp_ge_u32 s47, 15
    s_cbranch_scc1 WD_114
WF_113:
    ds_read_b32 v28, v17 offset:0
    s_sub_u32 s46, s46, 1
    s_cselect_b32 s46, 0, s46
    s_cbranch_scc1 WD_114
    s_waitcnt lgkmcnt(0)
    v_readfirstlane_b32 s47, v28
    s_cmp_ge_u32 s47, 15
    s_cbranch_scc0 WF_113
WD_114:
    ds_read_b64_tr_b16 v[132:133], v8 offset:0
    ds_read_b64_tr_b16 v[134:135], v8 offset:2560
    s_waitcnt lgkmcnt(11)
    v_mfma_f32_16x16x32_bf16 v[128:131], v[148:151], v[56:59], v[128:131]
    ds_read_b64_tr_b16 v[136:137], v8 offset:8
    ds_read_b64_tr_b16 v[138:139], v8 offset:2568
    v_mfma_f32_16x16x32_bf16 v[112:115], v[152:155], v[60:63], v[112:115]
    ds_read_b64_tr_b16 v[140:141], v8 offset:16
    ds_read_b64_tr_b16 v[142:143], v8 offset:2576
    s_waitcnt lgkmcnt(10)
    v_mfma_f32_16x16x32_bf16 v[116:119], v[156:159], v[60:63], v[116:119]
    ds_read_b64_tr_b16 v[144:145], v8 offset:24
    ds_read_b64_tr_b16 v[146:147], v8 offset:2584
    v_mfma_f32_16x16x32_bf16 v[120:123], v[160:163], v[60:63], v[120:123]
    ds_read_b64_tr_b16 v[148:149], v8 offset:32
    ds_read_b64_tr_b16 v[150:151], v8 offset:2592
    s_waitcnt lgkmcnt(10)
    v_mfma_f32_16x16x32_bf16 v[124:127], v[164:167], v[60:63], v[124:127]
    ds_read_b64_tr_b16 v[152:153], v8 offset:5120
    ds_read_b64_tr_b16 v[154:155], v8 offset:7680
    v_mfma_f32_16x16x32_bf16 v[128:131], v[168:171], v[60:63], v[128:131]
    v_mov_b32 v29, 14
    ds_write_b32 v18, v29
    ds_read_b64_tr_b16 v[156:157], v8 offset:5128
    ds_read_b64_tr_b16 v[158:159], v8 offset:7688
    s_waitcnt lgkmcnt(11)
    v_mfma_f32_16x16x32_bf16 v[112:115], v[132:135], v[64:67], v[112:115]
    ds_read_b64_tr_b16 v[160:161], v8 offset:5136
    ds_read_b64_tr_b16 v[162:163], v8 offset:7696
    v_mfma_f32_16x16x32_bf16 v[116:119], v[136:139], v[64:67], v[116:119]
    ds_read_b64_tr_b16 v[164:165], v8 offset:5144
    ds_read_b64_tr_b16 v[166:167], v8 offset:7704
    s_waitcnt lgkmcnt(11)
    v_mfma_f32_16x16x32_bf16 v[120:123], v[140:143], v[64:67], v[120:123]
    ds_read_b64_tr_b16 v[168:169], v8 offset:5152
    ds_read_b64_tr_b16 v[170:171], v8 offset:7712
    v_mfma_f32_16x16x32_bf16 v[124:127], v[144:147], v[64:67], v[124:127]
    s_cmp_ge_u32 s47, 16
    s_cbranch_scc1 WD_116
WF_115:
    ds_read_b32 v28, v17 offset:0
    s_sub_u32 s46, s46, 1
    s_cselect_b32 s46, 0, s46
    s_cbranch_scc1 WD_116
    s_waitcnt lgkmcnt(0)
    v_readfirstlane_b32 s47, v28
    s_cmp_ge_u32 s47, 16
    s_cbranch_scc0 WF_115
WD_116:
    ds_read_b64_tr_b16 v[132:133], v8 offset:10240
    ds_read_b64_tr_b16 v[134:135], v8 offset:12800
    s_waitcnt lgkmcnt(11)
    v_mfma_f32_16x16x32_bf16 v[128:131], v[148:151], v[64:67], v[128:131]
    ds_read_b64_tr_b16 v[136:137], v8 offset:10248
    ds_read_b64_tr_b16 v[138:139], v8 offset:12808
    v_mfma_f32_16x16x32_bf16 v[112:115], v[152:155], v[68:71], v[112:115]
    ds_read_b64_tr_b16 v[140:141], v8 offset:10256
    ds_read_b64_tr_b16 v[142:143], v8 offset:12816
    s_waitcnt lgkmcnt(10)
    v_mfma_f32_16x16x32_bf16 v[116:119], v[156:159], v[68:71], v[116:119]
    ds_read_b64_tr_b16 v[144:145], v8 offset:10264
    ds_read_b64_tr_b16 v[146:147], v8 offset:12824
    v_mfma_f32_16x16x32_bf16 v[120:123], v[160:163], v[68:71], v[120:123]
    ds_read_b64_tr_b16 v[148:149], v8 offset:10272
    ds_read_b64_tr_b16 v[150:151], v8 offset:12832
    s_waitcnt lgkmcnt(10)
    v_mfma_f32_16x16x32_bf16 v[124:127], v[164:167], v[68:71], v[124:127]
    ds_read_b64_tr_b16 v[152:153], v8 offset:15360
    ds_read_b64_tr_b16 v[154:155], v8 offset:17920
    v_mfma_f32_16x16x32_bf16 v[128:131], v[168:171], v[68:71], v[128:131]
    v_mov_b32 v29, 15
    ds_write_b32 v18, v29
    ds_read_b64_tr_b16 v[156:157], v8 offset:15368
    ds_read_b64_tr_b16 v[158:159], v8 offset:17928
    s_waitcnt lgkmcnt(11)
    v_mfma_f32_16x16x32_bf16 v[112:115], v[132:135], v[72:75], v[112:115]
    ds_read_b64_tr_b16 v[160:161], v8 offset:15376
    ds_read_b64_tr_b16 v[162:163], v8 offset:17936
    v_mfma_f32_16x16x32_bf16 v[116:119], v[136:139], v[72:75], v[116:119]
    ds_read_b64_tr_b16 v[164:165], v8 offset:15384
    ds_read_b64_tr_b16 v[166:167], v8 offset:17944
    s_waitcnt lgkmcnt(11)
    v_mfma_f32_16x16x32_bf16 v[120:123], v[140:143], v[72:75], v[120:123]
    ds_read_b64_tr_b16 v[168:169], v8 offset:15392
    ds_read_b64_tr_b16 v[170:171], v8 offset:17952
    v_mfma_f32_16x16x32_bf16 v[124:127], v[144:147], v[72:75], v[124:127]
    s_cmp_ge_u32 s47, 17
    s_cbranch_scc1 WD_118
WF_117:
    ds_read_b32 v28, v17 offset:0
    s_sub_u32 s46, s46, 1
    s_cselect_b32 s46, 0, s46
    s_cbranch_scc1 WD_118
    s_waitcnt lgkmcnt(0)
    v_readfirstlane_b32 s47, v28
    s_cmp_ge_u32 s47, 17
    s_cbranch_scc0 WF_117
WD_118:
    ds_read_b64_tr_b16 v[132:133], v8 offset:20480
    ds_read_b64_tr_b16 v[134:135], v8 offset:23040
    s_waitcnt lgkmcnt(11)
    v_mfma_f32_16x16x32_bf16 v[128:131], v[148:151], v[72:75], v[128:131]
    ds_read_b64_tr_b16 v[136:137], v8 offset:20488
    ds_read_b64_tr_b16 v[138:139], v8 offset:23048
    v_mfma_f32_16x16x32_bf16 v[112:115], v[152:155], v[76:79], v[112:115]
    ds_read_b64_tr_b16 v[140:141], v8 offset:20496
    ds_read_b64_tr_b16 v[142:143], v8 offset:23056
    s_waitcnt lgkmcnt(10)
    v_mfma_f32_16x16x32_bf16 v[116:119], v[156:159], v[76:79], v[116:119]
    ds_read_b64_tr_b16 v[144:145], v8 offset:20504
    ds_read_b64_tr_b16 v[146:147], v8 offset:23064
    v_mfma_f32_16x16x32_bf16 v[120:123], v[160:163], v[76:79], v[120:123]
    ds_read_b64_tr_b16 v[148:149], v8 offset:20512
    ds_read_b64_tr_b16 v[150:151], v8 offset:23072
    s_waitcnt lgkmcnt(10)
    v_mfma_f32_16x16x32_bf16 v[124:127], v[164:167], v[76:79], v[124:127]
    ds_read_b64_tr_b16 v[152:153], v8 offset:25600
    ds_read_b64_tr_b16 v[154:155], v8 offset:28160
    v_mfma_f32_16x16x32_bf16 v[128:131], v[168:171], v[76:79], v[128:131]
    v_mov_b32 v29, 16
    ds_write_b32 v18, v29
    ds_read_b64_tr_b16 v[156:157], v8 offset:25608
    ds_read_b64_tr_b16 v[158:159], v8 offset:28168
    s_waitcnt lgkmcnt(11)
    v_mfma_f32_16x16x32_bf16 v[112:115], v[132:135], v[80:83], v[112:115]
    ds_read_b64_tr_b16 v[160:161], v8 offset:25616
    ds_read_b64_tr_b16 v[162:163], v8 offset:28176
    v_mfma_f32_16x16x32_bf16 v[116:119], v[136:139], v[80:83], v[116:119]
    ds_read_b64_tr_b16 v[164:165], v8 offset:25624
    ds_read_b64_tr_b16 v[166:167], v8 offset:28184
    s_waitcnt lgkmcnt(11)
    v_mfma_f32_16x16x32_bf16 v[120:123], v[140:143], v[80:83], v[120:123]
    ds_read_b64_tr_b16 v[168:169], v8 offset:25632
    ds_read_b64_tr_b16 v[170:171], v8 offset:28192
    v_mfma_f32_16x16x32_bf16 v[124:127], v[144:147], v[80:83], v[124:127]
    s_cmp_ge_u32 s47, 18
    s_cbranch_scc1 WD_120
WF_119:
    ds_read_b32 v28, v17 offset:0
    s_sub_u32 s46, s46, 1
    s_cselect_b32 s46, 0, s46
    s_cbranch_scc1 WD_120
    s_waitcnt lgkmcnt(0)
    v_readfirstlane_b32 s47, v28
    s_cmp_ge_u32 s47, 18
    s_cbranch_scc0 WF_119
WD_120:
    ds_read_b64_tr_b16 v[132:133], v8 offset:30720
    ds_read_b64_tr_b16 v[134:135], v8 offset:33280
    s_waitcnt lgkmcnt(11)
    v_mfma_f32_16x16x32_bf16 v[128:131], v[148:151], v[80:83], v[128:131]
    ds_read_b64_tr_b16 v[136:137], v8 offset:30728
    ds_read_b64_tr_b16 v[138:139], v8 offset:33288
    v_mfma_f32_16x16x32_bf16 v[112:115], v[152:155], v[84:87], v[112:115]
    ds_read_b64_tr_b16 v[140:141], v8 offset:30736
    ds_read_b64_tr_b16 v[142:143], v8 offset:33296
    s_waitcnt lgkmcnt(10)
    v_mfma_f32_16x16x32_bf16 v[116:119], v[156:159], v[84:87], v[116:119]
    ds_read_b64_tr_b16 v[144:145], v8 offset:30744
    ds_read_b64_tr_b16 v[146:147], v8 offset:33304
    v_mfma_f32_16x16x32_bf16 v[120:123], v[160:163], v[84:87], v[120:123]
    ds_read_b64_tr_b16 v[148:149], v8 offset:30752
    ds_read_b64_tr_b16 v[150:151], v8 offset:33312
    s_waitcnt lgkmcnt(10)
    v_mfma_f32_16x16x32_bf16 v[124:127], v[164:167], v[84:87], v[124:127]
    ds_read_b64_tr_b16 v[152:153], v8 offset:35840
    ds_read_b64_tr_b16 v[154:155], v8 offset:38400
    v_mfma_f32_16x16x32_bf16 v[128:131], v[168:171], v[84:87], v[128:131]
    v_mov_b32 v29, 17
    ds_write_b32 v18, v29
    ds_read_b64_tr_b16 v[156:157], v8 offset:35848
    ds_read_b64_tr_b16 v[158:159], v8 offset:38408
    s_waitcnt lgkmcnt(11)
    v_mfma_f32_16x16x32_bf16 v[112:115], v[132:135], v[88:91], v[112:115]
    ds_read_b64_tr_b16 v[160:161], v8 offset:35856
    ds_read_b64_tr_b16 v[162:163], v8 offset:38416
    v_mfma_f32_16x16x32_bf16 v[116:119], v[136:139], v[88:91], v[116:119]
    ds_read_b64_tr_b16 v[164:165], v8 offset:35864
    ds_read_b64_tr_b16 v[166:167], v8 offset:38424
    s_waitcnt lgkmcnt(11)
    v_mfma_f32_16x16x32_bf16 v[120:123], v[140:143], v[88:91], v[120:123]
    ds_read_b64_tr_b16 v[168:169], v8 offset:35872
    ds_read_b64_tr_b16 v[170:171], v8 offset:38432
    v_mfma_f32_16x16x32_bf16 v[124:127], v[144:147], v[88:91], v[124:127]
    s_cmp_ge_u32 s47, 19
    s_cbranch_scc1 WD_122
WF_121:
    ds_read_b32 v28, v17 offset:0
    s_sub_u32 s46, s46, 1
    s_cselect_b32 s46, 0, s46
    s_cbranch_scc1 WD_122
    s_waitcnt lgkmcnt(0)
    v_readfirstlane_b32 s47, v28
    s_cmp_ge_u32 s47, 19
    s_cbranch_scc0 WF_121
WD_122:
    ds_read_b64_tr_b16 v[132:133], v9 offset:0
    ds_read_b64_tr_b16 v[134:135], v9 offset:2560
    s_waitcnt lgkmcnt(11)
    v_mfma_f32_16x16x32_bf16 v[128:131], v[148:151], v[88:91], v[128:131]
    ds_read_b64_tr_b16 v[136:137], v9 offset:8
    ds_read_b64_tr_b16 v[138:139], v9 offset:2568
    v_mfma_f32_16x16x32_bf16 v[112:115], v[152:155], v[92:95], v[112:115]
    ds_read_b64_tr_b16 v[140:141], v9 offset:16
    ds_read_b64_tr_b16 v[142:143], v9 offset:2576
    s_waitcnt lgkmcnt(10)
    v_mfma_f32_16x16x32_bf16 v[116:119], v[156:159], v[92:95], v[116:119]
    ds_read_b64_tr_b16 v[144:145], v9 offset:24
    ds_read_b64_tr_b16 v[146:147], v9 offset:2584
    v_mfma_f32_16x16x32_bf16 v[120:123], v[160:163], v[92:95], v[120:123]
    ds_read_b64_tr_b16 v[148:149], v9 offset:32
    ds_read_b64_tr_b16 v[150:151], v9 offset:2592
    s_waitcnt lgkmcnt(10)
    v_mfma_f32_16x16x32_bf16 v[124:127], v[164:167], v[92:95], v[124:127]
    ds_read_b64_tr_b16 v[152:153], v9 offset:5120
    ds_read_b64_tr_b16 v[154:155], v9 offset:7680
    v_mfma_f32_16x16x32_bf16 v[128:131], v[168:171], v[92:95], v[128:131]
    v_mov_b32 v29, 18
    ds_write_b32 v18, v29
    ds_read_b64_tr_b16 v[156:157], v9 offset:5128
    ds_read_b64_tr_b16 v[158:159], v9 offset:7688
    s_waitcnt lgkmcnt(11)
    v_mfma_f32_16x16x32_bf16 v[112:115], v[132:135], v[96:99], v[112:115]
    ds_read_b64_tr_b16 v[160:161], v9 offset:5136
    ds_read_b64_tr_b16 v[162:163], v9 offset:7696
    v_mfma_f32_16x16x32_bf16 v[116:119], v[136:139], v[96:99], v[116:119]
    ds_read_b64_tr_b16 v[164:165], v9 offset:5144
    ds_read_b64_tr_b16 v[166:167], v9 offset:7704
    s_waitcnt lgkmcnt(11)
    v_mfma_f32_16x16x32_bf16 v[120:123], v[140:143], v[96:99], v[120:123]
    ds_read_b64_tr_b16 v[168:169], v9 offset:5152
    ds_read_b64_tr_b16 v[170:171], v9 offset:7712
    v_mfma_f32_16x16x32_bf16 v[124:127], v[144:147], v[96:99], v[124:127]
    s_cmp_ge_u32 s47, 20
    s_cbranch_scc1 WD_124
WF_123:
    ds_read_b32 v28, v17 offset:0
    s_sub_u32 s46, s46, 1
    s_cselect_b32 s46, 0, s46
    s_cbranch_scc1 WD_124
    s_waitcnt lgkmcnt(0)
    v_readfirstlane_b32 s47, v28
    s_cmp_ge_u32 s47, 20
    s_cbranch_scc0 WF_123
WD_124:
    ds_read_b64_tr_b16 v[132:133], v9 offset:10240
    ds_read_b64_tr_b16 v[134:135], v9 offset:12800
    s_waitcnt lgkmcnt(11)
    v_mfma_f32_16x16x32_bf16 v[128:131], v[148:151], v[96:99], v[128:131]
    ds_read_b64_tr_b16 v[136:137], v9 offset:10248
    ds_read_b64_tr_b16 v[138:139], v9 offset:12808
    v_mfma_f32_16x16x32_bf16 v[112:115], v[152:155], v[100:103], v[112:115]
    ds_read_b64_tr_b16 v[140:141], v9 offset:10256
    ds_read_b64_tr_b16 v[142:143], v9 offset:12816
    s_waitcnt lgkmcnt(10)
    v_mfma_f32_16x16x32_bf16 v[116:119], v[156:159], v[100:103], v[116:119]
    ds_read_b64_tr_b16 v[144:145], v9 offset:10264
    ds_read_b64_tr_b16 v[146:147], v9 offset:12824
    v_mfma_f32_16x16x32_bf16 v[120:123], v[160:163], v[100:103], v[120:123]
    ds_read_b64_tr_b16 v[148:149], v9 offset:10272
    ds_read_b64_tr_b16 v[150:151], v9 offset:12832
    s_waitcnt lgkmcnt(10)
    v_mfma_f32_16x16x32_bf16 v[124:127], v[164:167], v[100:103], v[124:127]
    ds_read_b64_tr_b16 v[152:153], v9 offset:15360
    ds_read_b64_tr_b16 v[154:155], v9 offset:17920
    v_mfma_f32_16x16x32_bf16 v[128:131], v[168:171], v[100:103], v[128:131]
    v_mov_b32 v29, 19
    ds_write_b32 v18, v29
    ds_read_b64_tr_b16 v[156:157], v9 offset:15368
    ds_read_b64_tr_b16 v[158:159], v9 offset:17928
    s_waitcnt lgkmcnt(11)
    v_mfma_f32_16x16x32_bf16 v[112:115], v[132:135], v[104:107], v[112:115]
    ds_read_b64_tr_b16 v[160:161], v9 offset:15376
    ds_read_b64_tr_b16 v[162:163], v9 offset:17936
    v_mfma_f32_16x16x32_bf16 v[116:119], v[136:139], v[104:107], v[116:119]
    ds_read_b64_tr_b16 v[164:165], v9 offset:15384
    ds_read_b64_tr_b16 v[166:167], v9 offset:17944
    s_waitcnt lgkmcnt(11)
    v_mfma_f32_16x16x32_bf16 v[120:123], v[140:143], v[104:107], v[120:123]
    s_cmp_ge_u32 s49, 2
    s_cbranch_scc1 WD_126
WF_125:
    ds_read_b128 v[28:31], v17 offset:64
    s_waitcnt lgkmcnt(0)
    v_min3_u32 v28, v28, v29, v30
    v_min_u32 v28, v28, v31
    s_sub_u32 s46, s46, 1
    s_cselect_b32 s46, 0, s46
    s_cbranch_scc1 WD_126
    v_readfirstlane_b32 s49, v28
    s_cmp_ge_u32 s49, 2
    s_cbranch_scc0 WF_125
WD_126:
    s_mov_b32 s49, 0
    ds_read_b64_tr_b16 v[184:185], v21 offset:0
    ds_read_b64_tr_b16 v[186:187], v21 offset:2304
    ds_read_b64_tr_b16 v[188:189], v21 offset:32
    ds_read_b64_tr_b16 v[190:191], v21 offset:2336
    s_waitcnt lgkmcnt(14)
    ds_read_b64_tr_b16 v[192:193], v21 offset:64
    s_waitcnt lgkmcnt(14)
    ds_read_b64_tr_b16 v[194:195], v21 offset:2368
    s_waitcnt lgkmcnt(14)
    ds_read_b64_tr_b16 v[196:197], v21 offset:4608
    s_waitcnt lgkmcnt(14)
    ds_read_b64_tr_b16 v[198:199], v21 offset:6912
    s_waitcnt lgkmcnt(14)
    ds_read_b64_tr_b16 v[200:201], v21 offset:4640
    s_waitcnt lgkmcnt(14)
    ds_read_b64_tr_b16 v[202:203], v21 offset:6944
    s_waitcnt lgkmcnt(14)
    ds_read_b64_tr_b16 v[204:205], v21 offset:4672
    s_waitcnt lgkmcnt(14)
    ds_read_b64_tr_b16 v[206:207], v21 offset:6976
    s_waitcnt lgkmcnt(14)
    ds_read_b64_tr_b16 v[168:169], v9 offset:15392
    s_waitcnt lgkmcnt(14)
    ds_read_b64_tr_b16 v[170:171], v9 offset:17952
    v_mfma_f32_16x16x32_bf16 v[124:127], v[144:147], v[104:107], v[124:127]
    v_mfma_f32_16x16x32_bf16 v[128:131], v[148:151], v[104:107], v[128:131]
    v_mfma_f32_16x16x32_bf16 v[112:115], v[152:155], v[108:111], v[112:115]
    v_mfma_f32_16x16x32_bf16 v[116:119], v[156:159], v[108:111], v[116:119]
    v_mfma_f32_16x16x32_bf16 v[120:123], v[160:163], v[108:111], v[120:123]
    s_waitcnt lgkmcnt(0)
    v_mfma_f32_16x16x32_bf16 v[124:127], v[164:167], v[108:111], v[124:127]
    v_mfma_f32_16x16x32_bf16 v[128:131], v[168:171], v[108:111], v[128:131]
    s_nop 3
    v_cvt_pk_bf16_f32 v172, v112, v113
    v_cvt_pk_bf16_f32 v173, v114, v115
    v_cvt_pk_bf16_f32 v174, v116, v117
    v_cvt_pk_bf16_f32 v175, v118, v119
    ds_write_b128 v20, v[172:175] offset:80
    v_cvt_pk_bf16_f32 v176, v120, v121
    v_cvt_pk_bf16_f32 v177, v122, v123
    v_cvt_pk_bf16_f32 v178, v124, v125
    v_cvt_pk_bf16_f32 v179, v126, v127
    ds_write_b128 v20, v[176:179] offset:96
    v_cvt_pk_bf16_f32 v180, v128, v129
    v_cvt_pk_bf16_f32 v181, v130, v131
    ds_write_b128 v20, v[180:183] offset:112
    ds_write_b32 v18, v11
SY_127:
    ds_read_b32 v28, v26
    s_sub_u32 s46, s46, 1
    s_cselect_b32 s46, 0, s46
    s_cbranch_scc1 SD_128
    s_waitcnt lgkmcnt(0)
    v_cmp_gt_u32 vcc, 21, v28
    s_cbranch_vccnz SY_127
SD_128:
    ds_read_b64_tr_b16 v[132:133], v21 offset:80
    ds_read_b64_tr_b16 v[134:135], v21 offset:2384
    ds_read_b64_tr_b16 v[136:137], v21 offset:112
    ds_read_b64_tr_b16 v[138:139], v21 offset:2416
    ds_read_b64_tr_b16 v[140:141], v21 offset:4688
    ds_read_b64_tr_b16 v[142:143], v21 offset:6992
    ds_read_b64_tr_b16 v[144:145], v21 offset:4720
    ds_read_b64_tr_b16 v[146:147], v21 offset:7024
    s_waitcnt lgkmcnt(6)
    v_mfma_f32_16x16x32_bf16 v[208:211], v[184:187], v[132:135], 0
    v_mfma_f32_16x16x32_bf16 v[216:219], v[188:191], v[132:135], 0
    v_mfma_f32_16x16x32_bf16 v[224:227], v[192:195], v[132:135], 0
    s_waitcnt lgkmcnt(4)
    v_mfma_f32_16x16x32_bf16 v[212:215], v[184:187], v[136:139], 0
    v_mfma_f32_16x16x32_bf16 v[220:223], v[188:191], v[136:139], 0
    v_mfma_f32_16x16x32_bf16 v[228:231], v[192:195], v[136:139], 0
    s_waitcnt lgkmcnt(2)
    v_mfma_f32_16x16x32_bf16 v[208:211], v[196:199], v[140:143], v[208:211]
    v_mfma_f32_16x16x32_bf16 v[216:219], v[200:203], v[140:143], v[216:219]
    v_mfma_f32_16x16x32_bf16 v[224:227], v[204:207], v[140:143], v[224:227]
    s_waitcnt lgkmcnt(0)
    v_mfma_f32_16x16x32_bf16 v[212:215], v[196:199], v[144:147], v[212:215]
    v_mfma_f32_16x16x32_bf16 v[220:223], v[200:203], v[144:147], v[220:223]
    v_mfma_f32_16x16x32_bf16 v[228:231], v[204:207], v[144:147], v[228:231]
    s_nop 4
    v_cvt_pk_bf16_f32 v148, v208, v209
    v_cvt_pk_bf16_f32 v149, v210, v211
    v_cvt_pk_bf16_f32 v152, v216, v217
    v_cvt_pk_bf16_f32 v153, v218, v219
    v_cvt_pk_bf16_f32 v156, v224, v225
    v_cvt_pk_bf16_f32 v157, v226, v227
    ds_write_b64 v23, v[148:149] offset:0
    ds_write_b64 v23, v[152:153] offset:32
    s_mov_b64 exec, s[66:67]
    ds_write_b64 v23, v[156:157] offset:64
    s_mov_b64 exec, -1
    v_cvt_pk_bf16_f32 v150, v212, v213
    v_cvt_pk_bf16_f32 v151, v214, v215
    v_cvt_pk_bf16_f32 v154, v220, v221
    v_cvt_pk_bf16_f32 v155, v222, v223
    v_cvt_pk_bf16_f32 v158, v228, v229
    v_cvt_pk_bf16_f32 v159, v230, v231
    s_mov_b64 exec, s[68:69]
    ds_write_b64 v23, v[150:151] offset:1280
    ds_write_b64 v23, v[154:155] offset:1312
    s_mov_b32 exec_hi, 0
    ds_write_b64 v23, v[158:159] offset:1344
    s_mov_b64 exec, -1
    ds_read_b128 v[208:211], v22
    ds_read_b128 v[212:215], v22 offset:960
    s_mov_b32 s68, -1
    s_mov_b32 s69, 0xffff
    s_waitcnt lgkmcnt(1)
    v_and_or_b32 v208, v208, s33, v14
    v_and_or_b32 v209, v209, s33, v14
    v_and_or_b32 v210, v210, s33, v14
    v_and_or_b32 v211, v211, s33, v14
    buffer_store_dwordx4 v[208:211], v13, s[36:39], s74 offen sc1
    s_waitcnt lgkmcnt(0)
    v_and_or_b32 v212, v212, s33, v14
    v_and_or_b32 v213, v213, s33, v14
    v_and_or_b32 v214, v214, s33, v14
    v_and_or_b32 v215, v215, s33, v14
    s_mov_b64 exec, s[68:69]
    buffer_store_dwordx4 v[212:215], v13, s[36:39], s77 offen sc1
    s_mov_b64 exec, 1
    buffer_store_byte v10, v25, s[36:39], 0 offen sc1
    s_mov_b64 exec, -1
    v_mov_b32 v30, 22
    ds_write_b32 v18, v30
    s_cmp_ge_u32 s47, 21
    s_cbranch_scc1 WD_130
WF_129:
    ds_read_b32 v28, v17 offset:0
    s_sub_u32 s46, s46, 1
    s_cselect_b32 s46, 0, s46
    s_cbranch_scc1 WD_130
    s_waitcnt lgkmcnt(0)
    v_readfirstlane_b32 s47, v28
    s_cmp_ge_u32 s47, 21
    s_cbranch_scc0 WF_129
WD_130:
    ds_read_b64_tr_b16 v[132:133], v9 offset:20480
    ds_read_b64_tr_b16 v[134:135], v9 offset:23040
    ds_read_b64_tr_b16 v[136:137], v9 offset:20488
    ds_read_b64_tr_b16 v[138:139], v9 offset:23048
    ds_read_b64_tr_b16 v[140:141], v9 offset:20496
    ds_read_b64_tr_b16 v[142:143], v9 offset:23056
    ds_read_b64_tr_b16 v[144:145], v9 offset:20504
    ds_read_b64_tr_b16 v[146:147], v9 offset:23064
    ds_read_b64_tr_b16 v[148:149], v9 offset:20512
    ds_read_b64_tr_b16 v[150:151], v9 offset:23072
    ds_read_b64_tr_b16 v[152:153], v9 offset:25600
    ds_read_b64_tr_b16 v[154:155], v9 offset:28160
    ds_read_b64_tr_b16 v[156:157], v9 offset:25608
    ds_read_b64_tr_b16 v[158:159], v9 offset:28168
    s_waitcnt lgkmcnt(10)
    v_mfma_f32_16x16x32_bf16 v[112:115], v[132:135], v[32:35], 0
    ds_read_b64_tr_b16 v[160:161], v9 offset:25616
    ds_read_b64_tr_b16 v[162:163], v9 offset:28176
    v_mfma_f32_16x16x32_bf16 v[116:119], v[136:139], v[32:35], 0
    ds_read_b64_tr_b16 v[164:165], v9 offset:25624
    ds_read_b64_tr_b16 v[166:167], v9 offset:28184
    s_waitcnt lgkmcnt(10)
    v_mfma_f32_16x16x32_bf16 v[120:123], v[140:143], v[32:35], 0
    ds_read_b64_tr_b16 v[168:169], v9 offset:25632
    ds_read_b64_tr_b16 v[170:171], v9 offset:28192
    v_mfma_f32_16x16x32_bf16 v[124:127], v[144:147], v[32:35], 0
    s_cmp_ge_u32 s47, 22
    s_cbranch_scc1 WD_132
WF_131:
    ds_read_b32 v28, v17 offset:0
    s_sub_u32 s46, s46, 1
    s_cselect_b32 s46, 0, s46
    s_cbranch_scc1 WD_132
    s_waitcnt lgkmcnt(0)
    v_readfirstlane_b32 s47, v28
    s_cmp_ge_u32 s47, 22
    s_cbranch_scc0 WF_131
WD_132:
    ds_read_b64_tr_b16 v[132:133], v8 offset:0
    ds_read_b64_tr_b16 v[134:135], v8 offset:2560
    s_waitcnt lgkmcnt(10)
    v_mfma_f32_16x16x32_bf16 v[128:131], v[148:151], v[32:35], 0
    ds_read_b64_tr_b16 v[136:137], v8 offset:8
    ds_read_b64_tr_b16 v[138:139], v8 offset:2568
    v_mfma_f32_16x16x32_bf16 v[112:115], v[152:155], v[36:39], v[112:115]
    ds_read_b64_tr_b16 v[140:141], v8 offset:16
    ds_read_b64_tr_b16 v[142:143], v8 offset:2576
    s_waitcnt lgkmcnt(10)
    v_mfma_f32_16x16x32_bf16 v[116:119], v[156:159], v[36:39], v[116:119]
    ds_read_b64_tr_b16 v[144:145], v8 offset:24
    ds_read_b64_tr_b16 v[146:147], v8 offset:2584
    v_mfma_f32_16x16x32_bf16 v[120:123], v[160:163], v[36:39], v[120:123]
    ds_read_b64_tr_b16 v[148:149], v8 offset:32
    ds_read_b64_tr_b16 v[150:151], v8 offset:2592
    s_waitcnt lgkmcnt(10)
    v_mfma_f32_16x16x32_bf16 v[124:127], v[164:167], v[36:39], v[124:127]
    ds_read_b64_tr_b16 v[152:153], v8 offset:5120
    ds_read_b64_tr_b16 v[154:155], v8 offset:7680
    v_mfma_f32_16x16x32_bf16 v[128:131], v[168:171], v[36:39], v[128:131]
    v_mov_b32 v29, 23
    ds_write_b32 v18, v29
    ds_read_b64_tr_b16 v[156:157], v8 offset:5128
    ds_read_b64_tr_b16 v[158:159], v8 offset:7688
    s_waitcnt lgkmcnt(11)
    v_mfma_f32_16x16x32_bf16 v[112:115], v[132:135], v[40:43], v[112:115]
    ds_read_b64_tr_b16 v[160:161], v8 offset:5136
    ds_read_b64_tr_b16 v[162:163], v8 offset:7696
    v_mfma_f32_16x16x32_bf16 v[116:119], v[136:139], v[40:43], v[116:119]
    ds_read_b64_tr_b16 v[164:165], v8 offset:5144
    ds_read_b64_tr_b16 v[166:167], v8 offset:7704
    s_waitcnt lgkmcnt(11)
    v_mfma_f32_16x16x32_bf16 v[120:123], v[140:143], v[40:43], v[120:123]
    ds_read_b64_tr_b16 v[168:169], v8 offset:5152
    ds_read_b64_tr_b16 v[170:171], v8 offset:7712
    v_mfma_f32_16x16x32_bf16 v[124:127], v[144:147], v[40:43], v[124:127]
    s_cmp_ge_u32 s47, 23
    s_cbranch_scc1 WD_134
WF_133:
    ds_read_b32 v28, v17 offset:0
    s_sub_u32 s46, s46, 1
    s_cselect_b32 s46, 0, s46
    s_cbranch_scc1 WD_134
    s_waitcnt lgkmcnt(0)
    v_readfirstlane_b32 s47, v28
    s_cmp_ge_u32 s47, 23
    s_cbranch_scc0 WF_133
WD_134:
    ds_read_b64_tr_b16 v[132:133], v8 offset:10240
    ds_read_b64_tr_b16 v[134:135], v8 offset:12800
    s_waitcnt lgkmcnt(11)
    v_mfma_f32_16x16x32_bf16 v[128:131], v[148:151], v[40:43], v[128:131]
    ds_read_b64_tr_b16 v[136:137], v8 offset:10248
    ds_read_b64_tr_b16 v[138:139], v8 offset:12808
    v_mfma_f32_16x16x32_bf16 v[112:115], v[152:155], v[44:47], v[112:115]
    ds_read_b64_tr_b16 v[140:141], v8 offset:10256
    ds_read_b64_tr_b16 v[142:143], v8 offset:12816
    s_waitcnt lgkmcnt(10)
    v_mfma_f32_16x16x32_bf16 v[116:119], v[156:159], v[44:47], v[116:119]
    ds_read_b64_tr_b16 v[144:145], v8 offset:10264
    ds_read_b64_tr_b16 v[146:147], v8 offset:12824
    v_mfma_f32_16x16x32_bf16 v[120:123], v[160:163], v[44:47], v[120:123]
    ds_read_b64_tr_b16 v[148:149], v8 offset:10272
    ds_read_b64_tr_b16 v[150:151], v8 offset:12832
    s_waitcnt lgkmcnt(10)
    v_mfma_f32_16x16x32_bf16 v[124:127], v[164:167], v[44:47], v[124:127]
    ds_read_b64_tr_b16 v[152:153], v8 offset:15360
    ds_read_b64_tr_b16 v[154:155], v8 offset:17920
    v_mfma_f32_16x16x32_bf16 v[128:131], v[168:171], v[44:47], v[128:131]
    v_mov_b32 v29, 24
    ds_write_b32 v18, v29
    ds_read_b64_tr_b16 v[156:157], v8 offset:15368
    ds_read_b64_tr_b16 v[158:159], v8 offset:17928
    s_waitcnt lgkmcnt(11)
    v_mfma_f32_16x16x32_bf16 v[112:115], v[132:135], v[48:51], v[112:115]
    ds_read_b64_tr_b16 v[160:161], v8 offset:15376
    ds_read_b64_tr_b16 v[162:163], v8 offset:17936
    v_mfma_f32_16x16x32_bf16 v[116:119], v[136:139], v[48:51], v[116:119]
    ds_read_b64_tr_b16 v[164:165], v8 offset:15384
    ds_read_b64_tr_b16 v[166:167], v8 offset:17944
    s_waitcnt lgkmcnt(11)
    v_mfma_f32_16x16x32_bf16 v[120:123], v[140:143], v[48:51], v[120:123]
    ds_read_b64_tr_b16 v[168:169], v8 offset:15392
    ds_read_b64_tr_b16 v[170:171], v8 offset:17952
    v_mfma_f32_16x16x32_bf16 v[124:127], v[144:147], v[48:51], v[124:127]
    s_cmp_ge_u32 s47, 24
    s_cbranch_scc1 WD_136
WF_135:
    ds_read_b32 v28, v17 offset:0
    s_sub_u32 s46, s46, 1
    s_cselect_b32 s46, 0, s46
    s_cbranch_scc1 WD_136
    s_waitcnt lgkmcnt(0)
    v_readfirstlane_b32 s47, v28
    s_cmp_ge_u32 s47, 24
    s_cbranch_scc0 WF_135
WD_136:
    ds_read_b64_tr_b16 v[132:133], v8 offset:20480
    ds_read_b64_tr_b16 v[134:135], v8 offset:23040
    s_waitcnt lgkmcnt(11)
    v_mfma_f32_16x16x32_bf16 v[128:131], v[148:151], v[48:51], v[128:131]
    ds_read_b64_tr_b16 v[136:137], v8 offset:20488
    ds_read_b64_tr_b16 v[138:139], v8 offset:23048
    v_mfma_f32_16x16x32_bf16 v[112:115], v[152:155], v[52:55], v[112:115]
    ds_read_b64_tr_b16 v[140:141], v8 offset:20496
    ds_read_b64_tr_b16 v[142:143], v8 offset:23056
    s_waitcnt lgkmcnt(10)
    v_mfma_f32_16x16x32_bf16 v[116:119], v[156:159], v[52:55], v[116:119]
    ds_read_b64_tr_b16 v[144:145], v8 offset:20504
    ds_read_b64_tr_b16 v[146:147], v8 offset:23064
    v_mfma_f32_16x16x32_bf16 v[120:123], v[160:163], v[52:55], v[120:123]
    ds_read_b64_tr_b16 v[148:149], v8 offset:20512
    ds_read_b64_tr_b16 v[150:151], v8 offset:23072
    s_waitcnt lgkmcnt(10)
    v_mfma_f32_16x16x32_bf16 v[124:127], v[164:167], v[52:55], v[124:127]
    ds_read_b64_tr_b16 v[152:153], v8 offset:25600
    ds_read_b64_tr_b16 v[154:155], v8 offset:28160
    v_mfma_f32_16x16x32_bf16 v[128:131], v[168:171], v[52:55], v[128:131]
    v_mov_b32 v29, 25
    ds_write_b32 v18, v29
    ds_read_b64_tr_b16 v[156:157], v8 offset:25608
    ds_read_b64_tr_b16 v[158:159], v8 offset:28168
    s_waitcnt lgkmcnt(11)
    v_mfma_f32_16x16x32_bf16 v[112:115], v[132:135], v[56:59], v[112:115]
    ds_read_b64_tr_b16 v[160:161], v8 offset:25616
    ds_read_b64_tr_b16 v[162:163], v8 offset:28176
    v_mfma_f32_16x16x32_bf16 v[116:119], v[136:139], v[56:59], v[116:119]
    ds_read_b64_tr_b16 v[164:165], v8 offset:25624
    ds_read_b64_tr_b16 v[166:167], v8 offset:28184
    s_waitcnt lgkmcnt(11)
    v_mfma_f32_16x16x32_bf16 v[120:123], v[140:143], v[56:59], v[120:123]
    ds_read_b64_tr_b16 v[168:169], v8 offset:25632
    ds_read_b64_tr_b16 v[170:171], v8 offset:28192
    v_mfma_f32_16x16x32_bf16 v[124:127], v[144:147], v[56:59], v[124:127]
    s_cmp_ge_u32 s47, 25
    s_cbranch_scc1 WD_138
WF_137:
    ds_read_b32 v28, v17 offset:0
    s_sub_u32 s46, s46, 1
    s_cselect_b32 s46, 0, s46
    s_cbranch_scc1 WD_138
    s_waitcnt lgkmcnt(0)
    v_readfirstlane_b32 s47, v28
    s_cmp_ge_u32 s47, 25
    s_cbranch_scc0 WF_137
WD_138:
    ds_read_b64_tr_b16 v[132:133], v8 offset:30720
    ds_read_b64_tr_b16 v[134:135], v8 offset:33280
    s_waitcnt lgkmcnt(11)
    v_mfma_f32_16x16x32_bf16 v[128:131], v[148:151], v[56:59], v[128:131]
    ds_read_b64_tr_b16 v[136:137], v8 offset:30728
    ds_read_b64_tr_b16 v[138:139], v8 offset:33288
    v_mfma_f32_16x16x32_bf16 v[112:115], v[152:155], v[60:63], v[112:115]
    ds_read_b64_tr_b16 v[140:141], v8 offset:30736
    ds_read_b64_tr_b16 v[142:143], v8 offset:33296
    s_waitcnt lgkmcnt(10)
    v_mfma_f32_16x16x32_bf16 v[116:119], v[156:159], v[60:63], v[116:119]
    ds_read_b64_tr_b16 v[144:145], v8 offset:30744
    ds_read_b64_tr_b16 v[146:147], v8 offset:33304
    v_mfma_f32_16x16x32_bf16 v[120:123], v[160:163], v[60:63], v[120:123]
    ds_read_b64_tr_b16 v[148:149], v8 offset:30752
    ds_read_b64_tr_b16 v[150:151], v8 offset:33312
    s_waitcnt lgkmcnt(10)
    v_mfma_f32_16x16x32_bf16 v[124:127], v[164:167], v[60:63], v[124:127]
    ds_read_b64_tr_b16 v[152:153], v8 offset:35840
    ds_read_b64_tr_b16 v[154:155], v8 offset:38400
    v_mfma_f32_16x16x32_bf16 v[128:131], v[168:171], v[60:63], v[128:131]
    v_mov_b32 v29, 26
    ds_write_b32 v18, v29
    ds_read_b64_tr_b16 v[156:157], v8 offset:35848
    ds_read_b64_tr_b16 v[158:159], v8 offset:38408
    s_waitcnt lgkmcnt(11)
    v_mfma_f32_16x16x32_bf16 v[112:115], v[132:135], v[64:67], v[112:115]
    ds_read_b64_tr_b16 v[160:161], v8 offset:35856
    ds_read_b64_tr_b16 v[162:163], v8 offset:38416
    v_mfma_f32_16x16x32_bf16 v[116:119], v[136:139], v[64:67], v[116:119]
    ds_read_b64_tr_b16 v[164:165], v8 offset:35864
    ds_read_b64_tr_b16 v[166:167], v8 offset:38424
    s_waitcnt lgkmcnt(11)
    v_mfma_f32_16x16x32_bf16 v[120:123], v[140:143], v[64:67], v[120:123]
    ds_read_b64_tr_b16 v[168:169], v8 offset:35872
    ds_read_b64_tr_b16 v[170:171], v8 offset:38432
    v_mfma_f32_16x16x32_bf16 v[124:127], v[144:147], v[64:67], v[124:127]
    s_cmp_ge_u32 s47, 26
    s_cbranch_scc1 WD_140
WF_139:
    ds_read_b32 v28, v17 offset:0
    s_sub_u32 s46, s46, 1
    s_cselect_b32 s46, 0, s46
    s_cbranch_scc1 WD_140
    s_waitcnt lgkmcnt(0)
    v_readfirstlane_b32 s47, v28
    s_cmp_ge_u32 s47, 26
    s_cbranch_scc0 WF_139
WD_140:
    ds_read_b64_tr_b16 v[132:133], v9 offset:0
    ds_read_b64_tr_b16 v[134:135], v9 offset:2560
    s_waitcnt lgkmcnt(11)
    v_mfma_f32_16x16x32_bf16 v[128:131], v[148:151], v[64:67], v[128:131]
    ds_read_b64_tr_b16 v[136:137], v9 offset:8
    ds_read_b64_tr_b16 v[138:139], v9 offset:2568
    v_mfma_f32_16x16x32_bf16 v[112:115], v[152:155], v[68:71], v[112:115]
    ds_read_b64_tr_b16 v[140:141], v9 offset:16
    ds_read_b64_tr_b16 v[142:143], v9 offset:2576
    s_waitcnt lgkmcnt(10)
    v_mfma_f32_16x16x32_bf16 v[116:119], v[156:159], v[68:71], v[116:119]
    ds_read_b64_tr_b16 v[144:145], v9 offset:24
    ds_read_b64_tr_b16 v[146:147], v9 offset:2584
    v_mfma_f32_16x16x32_bf16 v[120:123], v[160:163], v[68:71], v[120:123]
    ds_read_b64_tr_b16 v[148:149], v9 offset:32
    ds_read_b64_tr_b16 v[150:151], v9 offset:2592
    s_waitcnt lgkmcnt(10)
    v_mfma_f32_16x16x32_bf16 v[124:127], v[164:167], v[68:71], v[124:127]
    ds_read_b64_tr_b16 v[152:153], v9 offset:5120
    ds_read_b64_tr_b16 v[154:155], v9 offset:7680
    v_mfma_f32_16x16x32_bf16 v[128:131], v[168:171], v[68:71], v[128:131]
    v_mov_b32 v29, 27
    ds_write_b32 v18, v29
    ds_read_b64_tr_b16 v[156:157], v9 offset:5128
    ds_read_b64_tr_b16 v[158:159], v9 offset:7688
    s_waitcnt lgkmcnt(11)
    v_mfma_f32_16x16x32_bf16 v[112:115], v[132:135], v[72:75], v[112:115]
    ds_read_b64_tr_b16 v[160:161], v9 offset:5136
    ds_read_b64_tr_b16 v[162:163], v9 offset:7696
    v_mfma_f32_16x16x32_bf16 v[116:119], v[136:139], v[72:75], v[116:119]
    ds_read_b64_tr_b16 v[164:165], v9 offset:5144
    ds_read_b64_tr_b16 v[166:167], v9 offset:7704
    s_waitcnt lgkmcnt(11)
    v_mfma_f32_16x16x32_bf16 v[120:123], v[140:143], v[72:75], v[120:123]
    ds_read_b64_tr_b16 v[168:169], v9 offset:5152
    ds_read_b64_tr_b16 v[170:171], v9 offset:7712
    v_mfma_f32_16x16x32_bf16 v[124:127], v[144:147], v[72:75], v[124:127]
    s_cmp_ge_u32 s47, 27
    s_cbranch_scc1 WD_142
WF_141:
    ds_read_b32 v28, v17 offset:0
    s_sub_u32 s46, s46, 1
    s_cselect_b32 s46, 0, s46
    s_cbranch_scc1 WD_142
    s_waitcnt lgkmcnt(0)
    v_readfirstlane_b32 s47, v28
    s_cmp_ge_u32 s47, 27
    s_cbranch_scc0 WF_141
WD_142:
    ds_read_b64_tr_b16 v[132:133], v9 offset:10240
    ds_read_b64_tr_b16 v[134:135], v9 offset:12800
    s_waitcnt lgkmcnt(11)
    v_mfma_f32_16x16x32_bf16 v[128:131], v[148:151], v[72:75], v[128:131]
    ds_read_b64_tr_b16 v[136:137], v9 offset:10248
    ds_read_b64_tr_b16 v[138:139], v9 offset:12808
    v_mfma_f32_16x16x32_bf16 v[112:115], v[152:155], v[76:79], v[112:115]
    ds_read_b64_tr_b16 v[140:141], v9 offset:10256
    ds_read_b64_tr_b16 v[142:143], v9 offset:12816
    s_waitcnt lgkmcnt(10)
    v_mfma_f32_16x16x32_bf16 v[116:119], v[156:159], v[76:79], v[116:119]
    ds_read_b64_tr_b16 v[144:145], v9 offset:10264
    ds_read_b64_tr_b16 v[146:147], v9 offset:12824
    v_mfma_f32_16x16x32_bf16 v[120:123], v[160:163], v[76:79], v[120:123]
    ds_read_b64_tr_b16 v[148:149], v9 offset:10272
    ds_read_b64_tr_b16 v[150:151], v9 offset:12832
    s_waitcnt lgkmcnt(10)
    v_mfma_f32_16x16x32_bf16 v[124:127], v[164:167], v[76:79], v[124:127]
    ds_read_b64_tr_b16 v[152:153], v9 offset:15360
    ds_read_b64_tr_b16 v[154:155], v9 offset:17920
    v_mfma_f32_16x16x32_bf16 v[128:131], v[168:171], v[76:79], v[128:131]
    v_mov_b32 v29, 28
    ds_write_b32 v18, v29
    ds_read_b64_tr_b16 v[156:157], v9 offset:15368
    ds_read_b64_tr_b16 v[158:159], v9 offset:17928
    s_waitcnt lgkmcnt(11)
    v_mfma_f32_16x16x32_bf16 v[112:115], v[132:135], v[80:83], v[112:115]
    ds_read_b64_tr_b16 v[160:161], v9 offset:15376
    ds_read_b64_tr_b16 v[162:163], v9 offset:17936
    v_mfma_f32_16x16x32_bf16 v[116:119], v[136:139], v[80:83], v[116:119]
    ds_read_b64_tr_b16 v[164:165], v9 offset:15384
    ds_read_b64_tr_b16 v[166:167], v9 offset:17944
    s_waitcnt lgkmcnt(11)
    v_mfma_f32_16x16x32_bf16 v[120:123], v[140:143], v[80:83], v[120:123]
    ds_read_b64_tr_b16 v[168:169], v9 offset:15392
    ds_read_b64_tr_b16 v[170:171], v9 offset:17952
    v_mfma_f32_16x16x32_bf16 v[124:127], v[144:147], v[80:83], v[124:127]
    ds_read_b64_tr_b16 v[204:205], v19 offset:0
    ds_read_b64_tr_b16 v[206:207], v19 offset:160
    s_waitcnt lgkmcnt(14)
    ds_read_b64_tr_b16 v[208:209], v19 offset:320
    s_waitcnt lgkmcnt(14)
    ds_read_b64_tr_b16 v[210:211], v19 offset:480
    s_waitcnt lgkmcnt(14)
    ds_read_b64_tr_b16 v[244:245], v19 offset:640
    s_waitcnt lgkmcnt(14)
    ds_read_b64_tr_b16 v[212:213], v19 offset:8
    s_waitcnt lgkmcnt(14)
    ds_read_b64_tr_b16 v[214:215], v19 offset:168
    s_waitcnt lgkmcnt(14)
    ds_read_b64_tr_b16 v[216:217], v19 offset:328
    s_waitcnt lgkmcnt(14)
    ds_read_b64_tr_b16 v[218:219], v19 offset:488
    s_waitcnt lgkmcnt(14)
    ds_read_b64_tr_b16 v[246:247], v19 offset:648
    s_waitcnt lgkmcnt(14)
    ds_read_b64_tr_b16 v[220:221], v19 offset:16
    s_waitcnt lgkmcnt(14)
    ds_read_b64_tr_b16 v[222:223], v19 offset:176
    s_waitcnt lgkmcnt(14)
    ds_read_b64_tr_b16 v[224:225], v19 offset:336
    s_waitcnt lgkmcnt(14)
    ds_read_b64_tr_b16 v[226:227], v19 offset:496
    s_waitcnt lgkmcnt(14)
    ds_read_b64_tr_b16 v[248:249], v19 offset:656
    s_waitcnt lgkmcnt(14)
    ds_read_b64_tr_b16 v[228:229], v19 offset:24
    s_waitcnt lgkmcnt(14)
    ds_read_b64_tr_b16 v[230:231], v19 offset:184
    s_waitcnt lgkmcnt(14)
    ds_read_b64_tr_b16 v[232:233], v19 offset:344
    s_waitcnt lgkmcnt(14)
    ds_read_b64_tr_b16 v[234:235], v19 offset:504
    s_waitcnt lgkmcnt(14)
    ds_read_b64_tr_b16 v[250:251], v19 offset:664
    s_waitcnt lgkmcnt(14)
    ds_read_b64_tr_b16 v[236:237], v19 offset:32
    s_waitcnt lgkmcnt(14)
    ds_read_b64_tr_b16 v[238:239], v19 offset:192
    s_waitcnt lgkmcnt(14)
    ds_read_b64_tr_b16 v[240:241], v19 offset:352
    s_waitcnt lgkmcnt(14)
    ds_read_b64_tr_b16 v[242:243], v19 offset:512
    s_waitcnt lgkmcnt(14)
    ds_read_b64_tr_b16 v[252:253], v19 offset:672
    s_cmp_ge_u32 s47, 28
    s_cbranch_scc1 WD_144
WF_143:
    ds_read_b32 v28, v17 offset:0
    s_sub_u32 s46, s46, 1
    s_cselect_b32 s46, 0, s46
    s_cbranch_scc1 WD_144
    s_waitcnt lgkmcnt(0)
    v_readfirstlane_b32 s47, v28
    s_cmp_ge_u32 s47, 28
    s_cbranch_scc0 WF_143
WD_144:
    s_waitcnt lgkmcnt(14)
    ds_read_b64_tr_b16 v[132:133], v9 offset:20480
    s_waitcnt lgkmcnt(14)
    ds_read_b64_tr_b16 v[134:135], v9 offset:23040
    v_mfma_f32_16x16x32_bf16 v[128:131], v[148:151], v[80:83], v[128:131]
    s_waitcnt lgkmcnt(14)
    ds_read_b64_tr_b16 v[136:137], v9 offset:20488
    s_waitcnt lgkmcnt(14)
    ds_read_b64_tr_b16 v[138:139], v9 offset:23048
    v_mfma_f32_16x16x32_bf16 v[112:115], v[152:155], v[84:87], v[112:115]
    s_waitcnt lgkmcnt(14)
    ds_read_b64_tr_b16 v[140:141], v9 offset:20496
    s_waitcnt lgkmcnt(14)
    ds_read_b64_tr_b16 v[142:143], v9 offset:23056
    v_mfma_f32_16x16x32_bf16 v[116:119], v[156:159], v[84:87], v[116:119]
    s_waitcnt lgkmcnt(14)
    ds_read_b64_tr_b16 v[144:145], v9 offset:20504
    s_waitcnt lgkmcnt(14)
    ds_read_b64_tr_b16 v[146:147], v9 offset:23064
    v_mfma_f32_16x16x32_bf16 v[120:123], v[160:163], v[84:87], v[120:123]
    s_waitcnt lgkmcnt(14)
    ds_read_b64_tr_b16 v[148:149], v9 offset:20512
    s_waitcnt lgkmcnt(14)
    ds_read_b64_tr_b16 v[150:151], v9 offset:23072
    v_mfma_f32_16x16x32_bf16 v[124:127], v[164:167], v[84:87], v[124:127]
    s_waitcnt lgkmcnt(14)
    ds_read_b64_tr_b16 v[152:153], v9 offset:25600
    s_waitcnt lgkmcnt(14)
    ds_read_b64_tr_b16 v[154:155], v9 offset:28160
    v_mfma_f32_16x16x32_bf16 v[128:131], v[168:171], v[84:87], v[128:131]
    v_mov_b32 v29, 29
    s_waitcnt lgkmcnt(14)
    ds_write_b32 v18, v29
    s_waitcnt lgkmcnt(14)
    ds_read_b64_tr_b16 v[156:157], v9 offset:25608
    s_waitcnt lgkmcnt(14)
    ds_read_b64_tr_b16 v[158:159], v9 offset:28168
    s_waitcnt lgkmcnt(11)
    v_mfma_f32_16x16x32_bf16 v[112:115], v[132:135], v[88:91], v[112:115]
    ds_read_b64_tr_b16 v[160:161], v9 offset:25616
    ds_read_b64_tr_b16 v[162:163], v9 offset:28176
    v_mfma_f32_16x16x32_bf16 v[116:119], v[136:139], v[88:91], v[116:119]
    ds_read_b64_tr_b16 v[164:165], v9 offset:25624
    ds_read_b64_tr_b16 v[166:167], v9 offset:28184
    s_waitcnt lgkmcnt(11)
    v_mfma_f32_16x16x32_bf16 v[120:123], v[140:143], v[88:91], v[120:123]
    ds_read_b64_tr_b16 v[168:169], v9 offset:25632
    ds_read_b64_tr_b16 v[170:171], v9 offset:28192
    v_mfma_f32_16x16x32_bf16 v[124:127], v[144:147], v[88:91], v[124:127]
    s_cmp_ge_u32 s47, 29
    s_cbranch_scc1 WD_146
WF_145:
    ds_read_b32 v28, v17 offset:0
    s_sub_u32 s46, s46, 1
    s_cselect_b32 s46, 0, s46
    s_cbranch_scc1 WD_146
    s_waitcnt lgkmcnt(0)
    v_readfirstlane_b32 s47, v28
    s_cmp_ge_u32 s47, 29
    s_cbranch_scc0 WF_145
WD_146:
    ds_read_b64_tr_b16 v[132:133], v8 offset:0
    ds_read_b64_tr_b16 v[134:135], v8 offset:2560
    s_waitcnt lgkmcnt(11)
    v_mfma_f32_16x16x32_bf16 v[128:131], v[148:151], v[88:91], v[128:131]
    ds_read_b64_tr_b16 v[136:137], v8 offset:8
    ds_read_b64_tr_b16 v[138:139], v8 offset:2568
    v_mfma_f32_16x16x32_bf16 v[112:115], v[152:155], v[92:95], v[112:115]
    ds_read_b64_tr_b16 v[140:141], v8 offset:16
    ds_read_b64_tr_b16 v[142:143], v8 offset:2576
    s_waitcnt lgkmcnt(10)
    v_mfma_f32_16x16x32_bf16 v[116:119], v[156:159], v[92:95], v[116:119]
    ds_read_b64_tr_b16 v[144:145], v8 offset:24
    ds_read_b64_tr_b16 v[146:147], v8 offset:2584
    v_mfma_f32_16x16x32_bf16 v[120:123], v[160:163], v[92:95], v[120:123]
    ds_read_b64_tr_b16 v[148:149], v8 offset:32
    ds_read_b64_tr_b16 v[150:151], v8 offset:2592
    s_waitcnt lgkmcnt(10)
    v_mfma_f32_16x16x32_bf16 v[124:127], v[164:167], v[92:95], v[124:127]
    ds_read_b64_tr_b16 v[152:153], v8 offset:5120
    ds_read_b64_tr_b16 v[154:155], v8 offset:7680
    v_mfma_f32_16x16x32_bf16 v[128:131], v[168:171], v[92:95], v[128:131]
    v_mov_b32 v29, 30
    ds_write_b32 v18, v29
    ds_read_b64_tr_b16 v[156:157], v8 offset:5128
    ds_read_b64_tr_b16 v[158:159], v8 offset:7688
    s_waitcnt lgkmcnt(11)
    v_mfma_f32_16x16x32_bf16 v[112:115], v[132:135], v[96:99], v[112:115]
    ds_read_b64_tr_b16 v[160:161], v8 offset:5136
    ds_read_b64_tr_b16 v[162:163], v8 offset:7696
    v_mfma_f32_16x16x32_bf16 v[116:119], v[136:139], v[96:99], v[116:119]
    ds_read_b64_tr_b16 v[164:165], v8 offset:5144
    ds_read_b64_tr_b16 v[166:167], v8 offset:7704
    s_waitcnt lgkmcnt(11)
    v_mfma_f32_16x16x32_bf16 v[120:123], v[140:143], v[96:99], v[120:123]
    ds_read_b64_tr_b16 v[168:169], v8 offset:5152
    ds_read_b64_tr_b16 v[170:171], v8 offset:7712
    v_mfma_f32_16x16x32_bf16 v[124:127], v[144:147], v[96:99], v[124:127]
    s_cmp_ge_u32 s47, 30
    s_cbranch_scc1 WD_148
WF_147:
    ds_read_b32 v28, v17 offset:0
    s_sub_u32 s46, s46, 1
    s_cselect_b32 s46, 0, s46
    s_cbranch_scc1 WD_148
    s_waitcnt lgkmcnt(0)
    v_readfirstlane_b32 s47, v28
    s_cmp_ge_u32 s47, 30
    s_cbranch_scc0 WF_147
WD_148:
    ds_read_b64_tr_b16 v[132:133], v8 offset:10240
    ds_read_b64_tr_b16 v[134:135], v8 offset:12800
    s_waitcnt lgkmcnt(11)
    v_mfma_f32_16x16x32_bf16 v[128:131], v[148:151], v[96:99], v[128:131]
    ds_read_b64_tr_b16 v[136:137], v8 offset:10248
    ds_read_b64_tr_b16 v[138:139], v8 offset:12808
    v_mfma_f32_16x16x32_bf16 v[112:115], v[152:155], v[100:103], v[112:115]
    ds_read_b64_tr_b16 v[140:141], v8 offset:10256
    ds_read_b64_tr_b16 v[142:143], v8 offset:12816
    s_waitcnt lgkmcnt(10)
    v_mfma_f32_16x16x32_bf16 v[116:119], v[156:159], v[100:103], v[116:119]
    ds_read_b64_tr_b16 v[144:145], v8 offset:10264
    ds_read_b64_tr_b16 v[146:147], v8 offset:12824
    v_mfma_f32_16x16x32_bf16 v[120:123], v[160:163], v[100:103], v[120:123]
    ds_read_b64_tr_b16 v[148:149], v8 offset:10272
    ds_read_b64_tr_b16 v[150:151], v8 offset:12832
    s_waitcnt lgkmcnt(10)
    v_mfma_f32_16x16x32_bf16 v[124:127], v[164:167], v[100:103], v[124:127]
    ds_read_b64_tr_b16 v[152:153], v8 offset:15360
    ds_read_b64_tr_b16 v[154:155], v8 offset:17920
    v_mfma_f32_16x16x32_bf16 v[128:131], v[168:171], v[100:103], v[128:131]
    v_mov_b32 v29, 31
    ds_write_b32 v18, v29
    ds_read_b64_tr_b16 v[156:157], v8 offset:15368
    ds_read_b64_tr_b16 v[158:159], v8 offset:17928
    s_waitcnt lgkmcnt(11)
    v_mfma_f32_16x16x32_bf16 v[112:115], v[132:135], v[104:107], v[112:115]
    ds_read_b64_tr_b16 v[160:161], v8 offset:15376
    ds_read_b64_tr_b16 v[162:163], v8 offset:17936
    v_mfma_f32_16x16x32_bf16 v[116:119], v[136:139], v[104:107], v[116:119]
    ds_read_b64_tr_b16 v[164:165], v8 offset:15384
    ds_read_b64_tr_b16 v[166:167], v8 offset:17944
    s_waitcnt lgkmcnt(11)
    v_mfma_f32_16x16x32_bf16 v[120:123], v[140:143], v[104:107], v[120:123]
    ds_read_b64_tr_b16 v[168:169], v8 offset:15392
    ds_read_b64_tr_b16 v[170:171], v8 offset:17952
    v_mfma_f32_16x16x32_bf16 v[124:127], v[144:147], v[104:107], v[124:127]
    s_waitcnt lgkmcnt(9)
    v_mfma_f32_16x16x32_bf16 v[128:131], v[148:151], v[104:107], v[128:131]
    v_mfma_f32_16x16x32_bf16 v[112:115], v[152:155], v[108:111], v[112:115]
    s_waitcnt lgkmcnt(4)
    v_mfma_f32_16x16x32_bf16 v[116:119], v[156:159], v[108:111], v[116:119]
    v_mfma_f32_16x16x32_bf16 v[120:123], v[160:163], v[108:111], v[120:123]
    s_waitcnt lgkmcnt(0)
    v_mfma_f32_16x16x32_bf16 v[124:127], v[164:167], v[108:111], v[124:127]
    v_mfma_f32_16x16x32_bf16 v[128:131], v[168:171], v[108:111], v[128:131]
    v_mov_b32 v29, 32
    ds_write_b32 v18, v29
    s_lshl_b32 s50, s42, 2
    s_lshr_b32 s51, s41, 3
    s_add_u32 s50, s50, s51
    s_lshl_b32 s50, s50, 2
    s_add_u32 s50, s50, s40
    s_lshl_b32 s50, s50, 7
    s_add_u32 s50, s50, 9109504
    s_add_u32 s4, s36, s50
    s_addc_u32 s5, s37, 0
    s_and_b32 s55, s34, 0xff
    s_mul_i32 s55, s55, 0x01010101
    s_lshl_b32 s50, s42, 13
    s_mul_i32 s51, s40, 1792
    s_add_u32 s50, s50, s51
    s_lshr_b32 s51, s41, 3
    s_lshl_b32 s51, s51, 16
    s_add_u32 s50, s50, s51
    s_add_u32 s50, s50, 2097152
    s_mov_b32 s52, -1
    s_mov_b32 s53, 0xffff
    s_mov_b32 s54, 0
    v_min_u32 v12, 1776, v15
    v_add_u32 v13, 1024, v15
    v_min_u32 v13, 1776, v13
    s_lshl_b32 s35, s41, 2
    s_add_u32 s35, s35, s40
    s_lshl_b32 s35, s35, 7
    s_add_u32 s35, s35, 9175040
    s_add_u32 s51, s35, s42
    v_mov_b32 v25, s51
    s_waitcnt lgkmcnt(0)
    s_load_dwordx2 s[68:69], s[4:5], 0 glc
    s_nop 7
    v_cvt_pk_bf16_f32 v180, v128, v129
    v_cvt_pk_bf16_f32 v181, v130, v131
    v_cvt_pk_bf16_f32 v172, v112, v113
    v_cvt_pk_bf16_f32 v173, v114, v115
    v_mfma_f32_16x16x16_bf16 v[184:187], v[244:245], v[180:181], 0
    v_mfma_f32_16x16x16_bf16 v[188:191], v[246:247], v[180:181], 0
    v_mfma_f32_16x16x16_bf16 v[192:195], v[248:249], v[180:181], 0
    v_mfma_f32_16x16x16_bf16 v[196:199], v[250:251], v[180:181], 0
    v_mfma_f32_16x16x16_bf16 v[200:203], v[252:253], v[180:181], 0
    v_cvt_pk_bf16_f32 v174, v116, v117
    v_cvt_pk_bf16_f32 v175, v118, v119
    v_cvt_pk_bf16_f32 v176, v120, v121
    v_cvt_pk_bf16_f32 v177, v122, v123
    v_cvt_pk_bf16_f32 v178, v124, v125
    v_cvt_pk_bf16_f32 v179, v126, v127
    s_nop 1
    v_mfma_f32_16x16x32_bf16 v[184:187], v[204:207], v[172:175], v[184:187]
    v_mfma_f32_16x16x32_bf16 v[188:191], v[212:215], v[172:175], v[188:191]
    v_mfma_f32_16x16x32_bf16 v[192:195], v[220:223], v[172:175], v[192:195]
    v_mfma_f32_16x16x32_bf16 v[196:199], v[228:231], v[172:175], v[196:199]
    v_mfma_f32_16x16x32_bf16 v[200:203], v[236:239], v[172:175], v[200:203]
    v_mfma_f32_16x16x32_bf16 v[184:187], v[208:211], v[176:179], v[184:187]
    v_mfma_f32_16x16x32_bf16 v[188:191], v[216:219], v[176:179], v[188:191]
    v_mfma_f32_16x16x32_bf16 v[192:195], v[224:227], v[176:179], v[192:195]
    v_mfma_f32_16x16x32_bf16 v[196:199], v[232:235], v[176:179], v[196:199]
    v_mfma_f32_16x16x32_bf16 v[200:203], v[240:243], v[176:179], v[200:203]
    s_nop 7
    v_max3_f32 v234, v184, v185, v186
    v_min3_f32 v236, v184, v185, v186
    v_max3_f32 v235, v187, v188, v189
    v_min3_f32 v237, v187, v188, v189
    v_max3_f32 v234, v234, v190, v191
    v_min3_f32 v236, v236, v190, v191
    v_max3_f32 v235, v235, v192, v193
    v_min3_f32 v237, v237, v192, v193
    v_max3_f32 v234, v234, v194, v195
    v_min3_f32 v236, v236, v194, v195
    v_max3_f32 v235, v235, v196, v197
    v_min3_f32 v237, v237, v196, v197
    v_max3_f32 v234, v234, v198, v199
    v_min3_f32 v236, v236, v198, v199
    v_max3_f32 v235, v235, v200, v201
    v_min3_f32 v237, v237, v200, v201
    v_max3_f32 v234, v234, v202, v203
    v_min3_f32 v236, v236, v202, v203
    v_max_f32 v234, v234, v235
    v_min_f32 v236, v236, v237
    v_mul_f32 v234, s70, v234
    v_mul_f32 v236, s70, v236
    v_pk_fma_f32 v[204:205], v[184:185], s[70:71], v[236:237] op_sel_hi:[1,0,0] neg_lo:[1,0,0] neg_hi:[1,0,0]
    v_pk_fma_f32 v[184:185], v[184:185], s[70:71], v[234:235] op_sel_hi:[1,0,0] neg_lo:[0,0,1] neg_hi:[0,0,1]
    v_pk_fma_f32 v[206:207], v[186:187], s[70:71], v[236:237] op_sel_hi:[1,0,0] neg_lo:[1,0,0] neg_hi:[1,0,0]
    v_pk_fma_f32 v[186:187], v[186:187], s[70:71], v[234:235] op_sel_hi:[1,0,0] neg_lo:[0,0,1] neg_hi:[0,0,1]
    v_pk_fma_f32 v[208:209], v[188:189], s[70:71], v[236:237] op_sel_hi:[1,0,0] neg_lo:[1,0,0] neg_hi:[1,0,0]
    v_pk_fma_f32 v[188:189], v[188:189], s[70:71], v[234:235] op_sel_hi:[1,0,0] neg_lo:[0,0,1] neg_hi:[0,0,1]
    v_pk_fma_f32 v[210:211], v[190:191], s[70:71], v[236:237] op_sel_hi:[1,0,0] neg_lo:[1,0,0] neg_hi:[1,0,0]
    v_pk_fma_f32 v[190:191], v[190:191], s[70:71], v[234:235] op_sel_hi:[1,0,0] neg_lo:[0,0,1] neg_hi:[0,0,1]
    v_pk_fma_f32 v[212:213], v[192:193], s[70:71], v[236:237] op_sel_hi:[1,0,0] neg_lo:[1,0,0] neg_hi:[1,0,0]
    v_pk_fma_f32 v[192:193], v[192:193], s[70:71], v[234:235] op_sel_hi:[1,0,0] neg_lo:[0,0,1] neg_hi:[0,0,1]
    v_pk_fma_f32 v[214:215], v[194:195], s[70:71], v[236:237] op_sel_hi:[1,0,0] neg_lo:[1,0,0] neg_hi:[1,0,0]
    v_pk_fma_f32 v[194:195], v[194:195], s[70:71], v[234:235] op_sel_hi:[1,0,0] neg_lo:[0,0,1] neg_hi:[0,0,1]
    v_pk_fma_f32 v[216:217], v[196:197], s[70:71], v[236:237] op_sel_hi:[1,0,0] neg_lo:[1,0,0] neg_hi:[1,0,0]
    v_pk_fma_f32 v[196:197], v[196:197], s[70:71], v[234:235] op_sel_hi:[1,0,0] neg_lo:[0,0,1] neg_hi:[0,0,1]
    v_pk_fma_f32 v[218:219], v[198:199], s[70:71], v[236:237] op_sel_hi:[1,0,0] neg_lo:[1,0,0] neg_hi:[1,0,0]
    v_pk_fma_f32 v[198:199], v[198:199], s[70:71], v[234:235] op_sel_hi:[1,0,0] neg_lo:[0,0,1] neg_hi:[0,0,1]
    v_pk_fma_f32 v[220:221], v[200:201], s[70:71], v[236:237] op_sel_hi:[1,0,0] neg_lo:[1,0,0] neg_hi:[1,0,0]
    v_pk_fma_f32 v[200:201], v[200:201], s[70:71], v[234:235] op_sel_hi:[1,0,0] neg_lo:[0,0,1] neg_hi:[0,0,1]
    v_pk_fma_f32 v[222:223], v[202:203], s[70:71], v[236:237] op_sel_hi:[1,0,0] neg_lo:[1,0,0] neg_hi:[1,0,0]
    v_pk_fma_f32 v[202:203], v[202:203], s[70:71], v[234:235] op_sel_hi:[1,0,0] neg_lo:[0,0,1] neg_hi:[0,0,1]
    v_exp_f32 v184, v184
    v_exp_f32 v204, v204
    v_exp_f32 v185, v185
    v_exp_f32 v205, v205
    v_exp_f32 v186, v186
    v_exp_f32 v206, v206
    v_exp_f32 v187, v187
    v_exp_f32 v207, v207
    v_exp_f32 v188, v188
    v_exp_f32 v208, v208
    v_exp_f32 v189, v189
    v_exp_f32 v209, v209
    v_exp_f32 v190, v190
    v_exp_f32 v210, v210
    v_exp_f32 v191, v191
    v_exp_f32 v211, v211
    v_exp_f32 v192, v192
    v_exp_f32 v212, v212
    v_exp_f32 v193, v193
    v_exp_f32 v213, v213
    v_exp_f32 v194, v194
    v_exp_f32 v214, v214
    v_exp_f32 v195, v195
    v_exp_f32 v215, v215
    v_exp_f32 v196, v196
    v_exp_f32 v216, v216
    v_exp_f32 v197, v197
    v_exp_f32 v217, v217
    v_exp_f32 v198, v198
    v_exp_f32 v218, v218
    v_exp_f32 v199, v199
    v_exp_f32 v219, v219
    v_exp_f32 v200, v200
    v_exp_f32 v220, v220
    v_exp_f32 v201, v201
    v_exp_f32 v221, v221
    v_exp_f32 v202, v202
    v_exp_f32 v222, v222
    v_exp_f32 v203, v203
    v_exp_f32 v223, v223
    v_pk_add_f32 v[234:235], v[184:185], v[186:187]
    v_pk_add_f32 v[236:237], v[204:205], v[206:207]
    v_pk_add_f32 v[238:239], v[188:189], v[190:191]
    v_pk_add_f32 v[240:241], v[208:209], v[210:211]
    v_pk_add_f32 v[234:235], v[234:235], v[192:193]
    v_pk_add_f32 v[236:237], v[236:237], v[212:213]
    v_pk_add_f32 v[238:239], v[238:239], v[194:195]
    v_pk_add_f32 v[240:241], v[240:241], v[214:215]
    v_pk_add_f32 v[234:235], v[234:235], v[196:197]
    v_pk_add_f32 v[236:237], v[236:237], v[216:217]
    v_pk_add_f32 v[238:239], v[238:239], v[198:199]
    v_pk_add_f32 v[240:241], v[240:241], v[218:219]
    v_pk_add_f32 v[234:235], v[234:235], v[200:201]
    v_pk_add_f32 v[236:237], v[236:237], v[220:221]
    v_pk_add_f32 v[238:239], v[238:239], v[202:203]
    v_pk_add_f32 v[240:241], v[240:241], v[222:223]
    v_pk_add_f32 v[234:235], v[234:235], v[238:239]
    v_pk_add_f32 v[236:237], v[236:237], v[240:241]
    v_add_f32 v234, v234, v235
    v_add_f32 v236, v236, v237
    v_rcp_f32 v234, v234
    v_rcp_f32 v236, v236
    s_nop 0
    v_pk_mul_f32 v[184:185], v[184:185], v[234:235] op_sel_hi:[1,0]
    v_pk_mul_f32 v[204:205], v[204:205], v[236:237] op_sel_hi:[1,0]
    v_pk_mul_f32 v[186:187], v[186:187], v[234:235] op_sel_hi:[1,0]
    v_pk_mul_f32 v[206:207], v[206:207], v[236:237] op_sel_hi:[1,0]
    v_pk_mul_f32 v[188:189], v[188:189], v[234:235] op_sel_hi:[1,0]
    v_pk_mul_f32 v[208:209], v[208:209], v[236:237] op_sel_hi:[1,0]
    v_pk_mul_f32 v[190:191], v[190:191], v[234:235] op_sel_hi:[1,0]
    v_pk_mul_f32 v[210:211], v[210:211], v[236:237] op_sel_hi:[1,0]
    v_pk_mul_f32 v[192:193], v[192:193], v[234:235] op_sel_hi:[1,0]
    v_pk_mul_f32 v[212:213], v[212:213], v[236:237] op_sel_hi:[1,0]
    v_pk_mul_f32 v[194:195], v[194:195], v[234:235] op_sel_hi:[1,0]
    v_pk_mul_f32 v[214:215], v[214:215], v[236:237] op_sel_hi:[1,0]
    v_pk_mul_f32 v[196:197], v[196:197], v[234:235] op_sel_hi:[1,0]
    v_pk_mul_f32 v[216:217], v[216:217], v[236:237] op_sel_hi:[1,0]
    v_pk_mul_f32 v[198:199], v[198:199], v[234:235] op_sel_hi:[1,0]
    v_pk_mul_f32 v[218:219], v[218:219], v[236:237] op_sel_hi:[1,0]
    v_pk_mul_f32 v[200:201], v[200:201], v[234:235] op_sel_hi:[1,0]
    v_pk_mul_f32 v[220:221], v[220:221], v[236:237] op_sel_hi:[1,0]
    v_pk_mul_f32 v[202:203], v[202:203], v[234:235] op_sel_hi:[1,0]
    v_pk_mul_f32 v[222:223], v[222:223], v[236:237] op_sel_hi:[1,0]
    v_cvt_pk_bf16_f32 v236, v184, v185
    v_cvt_pk_bf16_f32 v246, v204, v205
    v_cvt_pk_bf16_f32 v237, v186, v187
    v_cvt_pk_bf16_f32 v247, v206, v207
    v_cvt_pk_bf16_f32 v238, v188, v189
    v_cvt_pk_bf16_f32 v248, v208, v209
    v_cvt_pk_bf16_f32 v239, v190, v191
    v_cvt_pk_bf16_f32 v249, v210, v211
    v_cvt_pk_bf16_f32 v240, v192, v193
    v_cvt_pk_bf16_f32 v250, v212, v213
    v_cvt_pk_bf16_f32 v241, v194, v195
    v_cvt_pk_bf16_f32 v251, v214, v215
    v_cvt_pk_bf16_f32 v242, v196, v197
    v_cvt_pk_bf16_f32 v252, v216, v217
    v_cvt_pk_bf16_f32 v243, v198, v199
    v_cvt_pk_bf16_f32 v253, v218, v219
    v_cvt_pk_bf16_f32 v244, v200, v201
    v_cvt_pk_bf16_f32 v254, v220, v221
    v_cvt_pk_bf16_f32 v245, v202, v203
    v_cvt_pk_bf16_f32 v255, v222, v223
    s_cmp_eq_u32 s54, 1
    s_cbranch_scc1 K3_151
    s_waitcnt lgkmcnt(0)
    s_xor_b32 s68, s68, s55
    s_xor_b32 s69, s69, s55
    s_or_b32 s68, s68, s69
K2_149:
    buffer_load_dwordx4 v[32:35], v15, s[36:39], s50 offen sc1
    buffer_load_dwordx4 v[36:39], v13, s[36:39], s50 offen sc1
    v_mov_b32 v31, 33
    ds_write_b32 v18, v31
K3_151:
    s_waitcnt vmcnt(0)
    v_xor_b32 v32, s32, v32
    v_xor_b32 v33, s32, v33
    v_xor_b32 v34, s32, v34
    v_xor_b32 v35, s32, v35
    v_xor_b32 v36, s32, v36
    v_xor_b32 v37, s32, v37
    v_xor_b32 v38, s32, v38
    v_xor_b32 v39, s32, v39
    v_or_b32 v28, v32, v33
    v_or_b32 v29, v34, v35
    v_or3_b32 v28, v28, v36, v37
    v_or3_b32 v29, v29, v38, v39
    v_or_b32 v28, v28, v29
    v_and_b32 v28, 0x10001, v28
    v_cmp_ne_u32 vcc, 0, v28
    s_sub_u32 s46, s46, 32
    s_cselect_b32 s46, 0, s46
    s_cbranch_scc1 K2D_150
    s_cbranch_vccnz K2_149
K2D_150:
    s_mov_b32 exec_lo, 0x7fff7fff
    s_mov_b32 exec_hi, 0x7fff7fff
    ds_write_b128 v22, v[32:35]
    s_mov_b32 exec_hi, 0x7fff
    ds_write_b128 v22, v[36:39] offset:960
    s_mov_b64 exec, -1
    v_mov_b32 v28, 34
    ds_write_b32 v18, v28
SY_153:
    ds_read_b32 v28, v26
    s_sub_u32 s46, s46, 1
    s_cselect_b32 s46, 0, s46
    s_cbranch_scc1 SD_154
    s_waitcnt lgkmcnt(0)
    v_cmp_gt_u32 vcc, 34, v28
    s_cbranch_vccnz SY_153
SD_154:
    ds_read_b128 v[40:43], v24 offset:1600
    ds_read_b128 v[44:47], v24 offset:1616
    ds_read_b128 v[48:51], v24 offset:1632
    ds_read_b128 v[52:55], v24 offset:1648
    ds_read_b128 v[56:59], v24 offset:1664
    ds_read_b128 v[60:63], v24 offset:0
    ds_read_b128 v[64:67], v24 offset:16
    ds_read_b128 v[68:71], v24 offset:32
    ds_read_b128 v[72:75], v24 offset:48
    ds_read_b128 v[76:79], v24 offset:64
    ds_read_b128 v[80:83], v24 offset:320
    ds_read_b128 v[84:87], v24 offset:336
    s_waitcnt lgkmcnt(9)
    v_mfma_f32_16x16x32_bf16 v[180:183], v[40:43], v[236:239], 0
    ds_read_b128 v[88:91], v24 offset:352
    v_mfma_f32_16x16x32_bf16 v[180:183], v[44:47], v[240:243], v[180:183]
    ds_read_b128 v[92:95], v24 offset:368
    v_mfma_f32_16x16x32_bf16 v[180:183], v[48:51], v[244:247], v[180:183]
    ds_read_b128 v[96:99], v24 offset:384
    s_waitcnt lgkmcnt(9)
    v_mfma_f32_16x16x32_bf16 v[180:183], v[52:55], v[248:251], v[180:183]
    ds_read_b128 v[100:103], v24 offset:640
    v_mfma_f32_16x16x32_bf16 v[180:183], v[56:59], v[252:255], v[180:183]
    ds_read_b128 v[104:107], v24 offset:656
    v_mfma_f32_16x16x32_bf16 v[160:163], v[60:63], v[236:239], 0
    ds_read_b128 v[108:111], v24 offset:672
    s_waitcnt lgkmcnt(9)
    v_mfma_f32_16x16x32_bf16 v[160:163], v[64:67], v[240:243], v[160:163]
    ds_read_b128 v[112:115], v24 offset:688
    v_mfma_f32_16x16x32_bf16 v[160:163], v[68:71], v[244:247], v[160:163]
    ds_read_b128 v[116:119], v24 offset:704
    v_mfma_f32_16x16x32_bf16 v[160:163], v[72:75], v[248:251], v[160:163]
    ds_read_b128 v[120:123], v24 offset:960
    s_waitcnt lgkmcnt(9)
    v_mfma_f32_16x16x32_bf16 v[160:163], v[76:79], v[252:255], v[160:163]
    ds_read_b128 v[124:127], v24 offset:976
    v_mfma_f32_16x16x32_bf16 v[164:167], v[80:83], v[236:239], 0
    ds_read_b128 v[128:131], v24 offset:992
    v_mfma_f32_16x16x32_bf16 v[164:167], v[84:87], v[240:243], v[164:167]
    ds_read_b128 v[132:135], v24 offset:1008
    s_waitcnt lgkmcnt(9)
    v_mfma_f32_16x16x32_bf16 v[164:167], v[88:91], v[244:247], v[164:167]
    ds_read_b128 v[136:139], v24 offset:1024
    v_mfma_f32_16x16x32_bf16 v[164:167], v[92:95], v[248:251], v[164:167]
    v_add_f32 v28, 0x358637bd, v180
    ds_read_b128 v[140:143], v24 offset:1280
    v_mfma_f32_16x16x32_bf16 v[164:167], v[96:99], v[252:255], v[164:167]
    v_rcp_f32 v28, v28
    ds_read_b128 v[144:147], v24 offset:1296
    s_waitcnt lgkmcnt(9)
    v_mfma_f32_16x16x32_bf16 v[168:171], v[100:103], v[236:239], 0
    ds_read_b128 v[148:151], v24 offset:1312
    v_mfma_f32_16x16x32_bf16 v[168:171], v[104:107], v[240:243], v[168:171]
    v_mul_f32 v28, 0x3f805bc0, v28
    ds_read_b128 v[152:155], v24 offset:1328
    v_mfma_f32_16x16x32_bf16 v[168:171], v[108:111], v[244:247], v[168:171]
    ds_read_b128 v[156:159], v24 offset:1344
    s_waitcnt lgkmcnt(9)
    v_mfma_f32_16x16x32_bf16 v[168:171], v[112:115], v[248:251], v[168:171]
    v_mfma_f32_16x16x32_bf16 v[168:171], v[116:119], v[252:255], v[168:171]
    v_mul_f32 v160, v160, v28
    v_mul_f32 v161, v161, v28
    v_mul_f32 v162, v162, v28
    v_mul_f32 v163, v163, v28
    v_cvt_pk_bf16_f32 v184, v160, v161
    v_cvt_pk_bf16_f32 v185, v162, v163
    v_and_or_b32 v184, v184, s33, v14
    v_and_or_b32 v185, v185, s33, v14
    v_mfma_f32_16x16x32_bf16 v[172:175], v[120:123], v[236:239], 0
    s_waitcnt lgkmcnt(6)
    v_mfma_f32_16x16x32_bf16 v[172:175], v[124:127], v[240:243], v[172:175]
    v_mfma_f32_16x16x32_bf16 v[172:175], v[128:131], v[244:247], v[172:175]
    v_mfma_f32_16x16x32_bf16 v[172:175], v[132:135], v[248:251], v[172:175]
    s_waitcnt lgkmcnt(3)
    v_mfma_f32_16x16x32_bf16 v[172:175], v[136:139], v[252:255], v[172:175]
    v_mul_f32 v164, v164, v28
    v_mul_f32 v165, v165, v28
    v_mul_f32 v166, v166, v28
    v_mul_f32 v167, v167, v28
    v_cvt_pk_bf16_f32 v186, v164, v165
    v_cvt_pk_bf16_f32 v187, v166, v167
    v_and_or_b32 v186, v186, s33, v14
    v_and_or_b32 v187, v187, s33, v14
    v_mfma_f32_16x16x32_bf16 v[176:179], v[140:143], v[236:239], 0
    v_mfma_f32_16x16x32_bf16 v[176:179], v[144:147], v[240:243], v[176:179]
    s_waitcnt lgkmcnt(0)
    v_mfma_f32_16x16x32_bf16 v[176:179], v[148:151], v[244:247], v[176:179]
    v_mfma_f32_16x16x32_bf16 v[176:179], v[152:155], v[248:251], v[176:179]
    v_mfma_f32_16x16x32_bf16 v[176:179], v[156:159], v[252:255], v[176:179]
    v_mul_f32 v168, v168, v28
    v_mul_f32 v169, v169, v28
    v_mul_f32 v170, v170, v28
    v_mul_f32 v171, v171, v28
    v_cvt_pk_bf16_f32 v188, v168, v169
    v_cvt_pk_bf16_f32 v189, v170, v171
    v_and_or_b32 v188, v188, s33, v14
    v_and_or_b32 v189, v189, s33, v14
    v_mul_f32 v172, v172, v28
    v_mul_f32 v173, v173, v28
    v_mul_f32 v174, v174, v28
    v_mul_f32 v175, v175, v28
    v_cvt_pk_bf16_f32 v190, v172, v173
    v_cvt_pk_bf16_f32 v191, v174, v175
    v_and_or_b32 v190, v190, s33, v14
    v_and_or_b32 v191, v191, s33, v14
    s_nop 0
    v_mul_f32 v176, v176, v28
    v_mul_f32 v177, v177, v28
    v_mul_f32 v178, v178, v28
    v_mul_f32 v179, v179, v28
    v_cvt_pk_bf16_f32 v192, v176, v177
    v_cvt_pk_bf16_f32 v193, v178, v179
    v_and_or_b32 v192, v192, s33, v14
    v_and_or_b32 v193, v193, s33, v14
    buffer_store_dwordx4 v[184:187], v15, s[36:39], s76 offen sc1
    buffer_store_dwordx4 v[188:191], v15, s[36:39], s76 offen offset:1024 sc1
    buffer_store_dwordx2 v[192:193], v16, s[36:39], s76 offen offset:2048 sc1
    s_mov_b64 exec, 1
    buffer_store_byte v10, v25, s[36:39], 0 offen sc1
    s_mov_b64 exec, -1
    v_mov_b32 v30, 35
    ds_write_b32 v18, v30
    s_add_u32 s4, s36, s35
    s_addc_u32 s5, s37, 0
    s_and_b32 s55, s34, 0xff
    s_mul_i32 s55, s55, 0x01010101
    v_and_b32 v29, 15, v1
    v_lshrrev_b32 v30, 4, v1
    v_lshrrev_b32 v28, 2, v29
    v_mad_u32_u24 v28, v30, 20, v28
    v_mul_u32_u24 v28, 160, v28
    v_and_b32 v31, 3, v29
    v_lshl_add_u32 v8, v31, 3, v28
    v_add_u32 v9, 51200, v8
    s_lshl_b32 s50, s41, 2
    s_add_u32 s50, s50, s40
    s_mul_i32 s50, s50, 40960
    s_mul_i32 s51, s42, 160
    s_add_u32 s50, s50, s51
    v_mul_u32_u24 v28, 2560, v29
    v_add_u32 v28, s50, v28
    v_and_b32 v31, 1, v30
    v_lshlrev_b32 v31, 5, v31
    v_lshrrev_b32 v10, 1, v30
    v_lshlrev_b32 v10, 4, v10
    v_add3_u32 v10, v10, v31, v28
    v_lshl_add_u32 v11, v30, 3, v28
    s_bfe_u32 s56, s44, 0x10001
    s_lshl_b32 s58, s56, 2
    s_add_u32 s56, s58, 1
    s_xor_b32 s57, s56, 4
    s_xor_b32 s59, s58, 4
    s_mul_i32 s60, s56, 2560
    s_add_u32 s60, s60, s75
    s_mul_i32 s56, s56, 12800
    s_mul_i32 s61, s57, 2560
    s_add_u32 s61, s61, s75
    s_mul_i32 s57, s57, 12800
    s_mul_i32 s62, s58, 2560
    s_add_u32 s62, s62, s75
    s_mul_i32 s58, s58, 12800
    s_mul_i32 s63, s59, 2560
    s_add_u32 s63, s63, s75
    s_mul_i32 s59, s59, 12800
    s_cmp_ge_u32 s47, 40
    s_cbranch_scc1 WD_158
WF_157:
    ds_read_b32 v28, v17 offset:0
    s_sub_u32 s46, s46, 1
    s_cselect_b32 s46, 0, s46
    s_cbranch_scc1 WD_158
    s_waitcnt lgkmcnt(0)
    v_readfirstlane_b32 s47, v28
    s_cmp_ge_u32 s47, 40
    s_cbranch_scc0 WF_157
WD_158:
    v_add_u32 v9, s56, v8
    ds_read_b64_tr_b16 v[172:173], v9 offset:0
    ds_read_b64_tr_b16 v[174:175], v9 offset:640
    ds_read_b64_tr_b16 v[176:177], v9 offset:32
    ds_read_b64_tr_b16 v[178:179], v9 offset:672
    ds_read_b64_tr_b16 v[180:181], v9 offset:64
    ds_read_b64_tr_b16 v[182:183], v9 offset:704
    ds_read_b64_tr_b16 v[184:185], v9 offset:96
    ds_read_b64_tr_b16 v[186:187], v9 offset:736
    ds_read_b64_tr_b16 v[188:189], v9 offset:128
    ds_read_b64_tr_b16 v[190:191], v9 offset:768
    ds_read_b64_tr_b16 v[192:193], v9 offset:1280
    ds_read_b64_tr_b16 v[194:195], v9 offset:1920
    ds_read_b64_tr_b16 v[196:197], v9 offset:1312
    ds_read_b64_tr_b16 v[198:199], v9 offset:1952
    s_waitcnt lgkmcnt(14)
    ds_read_b64_tr_b16 v[200:201], v9 offset:1344
    s_waitcnt lgkmcnt(14)
    ds_read_b64_tr_b16 v[202:203], v9 offset:1984
    s_waitcnt lgkmcnt(14)
    ds_read_b64_tr_b16 v[204:205], v9 offset:1376
    s_waitcnt lgkmcnt(14)
    ds_read_b64_tr_b16 v[206:207], v9 offset:2016
    s_waitcnt lgkmcnt(14)
    ds_read_b64_tr_b16 v[208:209], v9 offset:1408
    s_waitcnt lgkmcnt(14)
    ds_read_b64_tr_b16 v[210:211], v9 offset:2048
    s_waitcnt lgkmcnt(14)
    ds_read_b64_tr_b16 v[212:213], v9 offset:25600
    s_waitcnt lgkmcnt(14)
    ds_read_b64_tr_b16 v[214:215], v9 offset:26240
    s_waitcnt lgkmcnt(14)
    ds_read_b64_tr_b16 v[216:217], v9 offset:25632
    s_waitcnt lgkmcnt(14)
    ds_read_b64_tr_b16 v[218:219], v9 offset:26272
    s_waitcnt lgkmcnt(14)
    ds_read_b64_tr_b16 v[220:221], v9 offset:25664
    s_waitcnt lgkmcnt(14)
    ds_read_b64_tr_b16 v[222:223], v9 offset:26304
    s_waitcnt lgkmcnt(14)
    ds_read_b64_tr_b16 v[224:225], v9 offset:25696
    s_waitcnt lgkmcnt(14)
    ds_read_b64_tr_b16 v[226:227], v9 offset:26336
    s_waitcnt lgkmcnt(14)
    ds_read_b64_tr_b16 v[228:229], v9 offset:25728
    s_waitcnt lgkmcnt(14)
    ds_read_b64_tr_b16 v[230:231], v9 offset:26368
    s_waitcnt lgkmcnt(14)
    ds_read_b64_tr_b16 v[232:233], v9 offset:26880
    s_waitcnt lgkmcnt(14)
    ds_read_b64_tr_b16 v[234:235], v9 offset:27520
    s_waitcnt lgkmcnt(14)
    ds_read_b64_tr_b16 v[236:237], v9 offset:26912
    s_waitcnt lgkmcnt(14)
    ds_read_b64_tr_b16 v[238:239], v9 offset:27552
    s_waitcnt lgkmcnt(14)
    ds_read_b64_tr_b16 v[240:241], v9 offset:26944
    s_waitcnt lgkmcnt(14)
    ds_read_b64_tr_b16 v[242:243], v9 offset:27584
    s_waitcnt lgkmcnt(14)
    ds_read_b64_tr_b16 v[244:245], v9 offset:26976
    s_waitcnt lgkmcnt(14)
    ds_read_b64_tr_b16 v[246:247], v9 offset:27616
    s_waitcnt lgkmcnt(14)
    ds_read_b64_tr_b16 v[248:249], v9 offset:27008
    s_waitcnt lgkmcnt(14)
    ds_read_b64_tr_b16 v[250:251], v9 offset:27648
HW_159:
    s_load_dwordx2 s[68:69], s[4:5], 0 glc
    s_waitcnt lgkmcnt(0)
    s_sub_u32 s46, s46, 8
    s_cselect_b32 s46, 0, s46
    s_cbranch_scc1 HD_160
    s_xor_b32 s68, s68, s55
    s_xor_b32 s69, s69, s55
    s_or_b32 s68, s68, s69
    s_and_b32 s69, s68, 0xff00ff00
    s_cbranch_scc1 HW_159
HD_160:
    s_branch OQ_161
OP_155:
    v_add_u32 v9, s56, v8
    ds_read_b64_tr_b16 v[172:173], v9 offset:0
    ds_read_b64_tr_b16 v[174:175], v9 offset:640
    ds_read_b64_tr_b16 v[176:177], v9 offset:32
    ds_read_b64_tr_b16 v[178:179], v9 offset:672
    ds_read_b64_tr_b16 v[180:181], v9 offset:64
    ds_read_b64_tr_b16 v[182:183], v9 offset:704
    ds_read_b64_tr_b16 v[184:185], v9 offset:96
    ds_read_b64_tr_b16 v[186:187], v9 offset:736
    ds_read_b64_tr_b16 v[188:189], v9 offset:128
    ds_read_b64_tr_b16 v[190:191], v9 offset:768
    ds_read_b64_tr_b16 v[192:193], v9 offset:1280
    ds_read_b64_tr_b16 v[194:195], v9 offset:1920
    ds_read_b64_tr_b16 v[196:197], v9 offset:1312
    ds_read_b64_tr_b16 v[198:199], v9 offset:1952
    ds_read_b64_tr_b16 v[200:201], v9 offset:1344
    s_waitcnt lgkmcnt(14)
    ds_read_b64_tr_b16 v[202:203], v9 offset:1984
    s_waitcnt lgkmcnt(14)
    ds_read_b64_tr_b16 v[204:205], v9 offset:1376
    s_waitcnt lgkmcnt(14)
    ds_read_b64_tr_b16 v[206:207], v9 offset:2016
    s_waitcnt lgkmcnt(14)
    ds_read_b64_tr_b16 v[208:209], v9 offset:1408
    s_waitcnt lgkmcnt(14)
    ds_read_b64_tr_b16 v[210:211], v9 offset:2048
    s_waitcnt lgkmcnt(14)
    ds_read_b64_tr_b16 v[212:213], v9 offset:25600
    s_waitcnt lgkmcnt(14)
    ds_read_b64_tr_b16 v[214:215], v9 offset:26240
    s_waitcnt lgkmcnt(14)
    ds_read_b64_tr_b16 v[216:217], v9 offset:25632
    s_waitcnt lgkmcnt(14)
    ds_read_b64_tr_b16 v[218:219], v9 offset:26272
    s_waitcnt lgkmcnt(14)
    ds_read_b64_tr_b16 v[220:221], v9 offset:25664
    s_waitcnt lgkmcnt(14)
    ds_read_b64_tr_b16 v[222:223], v9 offset:26304
    s_waitcnt lgkmcnt(14)
    ds_read_b64_tr_b16 v[224:225], v9 offset:25696
    s_waitcnt lgkmcnt(14)
    ds_read_b64_tr_b16 v[226:227], v9 offset:26336
    s_waitcnt lgkmcnt(14)
    ds_read_b64_tr_b16 v[228:229], v9 offset:25728
    s_waitcnt lgkmcnt(14)
    ds_read_b64_tr_b16 v[230:231], v9 offset:26368
    s_waitcnt lgkmcnt(14)
    ds_read_b64_tr_b16 v[232:233], v9 offset:26880
    s_waitcnt lgkmcnt(14)
    ds_read_b64_tr_b16 v[234:235], v9 offset:27520
    s_waitcnt lgkmcnt(14)
    ds_read_b64_tr_b16 v[236:237], v9 offset:26912
    s_waitcnt lgkmcnt(14)
    ds_read_b64_tr_b16 v[238:239], v9 offset:27552
    s_waitcnt lgkmcnt(14)
    ds_read_b64_tr_b16 v[240:241], v9 offset:26944
    s_waitcnt lgkmcnt(14)
    ds_read_b64_tr_b16 v[242:243], v9 offset:27584
    s_waitcnt lgkmcnt(14)
    ds_read_b64_tr_b16 v[244:245], v9 offset:26976
    s_waitcnt lgkmcnt(14)
    ds_read_b64_tr_b16 v[246:247], v9 offset:27616
    s_waitcnt lgkmcnt(14)
    ds_read_b64_tr_b16 v[248:249], v9 offset:27008
    s_waitcnt lgkmcnt(14)
    ds_read_b64_tr_b16 v[250:251], v9 offset:27648
    s_waitcnt lgkmcnt(0)
OQ_161:
    s_add_u32 s50, s60, 0
    buffer_load_dwordx4 v[32:35], v15, s[36:39], s50 offen sc1
    buffer_load_dwordx4 v[36:39], v15, s[36:39], s50 offen offset:1024 sc1
    buffer_load_dwordx2 v[96:97], v16, s[36:39], s50 offen offset:2048 sc1
    s_add_u32 s50, s60, 5120
    buffer_load_dwordx4 v[40:43], v15, s[36:39], s50 offen sc1
    buffer_load_dwordx4 v[44:47], v15, s[36:39], s50 offen offset:1024 sc1
    buffer_load_dwordx2 v[98:99], v16, s[36:39], s50 offen offset:2048 sc1
    s_add_u32 s50, s61, 0
    buffer_load_dwordx4 v[48:51], v15, s[36:39], s50 offen sc1
    buffer_load_dwordx4 v[52:55], v15, s[36:39], s50 offen offset:1024 sc1
    buffer_load_dwordx2 v[100:101], v16, s[36:39], s50 offen offset:2048 sc1
    s_add_u32 s50, s61, 5120
    buffer_load_dwordx4 v[56:59], v15, s[36:39], s50 offen sc1
    buffer_load_dwordx4 v[60:63], v15, s[36:39], s50 offen offset:1024 sc1
    buffer_load_dwordx2 v[102:103], v16, s[36:39], s50 offen offset:2048 sc1
    v_mov_b32 v12, 0
    v_mov_b32 v13, 0
    s_waitcnt vmcnt(9)
    v_xor_b32 v32, s32, v32
    v_xor_b32 v33, s32, v33
    v_xor_b32 v34, s32, v34
    v_xor_b32 v35, s32, v35
    v_xor_b32 v36, s32, v36
    v_xor_b32 v37, s32, v37
    v_xor_b32 v38, s32, v38
    v_xor_b32 v39, s32, v39
    v_xor_b32 v96, s32, v96
    v_xor_b32 v97, s32, v97
    v_or3_b32 v12, v12, v32, v33
    v_or3_b32 v13, v13, v34, v35
    v_or3_b32 v12, v12, v36, v37
    v_or3_b32 v13, v13, v38, v39
    v_or3_b32 v12, v12, v96, v97
    v_mfma_f32_16x16x32_bf16 v[112:115], v[172:175], v[32:35], 0
    ds_read_b64_tr_b16 v[132:133], v9 offset:2560
    ds_read_b64_tr_b16 v[134:135], v9 offset:28160
    v_mfma_f32_16x16x32_bf16 v[116:119], v[176:179], v[32:35], 0
    ds_read_b64_tr_b16 v[136:137], v9 offset:2592
    ds_read_b64_tr_b16 v[138:139], v9 offset:28192
    v_mfma_f32_16x16x32_bf16 v[120:123], v[180:183], v[32:35], 0
    ds_read_b64_tr_b16 v[140:141], v9 offset:2624
    ds_read_b64_tr_b16 v[142:143], v9 offset:28224
    v_mfma_f32_16x16x32_bf16 v[124:127], v[184:187], v[32:35], 0
    ds_read_b64_tr_b16 v[144:145], v9 offset:2656
    ds_read_b64_tr_b16 v[146:147], v9 offset:28256
    v_mfma_f32_16x16x32_bf16 v[128:131], v[188:191], v[32:35], 0
    ds_read_b64_tr_b16 v[148:149], v9 offset:2688
    ds_read_b64_tr_b16 v[150:151], v9 offset:28288
    v_mfma_f32_16x16x32_bf16 v[112:115], v[192:195], v[36:39], v[112:115]
    v_add_u32 v2, s57, v8
    ds_read_b64_tr_b16 v[152:153], v2 offset:0
    ds_read_b64_tr_b16 v[154:155], v2 offset:640
    v_mfma_f32_16x16x32_bf16 v[116:119], v[196:199], v[36:39], v[116:119]
    ds_read_b64_tr_b16 v[156:157], v2 offset:32
    ds_read_b64_tr_b16 v[158:159], v2 offset:672
    v_mfma_f32_16x16x32_bf16 v[120:123], v[200:203], v[36:39], v[120:123]
    ds_read_b64_tr_b16 v[160:161], v2 offset:64
    s_waitcnt lgkmcnt(14)
    ds_read_b64_tr_b16 v[162:163], v2 offset:704
    v_mfma_f32_16x16x32_bf16 v[124:127], v[204:207], v[36:39], v[124:127]
    s_waitcnt lgkmcnt(14)
    ds_read_b64_tr_b16 v[164:165], v2 offset:96
    s_waitcnt lgkmcnt(14)
    ds_read_b64_tr_b16 v[166:167], v2 offset:736
    v_mfma_f32_16x16x32_bf16 v[128:131], v[208:211], v[36:39], v[128:131]
    s_waitcnt lgkmcnt(14)
    ds_read_b64_tr_b16 v[168:169], v2 offset:128
    s_waitcnt lgkmcnt(14)
    ds_read_b64_tr_b16 v[170:171], v2 offset:768
    s_waitcnt vmcnt(6)
    v_xor_b32 v40, s32, v40
    v_xor_b32 v41, s32, v41
    v_xor_b32 v42, s32, v42
    v_xor_b32 v43, s32, v43
    v_xor_b32 v44, s32, v44
    v_xor_b32 v45, s32, v45
    v_xor_b32 v46, s32, v46
    v_xor_b32 v47, s32, v47
    v_xor_b32 v98, s32, v98
    v_xor_b32 v99, s32, v99
    v_or3_b32 v12, v12, v40, v41
    v_or3_b32 v13, v13, v42, v43
    v_or3_b32 v12, v12, v44, v45
    v_or3_b32 v13, v13, v46, v47
    v_or3_b32 v12, v12, v98, v99
    v_mfma_f32_16x16x32_bf16 v[112:115], v[212:215], v[40:43], v[112:115]
    v_mfma_f32_16x16x32_bf16 v[116:119], v[216:219], v[40:43], v[116:119]
    v_mfma_f32_16x16x32_bf16 v[120:123], v[220:223], v[40:43], v[120:123]
    v_mfma_f32_16x16x32_bf16 v[124:127], v[224:227], v[40:43], v[124:127]
    v_mfma_f32_16x16x32_bf16 v[128:131], v[228:231], v[40:43], v[128:131]
    v_mfma_f32_16x16x32_bf16 v[112:115], v[232:235], v[44:47], v[112:115]
    v_mfma_f32_16x16x32_bf16 v[116:119], v[236:239], v[44:47], v[116:119]
    v_mfma_f32_16x16x32_bf16 v[120:123], v[240:243], v[44:47], v[120:123]
    v_mfma_f32_16x16x32_bf16 v[124:127], v[244:247], v[44:47], v[124:127]
    v_mfma_f32_16x16x32_bf16 v[128:131], v[248:251], v[44:47], v[128:131]
    v_mfma_f32_16x16x32_bf16 v[112:115], v[132:135], v[96:99], v[112:115]
    v_mfma_f32_16x16x32_bf16 v[116:119], v[136:139], v[96:99], v[116:119]
    s_waitcnt lgkmcnt(12)
    v_mfma_f32_16x16x32_bf16 v[120:123], v[140:143], v[96:99], v[120:123]
    v_mfma_f32_16x16x32_bf16 v[124:127], v[144:147], v[96:99], v[124:127]
    ds_read_b64_tr_b16 v[132:133], v2 offset:1280
    ds_read_b64_tr_b16 v[134:135], v2 offset:1920
    s_waitcnt lgkmcnt(10)
    v_mfma_f32_16x16x32_bf16 v[128:131], v[148:151], v[96:99], v[128:131]
    ds_read_b64_tr_b16 v[136:137], v2 offset:1312
    ds_read_b64_tr_b16 v[138:139], v2 offset:1952
    s_waitcnt vmcnt(3)
    v_xor_b32 v48, s32, v48
    v_xor_b32 v49, s32, v49
    v_xor_b32 v50, s32, v50
    v_xor_b32 v51, s32, v51
    v_xor_b32 v52, s32, v52
    v_xor_b32 v53, s32, v53
    v_xor_b32 v54, s32, v54
    v_xor_b32 v55, s32, v55
    v_xor_b32 v100, s32, v100
    v_xor_b32 v101, s32, v101
    v_or3_b32 v12, v12, v48, v49
    v_or3_b32 v13, v13, v50, v51
    v_or3_b32 v12, v12, v52, v53
    v_or3_b32 v13, v13, v54, v55
    v_or3_b32 v12, v12, v100, v101
    v_mfma_f32_16x16x32_bf16 v[112:115], v[152:155], v[48:51], v[112:115]
    ds_read_b64_tr_b16 v[140:141], v2 offset:1344
    ds_read_b64_tr_b16 v[142:143], v2 offset:1984
    s_waitcnt lgkmcnt(10)
    v_mfma_f32_16x16x32_bf16 v[116:119], v[156:159], v[48:51], v[116:119]
    ds_read_b64_tr_b16 v[144:145], v2 offset:1376
    ds_read_b64_tr_b16 v[146:147], v2 offset:2016
    v_mfma_f32_16x16x32_bf16 v[120:123], v[160:163], v[48:51], v[120:123]
    ds_read_b64_tr_b16 v[148:149], v2 offset:1408
    ds_read_b64_tr_b16 v[150:151], v2 offset:2048
    s_waitcnt lgkmcnt(10)
    v_mfma_f32_16x16x32_bf16 v[124:127], v[164:167], v[48:51], v[124:127]
    ds_read_b64_tr_b16 v[152:153], v2 offset:25600
    ds_read_b64_tr_b16 v[154:155], v2 offset:26240
    v_mfma_f32_16x16x32_bf16 v[128:131], v[168:171], v[48:51], v[128:131]
    ds_read_b64_tr_b16 v[156:157], v2 offset:25632
    ds_read_b64_tr_b16 v[158:159], v2 offset:26272
    s_waitcnt lgkmcnt(10)
    v_mfma_f32_16x16x32_bf16 v[112:115], v[132:135], v[52:55], v[112:115]
    ds_read_b64_tr_b16 v[160:161], v2 offset:25664
    ds_read_b64_tr_b16 v[162:163], v2 offset:26304
    v_mfma_f32_16x16x32_bf16 v[116:119], v[136:139], v[52:55], v[116:119]
    ds_read_b64_tr_b16 v[164:165], v2 offset:25696
    ds_read_b64_tr_b16 v[166:167], v2 offset:26336
    s_waitcnt lgkmcnt(10)
    v_mfma_f32_16x16x32_bf16 v[120:123], v[140:143], v[52:55], v[120:123]
    ds_read_b64_tr_b16 v[168:169], v2 offset:25728
    ds_read_b64_tr_b16 v[170:171], v2 offset:26368
    v_mfma_f32_16x16x32_bf16 v[124:127], v[144:147], v[52:55], v[124:127]
    ds_read_b64_tr_b16 v[132:133], v2 offset:26880
    ds_read_b64_tr_b16 v[134:135], v2 offset:27520
    s_waitcnt lgkmcnt(10)
    v_mfma_f32_16x16x32_bf16 v[128:131], v[148:151], v[52:55], v[128:131]
    ds_read_b64_tr_b16 v[136:137], v2 offset:26912
    ds_read_b64_tr_b16 v[138:139], v2 offset:27552
    s_waitcnt vmcnt(0)
    s_cmp_eq_u32 s68, 0
    s_cbranch_scc1 HS_162
HW_163:
    s_load_dwordx2 s[68:69], s[4:5], 0 glc
    s_waitcnt lgkmcnt(0)
    s_sub_u32 s46, s46, 8
    s_cselect_b32 s46, 0, s46
    s_cbranch_scc1 HD_164
    s_xor_b32 s68, s68, s55
    s_xor_b32 s69, s69, s55
    s_or_b32 s68, s68, s69
    s_and_b32 s69, s68, 0xffffffff
    s_cbranch_scc1 HW_163
HD_164:
HS_162:
    s_add_u32 s50, s62, 0
    buffer_load_dwordx4 v[64:67], v15, s[36:39], s50 offen sc1
    buffer_load_dwordx4 v[68:71], v15, s[36:39], s50 offen offset:1024 sc1
    buffer_load_dwordx2 v[104:105], v16, s[36:39], s50 offen offset:2048 sc1
    s_add_u32 s50, s62, 5120
    buffer_load_dwordx4 v[72:75], v15, s[36:39], s50 offen sc1
    buffer_load_dwordx4 v[76:79], v15, s[36:39], s50 offen offset:1024 sc1
    buffer_load_dwordx2 v[106:107], v16, s[36:39], s50 offen offset:2048 sc1
    s_add_u32 s50, s63, 0
    buffer_load_dwordx4 v[80:83], v15, s[36:39], s50 offen sc1
    buffer_load_dwordx4 v[84:87], v15, s[36:39], s50 offen offset:1024 sc1
    buffer_load_dwordx2 v[108:109], v16, s[36:39], s50 offen offset:2048 sc1
    s_add_u32 s50, s63, 5120
    buffer_load_dwordx4 v[88:91], v15, s[36:39], s50 offen sc1
    buffer_load_dwordx4 v[92:95], v15, s[36:39], s50 offen offset:1024 sc1
    buffer_load_dwordx2 v[110:111], v16, s[36:39], s50 offen offset:2048 sc1
    v_xor_b32 v56, s32, v56
    v_xor_b32 v57, s32, v57
    v_xor_b32 v58, s32, v58
    v_xor_b32 v59, s32, v59
    v_xor_b32 v60, s32, v60
    v_xor_b32 v61, s32, v61
    v_xor_b32 v62, s32, v62
    v_xor_b32 v63, s32, v63
    v_xor_b32 v102, s32, v102
    v_xor_b32 v103, s32, v103
    v_or3_b32 v12, v12, v56, v57
    v_or3_b32 v13, v13, v58, v59
    v_or3_b32 v12, v12, v60, v61
    v_or3_b32 v13, v13, v62, v63
    v_or3_b32 v12, v12, v102, v103
    v_mfma_f32_16x16x32_bf16 v[112:115], v[152:155], v[56:59], v[112:115]
    ds_read_b64_tr_b16 v[140:141], v2 offset:26944
    ds_read_b64_tr_b16 v[142:143], v2 offset:27584
    s_waitcnt lgkmcnt(10)
    v_mfma_f32_16x16x32_bf16 v[116:119], v[156:159], v[56:59], v[116:119]
    ds_read_b64_tr_b16 v[144:145], v2 offset:26976
    ds_read_b64_tr_b16 v[146:147], v2 offset:27616
    v_mfma_f32_16x16x32_bf16 v[120:123], v[160:163], v[56:59], v[120:123]
    ds_read_b64_tr_b16 v[148:149], v2 offset:27008
    ds_read_b64_tr_b16 v[150:151], v2 offset:27648
    s_waitcnt lgkmcnt(10)
    v_mfma_f32_16x16x32_bf16 v[124:127], v[164:167], v[56:59], v[124:127]
    ds_read_b64_tr_b16 v[152:153], v2 offset:2560
    ds_read_b64_tr_b16 v[154:155], v2 offset:28160
    v_mfma_f32_16x16x32_bf16 v[128:131], v[168:171], v[56:59], v[128:131]
    ds_read_b64_tr_b16 v[156:157], v2 offset:2592
    ds_read_b64_tr_b16 v[158:159], v2 offset:28192
    s_waitcnt lgkmcnt(10)
    v_mfma_f32_16x16x32_bf16 v[112:115], v[132:135], v[60:63], v[112:115]
    ds_read_b64_tr_b16 v[160:161], v2 offset:2624
    ds_read_b64_tr_b16 v[162:163], v2 offset:28224
    v_mfma_f32_16x16x32_bf16 v[116:119], v[136:139], v[60:63], v[116:119]
    ds_read_b64_tr_b16 v[164:165], v2 offset:2656
    ds_read_b64_tr_b16 v[166:167], v2 offset:28256
    s_waitcnt lgkmcnt(10)
    v_mfma_f32_16x16x32_bf16 v[120:123], v[140:143], v[60:63], v[120:123]
    ds_read_b64_tr_b16 v[168:169], v2 offset:2688
    ds_read_b64_tr_b16 v[170:171], v2 offset:28288
    v_mfma_f32_16x16x32_bf16 v[124:127], v[144:147], v[60:63], v[124:127]
    v_add_u32 v9, s58, v8
    ds_read_b64_tr_b16 v[132:133], v9 offset:0
    ds_read_b64_tr_b16 v[134:135], v9 offset:640
    s_waitcnt lgkmcnt(10)
    v_mfma_f32_16x16x32_bf16 v[128:131], v[148:151], v[60:63], v[128:131]
    ds_read_b64_tr_b16 v[136:137], v9 offset:32
    ds_read_b64_tr_b16 v[138:139], v9 offset:672
    v_mfma_f32_16x16x32_bf16 v[112:115], v[152:155], v[100:103], v[112:115]
    ds_read_b64_tr_b16 v[140:141], v9 offset:64
    ds_read_b64_tr_b16 v[142:143], v9 offset:704
    s_waitcnt lgkmcnt(10)
    v_mfma_f32_16x16x32_bf16 v[116:119], v[156:159], v[100:103], v[116:119]
    ds_read_b64_tr_b16 v[144:145], v9 offset:96
    ds_read_b64_tr_b16 v[146:147], v9 offset:736
    v_mfma_f32_16x16x32_bf16 v[120:123], v[160:163], v[100:103], v[120:123]
    ds_read_b64_tr_b16 v[148:149], v9 offset:128
    ds_read_b64_tr_b16 v[150:151], v9 offset:768
    s_waitcnt lgkmcnt(10)
    v_mfma_f32_16x16x32_bf16 v[124:127], v[164:167], v[100:103], v[124:127]
    ds_read_b64_tr_b16 v[152:153], v9 offset:1280
    ds_read_b64_tr_b16 v[154:155], v9 offset:1920
    v_mfma_f32_16x16x32_bf16 v[128:131], v[168:171], v[100:103], v[128:131]
    ds_read_b64_tr_b16 v[156:157], v9 offset:1312
    ds_read_b64_tr_b16 v[158:159], v9 offset:1952
    s_waitcnt vmcnt(9)
    v_xor_b32 v64, s32, v64
    v_xor_b32 v65, s32, v65
    v_xor_b32 v66, s32, v66
    v_xor_b32 v67, s32, v67
    v_xor_b32 v68, s32, v68
    v_xor_b32 v69, s32, v69
    v_xor_b32 v70, s32, v70
    v_xor_b32 v71, s32, v71
    v_xor_b32 v104, s32, v104
    v_xor_b32 v105, s32, v105
    v_or3_b32 v12, v12, v64, v65
    v_or3_b32 v13, v13, v66, v67
    v_or3_b32 v12, v12, v68, v69
    v_or3_b32 v13, v13, v70, v71
    v_or3_b32 v12, v12, v104, v105
    s_waitcnt lgkmcnt(10)
    v_mfma_f32_16x16x32_bf16 v[112:115], v[132:135], v[64:67], v[112:115]
    ds_read_b64_tr_b16 v[160:161], v9 offset:1344
    ds_read_b64_tr_b16 v[162:163], v9 offset:1984
    v_mfma_f32_16x16x32_bf16 v[116:119], v[136:139], v[64:67], v[116:119]
    ds_read_b64_tr_b16 v[164:165], v9 offset:1376
    ds_read_b64_tr_b16 v[166:167], v9 offset:2016
    s_waitcnt lgkmcnt(10)
    v_mfma_f32_16x16x32_bf16 v[120:123], v[140:143], v[64:67], v[120:123]
    ds_read_b64_tr_b16 v[168:169], v9 offset:1408
    ds_read_b64_tr_b16 v[170:171], v9 offset:2048
    v_mfma_f32_16x16x32_bf16 v[124:127], v[144:147], v[64:67], v[124:127]
    ds_read_b64_tr_b16 v[132:133], v9 offset:25600
    ds_read_b64_tr_b16 v[134:135], v9 offset:26240
    s_waitcnt lgkmcnt(10)
    v_mfma_f32_16x16x32_bf16 v[128:131], v[148:151], v[64:67], v[128:131]
    ds_read_b64_tr_b16 v[136:137], v9 offset:25632
    ds_read_b64_tr_b16 v[138:139], v9 offset:26272
    v_mfma_f32_16x16x32_bf16 v[112:115], v[152:155], v[68:71], v[112:115]
    ds_read_b64_tr_b16 v[140:141], v9 offset:25664
    ds_read_b64_tr_b16 v[142:143], v9 offset:26304
    s_waitcnt lgkmcnt(10)
    v_mfma_f32_16x16x32_bf16 v[116:119], v[156:159], v[68:71], v[116:119]
    ds_read_b64_tr_b16 v[144:145], v9 offset:25696
    ds_read_b64_tr_b16 v[146:147], v9 offset:26336
    v_mfma_f32_16x16x32_bf16 v[120:123], v[160:163], v[68:71], v[120:123]
    ds_read_b64_tr_b16 v[148:149], v9 offset:25728
    ds_read_b64_tr_b16 v[150:151], v9 offset:26368
    s_waitcnt lgkmcnt(10)
    v_mfma_f32_16x16x32_bf16 v[124:127], v[164:167], v[68:71], v[124:127]
    ds_read_b64_tr_b16 v[152:153], v9 offset:26880
    ds_read_b64_tr_b16 v[154:155], v9 offset:27520
    v_mfma_f32_16x16x32_bf16 v[128:131], v[168:171], v[68:71], v[128:131]
    ds_read_b64_tr_b16 v[156:157], v9 offset:26912
    ds_read_b64_tr_b16 v[158:159], v9 offset:27552
    s_waitcnt vmcnt(6)
    v_xor_b32 v72, s32, v72
    v_xor_b32 v73, s32, v73
    v_xor_b32 v74, s32, v74
    v_xor_b32 v75, s32, v75
    v_xor_b32 v76, s32, v76
    v_xor_b32 v77, s32, v77
    v_xor_b32 v78, s32, v78
    v_xor_b32 v79, s32, v79
    v_xor_b32 v106, s32, v106
    v_xor_b32 v107, s32, v107
    v_or3_b32 v12, v12, v72, v73
    v_or3_b32 v13, v13, v74, v75
    v_or3_b32 v12, v12, v76, v77
    v_or3_b32 v13, v13, v78, v79
    v_or3_b32 v12, v12, v106, v107
    s_waitcnt lgkmcnt(10)
    v_mfma_f32_16x16x32_bf16 v[112:115], v[132:135], v[72:75], v[112:115]
    ds_read_b64_tr_b16 v[160:161], v9 offset:26944
    ds_read_b64_tr_b16 v[162:163], v9 offset:27584
    v_mfma_f32_16x16x32_bf16 v[116:119], v[136:139], v[72:75], v[116:119]
    ds_read_b64_tr_b16 v[164:165], v9 offset:26976
    ds_read_b64_tr_b16 v[166:167], v9 offset:27616
    s_waitcnt lgkmcnt(10)
    v_mfma_f32_16x16x32_bf16 v[120:123], v[140:143], v[72:75], v[120:123]
    ds_read_b64_tr_b16 v[168:169], v9 offset:27008
    ds_read_b64_tr_b16 v[170:171], v9 offset:27648
    v_mfma_f32_16x16x32_bf16 v[124:127], v[144:147], v[72:75], v[124:127]
    ds_read_b64_tr_b16 v[132:133], v9 offset:2560
    ds_read_b64_tr_b16 v[134:135], v9 offset:28160
    s_waitcnt lgkmcnt(10)
    v_mfma_f32_16x16x32_bf16 v[128:131], v[148:151], v[72:75], v[128:131]
    ds_read_b64_tr_b16 v[136:137], v9 offset:2592
    ds_read_b64_tr_b16 v[138:139], v9 offset:28192
    v_mfma_f32_16x16x32_bf16 v[112:115], v[152:155], v[76:79], v[112:115]
    ds_read_b64_tr_b16 v[140:141], v9 offset:2624
    ds_read_b64_tr_b16 v[142:143], v9 offset:28224
    s_waitcnt lgkmcnt(10)
    v_mfma_f32_16x16x32_bf16 v[116:119], v[156:159], v[76:79], v[116:119]
    ds_read_b64_tr_b16 v[144:145], v9 offset:2656
    ds_read_b64_tr_b16 v[146:147], v9 offset:28256
    v_mfma_f32_16x16x32_bf16 v[120:123], v[160:163], v[76:79], v[120:123]
    ds_read_b64_tr_b16 v[148:149], v9 offset:2688
    ds_read_b64_tr_b16 v[150:151], v9 offset:28288
    s_waitcnt lgkmcnt(10)
    v_mfma_f32_16x16x32_bf16 v[124:127], v[164:167], v[76:79], v[124:127]
    v_add_u32 v2, s59, v8
    ds_read_b64_tr_b16 v[152:153], v2 offset:0
    ds_read_b64_tr_b16 v[154:155], v2 offset:640
    v_mfma_f32_16x16x32_bf16 v[128:131], v[168:171], v[76:79], v[128:131]
    ds_read_b64_tr_b16 v[156:157], v2 offset:32
    ds_read_b64_tr_b16 v[158:159], v2 offset:672
    s_waitcnt lgkmcnt(10)
    v_mfma_f32_16x16x32_bf16 v[112:115], v[132:135], v[104:107], v[112:115]
    ds_read_b64_tr_b16 v[160:161], v2 offset:64
    ds_read_b64_tr_b16 v[162:163], v2 offset:704
    v_mfma_f32_16x16x32_bf16 v[116:119], v[136:139], v[104:107], v[116:119]
    ds_read_b64_tr_b16 v[164:165], v2 offset:96
    ds_read_b64_tr_b16 v[166:167], v2 offset:736
    s_waitcnt lgkmcnt(10)
    v_mfma_f32_16x16x32_bf16 v[120:123], v[140:143], v[104:107], v[120:123]
    ds_read_b64_tr_b16 v[168:169], v2 offset:128
    ds_read_b64_tr_b16 v[170:171], v2 offset:768
    v_mfma_f32_16x16x32_bf16 v[124:127], v[144:147], v[104:107], v[124:127]
    ds_read_b64_tr_b16 v[132:133], v2 offset:1280
    ds_read_b64_tr_b16 v[134:135], v2 offset:1920
    s_waitcnt lgkmcnt(10)
    v_mfma_f32_16x16x32_bf16 v[128:131], v[148:151], v[104:107], v[128:131]
    ds_read_b64_tr_b16 v[136:137], v2 offset:1312
    ds_read_b64_tr_b16 v[138:139], v2 offset:1952
    s_waitcnt vmcnt(3)
    v_xor_b32 v80, s32, v80
    v_xor_b32 v81, s32, v81
    v_xor_b32 v82, s32, v82
    v_xor_b32 v83, s32, v83
    v_xor_b32 v84, s32, v84
    v_xor_b32 v85, s32, v85
    v_xor_b32 v86, s32, v86
    v_xor_b32 v87, s32, v87
    v_xor_b32 v108, s32, v108
    v_xor_b32 v109, s32, v109
    v_or3_b32 v12, v12, v80, v81
    v_or3_b32 v13, v13, v82, v83
    v_or3_b32 v12, v12, v84, v85
    v_or3_b32 v13, v13, v86, v87
    v_or3_b32 v12, v12, v108, v109
    v_mfma_f32_16x16x32_bf16 v[112:115], v[152:155], v[80:83], v[112:115]
    ds_read_b64_tr_b16 v[140:141], v2 offset:1344
    ds_read_b64_tr_b16 v[142:143], v2 offset:1984
    s_waitcnt lgkmcnt(10)
    v_mfma_f32_16x16x32_bf16 v[116:119], v[156:159], v[80:83], v[116:119]
    ds_read_b64_tr_b16 v[144:145], v2 offset:1376
    ds_read_b64_tr_b16 v[146:147], v2 offset:2016
    v_mfma_f32_16x16x32_bf16 v[120:123], v[160:163], v[80:83], v[120:123]
    ds_read_b64_tr_b16 v[148:149], v2 offset:1408
    ds_read_b64_tr_b16 v[150:151], v2 offset:2048
    s_waitcnt lgkmcnt(10)
    v_mfma_f32_16x16x32_bf16 v[124:127], v[164:167], v[80:83], v[124:127]
    ds_read_b64_tr_b16 v[152:153], v2 offset:25600
    ds_read_b64_tr_b16 v[154:155], v2 offset:26240
    v_mfma_f32_16x16x32_bf16 v[128:131], v[168:171], v[80:83], v[128:131]
    ds_read_b64_tr_b16 v[156:157], v2 offset:25632
    ds_read_b64_tr_b16 v[158:159], v2 offset:26272
    s_waitcnt lgkmcnt(10)
    v_mfma_f32_16x16x32_bf16 v[112:115], v[132:135], v[84:87], v[112:115]
    ds_read_b64_tr_b16 v[160:161], v2 offset:25664
    ds_read_b64_tr_b16 v[162:163], v2 offset:26304
    v_mfma_f32_16x16x32_bf16 v[116:119], v[136:139], v[84:87], v[116:119]
    ds_read_b64_tr_b16 v[164:165], v2 offset:25696
    ds_read_b64_tr_b16 v[166:167], v2 offset:26336
    s_waitcnt lgkmcnt(10)
    v_mfma_f32_16x16x32_bf16 v[120:123], v[140:143], v[84:87], v[120:123]
    ds_read_b64_tr_b16 v[168:169], v2 offset:25728
    ds_read_b64_tr_b16 v[170:171], v2 offset:26368
    v_mfma_f32_16x16x32_bf16 v[124:127], v[144:147], v[84:87], v[124:127]
    ds_read_b64_tr_b16 v[132:133], v2 offset:26880
    ds_read_b64_tr_b16 v[134:135], v2 offset:27520
    s_waitcnt lgkmcnt(10)
    v_mfma_f32_16x16x32_bf16 v[128:131], v[148:151], v[84:87], v[128:131]
    ds_read_b64_tr_b16 v[136:137], v2 offset:26912
    ds_read_b64_tr_b16 v[138:139], v2 offset:27552
    s_waitcnt vmcnt(0)
    v_xor_b32 v88, s32, v88
    v_xor_b32 v89, s32, v89
    v_xor_b32 v90, s32, v90
    v_xor_b32 v91, s32, v91
    v_xor_b32 v92, s32, v92
    v_xor_b32 v93, s32, v93
    v_xor_b32 v94, s32, v94
    v_xor_b32 v95, s32, v95
    v_xor_b32 v110, s32, v110
    v_xor_b32 v111, s32, v111
    v_or3_b32 v12, v12, v88, v89
    v_or3_b32 v13, v13, v90, v91
    v_or3_b32 v12, v12, v92, v93
    v_or3_b32 v13, v13, v94, v95
    v_or3_b32 v12, v12, v110, v111
    v_mfma_f32_16x16x32_bf16 v[112:115], v[152:155], v[88:91], v[112:115]
    ds_read_b64_tr_b16 v[140:141], v2 offset:26944
    ds_read_b64_tr_b16 v[142:143], v2 offset:27584
    s_waitcnt lgkmcnt(10)
    v_mfma_f32_16x16x32_bf16 v[116:119], v[156:159], v[88:91], v[116:119]
    ds_read_b64_tr_b16 v[144:145], v2 offset:26976
    ds_read_b64_tr_b16 v[146:147], v2 offset:27616
    v_mfma_f32_16x16x32_bf16 v[120:123], v[160:163], v[88:91], v[120:123]
    ds_read_b64_tr_b16 v[148:149], v2 offset:27008
    ds_read_b64_tr_b16 v[150:151], v2 offset:27648
    s_waitcnt lgkmcnt(10)
    v_mfma_f32_16x16x32_bf16 v[124:127], v[164:167], v[88:91], v[124:127]
    ds_read_b64_tr_b16 v[152:153], v2 offset:2560
    ds_read_b64_tr_b16 v[154:155], v2 offset:28160
    v_mfma_f32_16x16x32_bf16 v[128:131], v[168:171], v[88:91], v[128:131]
    ds_read_b64_tr_b16 v[156:157], v2 offset:2592
    ds_read_b64_tr_b16 v[158:159], v2 offset:28192
    s_waitcnt lgkmcnt(10)
    v_mfma_f32_16x16x32_bf16 v[112:115], v[132:135], v[92:95], v[112:115]
    ds_read_b64_tr_b16 v[160:161], v2 offset:2624
    ds_read_b64_tr_b16 v[162:163], v2 offset:28224
    v_mfma_f32_16x16x32_bf16 v[116:119], v[136:139], v[92:95], v[116:119]
    ds_read_b64_tr_b16 v[164:165], v2 offset:2656
    ds_read_b64_tr_b16 v[166:167], v2 offset:28256
    s_waitcnt lgkmcnt(10)
    v_mfma_f32_16x16x32_bf16 v[120:123], v[140:143], v[92:95], v[120:123]
    ds_read_b64_tr_b16 v[168:169], v2 offset:2688
    ds_read_b64_tr_b16 v[170:171], v2 offset:28288
    v_mfma_f32_16x16x32_bf16 v[124:127], v[144:147], v[92:95], v[124:127]
    s_waitcnt lgkmcnt(8)
    v_mfma_f32_16x16x32_bf16 v[128:131], v[148:151], v[92:95], v[128:131]
    v_mfma_f32_16x16x32_bf16 v[112:115], v[152:155], v[108:111], v[112:115]
    s_waitcnt lgkmcnt(4)
    v_mfma_f32_16x16x32_bf16 v[116:119], v[156:159], v[108:111], v[116:119]
    v_mfma_f32_16x16x32_bf16 v[120:123], v[160:163], v[108:111], v[120:123]
    s_waitcnt lgkmcnt(0)
    v_mfma_f32_16x16x32_bf16 v[124:127], v[164:167], v[108:111], v[124:127]
    v_mfma_f32_16x16x32_bf16 v[128:131], v[168:171], v[108:111], v[128:131]
    v_or_b32 v12, v12, v13
    v_and_b32 v12, 0x10001, v12
    v_cmp_ne_u32 vcc, 0, v12
    s_sub_u32 s46, s46, 64
    s_cselect_b32 s46, 0, s46
    s_cbranch_scc1 OD_156
    s_cbranch_vccnz OP_155
OD_156:
    s_add_u32 s50, s2, s40
    s_cmp_eq_u32 s50, 0
    s_cbranch_scc0 EP_165
    v_mov_b32 v28, 9371648
    v_mov_b32 v29, s34
    s_mov_b64 exec, 1
    buffer_store_dword v29, v28, s[36:39], 0 offen sc1
    s_mov_b64 exec, -1
EP_165:
    s_nop 1
    v_cvt_pk_bf16_f32 v172, v112, v113
    v_cvt_pk_bf16_f32 v173, v114, v115
    v_cvt_pk_bf16_f32 v174, v116, v117
    v_cvt_pk_bf16_f32 v175, v118, v119
    v_cvt_pk_bf16_f32 v176, v120, v121
    v_cvt_pk_bf16_f32 v177, v122, v123
    v_cvt_pk_bf16_f32 v178, v124, v125
    v_cvt_pk_bf16_f32 v179, v126, v127
    v_cvt_pk_bf16_f32 v180, v128, v129
    v_cvt_pk_bf16_f32 v181, v130, v131
    s_nop 1
    v_permlane16_swap_b32 v172, v174
    v_permlane16_swap_b32 v173, v175
    v_permlane16_swap_b32 v176, v178
    v_permlane16_swap_b32 v177, v179
    s_nop 1
    buffer_store_dwordx4 v[172:175], v10, s[28:31], 0 offen
    buffer_store_dwordx4 v[176:179], v10, s[28:31], 0 offen offset:64
    buffer_store_dwordx2 v[180:181], v11, s[28:31], 0 offen offset:128
    s_endpgm
L_helper:
    s_load_dwordx2 s[88:89], s[0:1], 32
    s_load_dwordx2 s[92:93], s[0:1], 72
    s_load_dwordx2 s[90:91], s[0:1], 88
    s_mov_b32 s46, 0x200000
    s_mov_b32 s47, 0
    s_mov_b32 s48, 0
    s_mov_b32 s49, 0
    s_mov_b32 s66, -1
    s_mov_b32 s67, 0
    s_mov_b32 s43, s44
    s_and_b32 s72, s43, 1
    v_mov_b32 v17, 161792
    s_waitcnt lgkmcnt(0)
    s_waitcnt lgkmcnt(0)
    s_mov_b32 s8, s80
    s_and_b32 s9, s81, 0xffff
    s_mov_b32 s10, 2621440
    s_mov_b32 s11, 0x20000
    s_mov_b32 s12, s82
    s_and_b32 s13, s83, 0xffff
    s_mov_b32 s14, 2457600
    s_mov_b32 s15, 0x20000
    s_mov_b32 s16, s84
    s_and_b32 s17, s85, 0xffff
    s_mov_b32 s18, 25600
    s_mov_b32 s19, 0x20000
    s_mov_b32 s20, s86
    s_and_b32 s21, s87, 0xffff
    s_mov_b32 s22, 819200
    s_mov_b32 s23, 0x20000
    s_mov_b32 s24, s88
    s_and_b32 s25, s89, 0xffff
    s_mov_b32 s26, 2621440
    s_mov_b32 s27, 0x20000
    s_mov_b32 s28, s92
    s_and_b32 s29, s93, 0xffff
    s_mov_b32 s30, 5242880
    s_mov_b32 s31, 0x20000
    s_mov_b32 s36, s90
    s_and_b32 s37, s91, 0xffff
    s_mov_b32 s38, 9437184
    s_mov_b32 s39, 0x20000
    s_sub_u32 s74, s40, 4
    v_lshrrev_b32 v20, 4, v1
    v_and_b32 v21, 15, v1
    s_lshl_b32 s50, s74, 2
    s_add_u32 s50, s50, 161824
    v_mov_b32 v19, s50
    s_cmp_eq_u32 s72, 1
    s_cbranch_scc1 L_hC
    s_bfe_u32 s50, s43, 0x10001
    s_mul_i32 s73, s50, 3
    s_add_u32 s73, s73, s74
    s_lshr_b32 s50, s43, 2
    s_lshl_b32 s76, s45, 3
    s_add_u32 s76, s76, s50
    s_lshl_b32 s50, s73, 4
    v_add_u32 v180, s50, v21
    v_cvt_f32_u32 v180, v180
    v_mul_f32 v23, 0x3bcccccd, v180
    v_cvt_f32_u32 v181, v20
    v_mul_f32 v181, 4.0, v181
    v_mul_f32 v22, v181, v23
    v_mul_f32 v182, 0x3acccccd, v180
    v_cos_f32 v104, v182
    v_sin_f32 v105, v182
    v_mul_f32 v182, 0x3b4ccccd, v180
    v_cos_f32 v106, v182
    v_sin_f32 v107, v182
    v_mul_f32 v182, 0x3b99999a, v180
    v_cos_f32 v108, v182
    v_sin_f32 v109, v182
    v_fmamk_f32 v182, v23, 0x0, v22
    v_fract_f32 v182, v182
    v_fmamk_f32 v183, v23, 0x3f800000, v22
    v_fract_f32 v183, v183
    v_cos_f32 v184, v182
    v_cos_f32 v185, v183
    v_sin_f32 v186, v182
    v_sin_f32 v187, v183
    v_mul_f32 v184, 0x3f805bc0, v184
    v_mul_f32 v185, 0x3f805bc0, v185
    v_mul_f32 v186, 0x3f805bc0, v186
    v_mul_f32 v187, 0x3f805bc0, v187
    v_cvt_pk_bf16_f32 v32, v184, v185
    v_cvt_pk_bf16_f32 v36, -v186, -v187
    v_fmamk_f32 v182, v23, 0x40000000, v22
    v_fract_f32 v182, v182
    v_fmamk_f32 v183, v23, 0x40400000, v22
    v_fract_f32 v183, v183
    v_cos_f32 v184, v182
    v_cos_f32 v185, v183
    v_sin_f32 v186, v182
    v_sin_f32 v187, v183
    v_mul_f32 v184, 0x3f805bc0, v184
    v_mul_f32 v185, 0x3f805bc0, v185
    v_mul_f32 v186, 0x3f805bc0, v186
    v_mul_f32 v187, 0x3f805bc0, v187
    v_cvt_pk_bf16_f32 v33, v184, v185
    v_cvt_pk_bf16_f32 v37, -v186, -v187
    v_fmamk_f32 v182, v23, 0x41800000, v22
    v_fract_f32 v182, v182
    v_fmamk_f32 v183, v23, 0x41880000, v22
    v_fract_f32 v183, v183
    v_cos_f32 v184, v182
    v_cos_f32 v185, v183
    v_sin_f32 v186, v182
    v_sin_f32 v187, v183
    v_mul_f32 v184, 0x3f805bc0, v184
    v_mul_f32 v185, 0x3f805bc0, v185
    v_mul_f32 v186, 0x3f805bc0, v186
    v_mul_f32 v187, 0x3f805bc0, v187
    v_cvt_pk_bf16_f32 v34, v184, v185
    v_cvt_pk_bf16_f32 v38, -v186, -v187
    v_fmamk_f32 v182, v23, 0x41900000, v22
    v_fract_f32 v182, v182
    v_fmamk_f32 v183, v23, 0x41980000, v22
    v_fract_f32 v183, v183
    v_cos_f32 v184, v182
    v_cos_f32 v185, v183
    v_sin_f32 v186, v182
    v_sin_f32 v187, v183
    v_mul_f32 v184, 0x3f805bc0, v184
    v_mul_f32 v185, 0x3f805bc0, v185
    v_mul_f32 v186, 0x3f805bc0, v186
    v_mul_f32 v187, 0x3f805bc0, v187
    v_cvt_pk_bf16_f32 v35, v184, v185
    v_cvt_pk_bf16_f32 v39, -v186, -v187
    v_fmamk_f32 v182, v23, 0x42000000, v22
    v_fract_f32 v182, v182
    v_fmamk_f32 v183, v23, 0x42040000, v22
    v_fract_f32 v183, v183
    v_cos_f32 v184, v182
    v_cos_f32 v185, v183
    v_sin_f32 v186, v182
    v_sin_f32 v187, v183
    v_mul_f32 v184, 0x3f805bc0, v184
    v_mul_f32 v185, 0x3f805bc0, v185
    v_mul_f32 v186, 0x3f805bc0, v186
    v_mul_f32 v187, 0x3f805bc0, v187
    v_cvt_pk_bf16_f32 v40, v184, v185
    v_cvt_pk_bf16_f32 v44, -v186, -v187
    v_fmamk_f32 v182, v23, 0x42080000, v22
    v_fract_f32 v182, v182
    v_fmamk_f32 v183, v23, 0x420c0000, v22
    v_fract_f32 v183, v183
    v_cos_f32 v184, v182
    v_cos_f32 v185, v183
    v_sin_f32 v186, v182
    v_sin_f32 v187, v183
    v_mul_f32 v184, 0x3f805bc0, v184
    v_mul_f32 v185, 0x3f805bc0, v185
    v_mul_f32 v186, 0x3f805bc0, v186
    v_mul_f32 v187, 0x3f805bc0, v187
    v_cvt_pk_bf16_f32 v41, v184, v185
    v_cvt_pk_bf16_f32 v45, -v186, -v187
    v_fmamk_f32 v182, v23, 0x42400000, v22
    v_fract_f32 v182, v182
    v_fmamk_f32 v183, v23, 0x42440000, v22
    v_fract_f32 v183, v183
    v_cos_f32 v184, v182
    v_cos_f32 v185, v183
    v_sin_f32 v186, v182
    v_sin_f32 v187, v183
    v_mul_f32 v184, 0x3f805bc0, v184
    v_mul_f32 v185, 0x3f805bc0, v185
    v_mul_f32 v186, 0x3f805bc0, v186
    v_mul_f32 v187, 0x3f805bc0, v187
    v_cvt_pk_bf16_f32 v42, v184, v185
    v_cvt_pk_bf16_f32 v46, -v186, -v187
    v_fmamk_f32 v182, v23, 0x42480000, v22
    v_fract_f32 v182, v182
    v_fmamk_f32 v183, v23, 0x424c0000, v22
    v_fract_f32 v183, v183
    v_cos_f32 v184, v182
    v_cos_f32 v185, v183
    v_sin_f32 v186, v182
    v_sin_f32 v187, v183
    v_mul_f32 v184, 0x3f805bc0, v184
    v_mul_f32 v185, 0x3f805bc0, v185
    v_mul_f32 v186, 0x3f805bc0, v186
    v_mul_f32 v187, 0x3f805bc0, v187
    v_cvt_pk_bf16_f32 v43, v184, v185
    v_cvt_pk_bf16_f32 v47, -v186, -v187
    v_fmamk_f32 v182, v23, 0x42800000, v22
    v_fract_f32 v182, v182
    v_fmamk_f32 v183, v23, 0x42820000, v22
    v_fract_f32 v183, v183
    v_cos_f32 v184, v182
    v_cos_f32 v185, v183
    v_sin_f32 v186, v182
    v_sin_f32 v187, v183
    v_mul_f32 v184, 0x3f805bc0, v184
    v_mul_f32 v185, 0x3f805bc0, v185
    v_mul_f32 v186, 0x3f805bc0, v186
    v_mul_f32 v187, 0x3f805bc0, v187
    v_cvt_pk_bf16_f32 v48, v184, v185
    v_cvt_pk_bf16_f32 v52, -v186, -v187
    v_fmamk_f32 v182, v23, 0x42840000, v22
    v_fract_f32 v182, v182
    v_fmamk_f32 v183, v23, 0x42860000, v22
    v_fract_f32 v183, v183
    v_cos_f32 v184, v182
    v_cos_f32 v185, v183
    v_sin_f32 v186, v182
    v_sin_f32 v187, v183
    v_mul_f32 v184, 0x3f805bc0, v184
    v_mul_f32 v185, 0x3f805bc0, v185
    v_mul_f32 v186, 0x3f805bc0, v186
    v_mul_f32 v187, 0x3f805bc0, v187
    v_cvt_pk_bf16_f32 v49, v184, v185
    v_cvt_pk_bf16_f32 v53, -v186, -v187
    v_fmamk_f32 v182, v23, 0x42a00000, v22
    v_fract_f32 v182, v182
    v_fmamk_f32 v183, v23, 0x42a20000, v22
    v_fract_f32 v183, v183
    v_cos_f32 v184, v182
    v_cos_f32 v185, v183
    v_sin_f32 v186, v182
    v_sin_f32 v187, v183
    v_mul_f32 v184, 0x3f805bc0, v184
    v_mul_f32 v185, 0x3f805bc0, v185
    v_mul_f32 v186, 0x3f805bc0, v186
    v_mul_f32 v187, 0x3f805bc0, v187
    v_cvt_pk_bf16_f32 v50, v184, v185
    v_cvt_pk_bf16_f32 v54, -v186, -v187
    v_fmamk_f32 v182, v23, 0x42a40000, v22
    v_fract_f32 v182, v182
    v_fmamk_f32 v183, v23, 0x42a60000, v22
    v_fract_f32 v183, v183
    v_cos_f32 v184, v182
    v_cos_f32 v185, v183
    v_sin_f32 v186, v182
    v_sin_f32 v187, v183
    v_mul_f32 v184, 0x3f805bc0, v184
    v_mul_f32 v185, 0x3f805bc0, v185
    v_mul_f32 v186, 0x3f805bc0, v186
    v_mul_f32 v187, 0x3f805bc0, v187
    v_cvt_pk_bf16_f32 v51, v184, v185
    v_cvt_pk_bf16_f32 v55, -v186, -v187
    v_fmamk_f32 v182, v23, 0x42c00000, v22
    v_fract_f32 v182, v182
    v_fmamk_f32 v183, v23, 0x42c20000, v22
    v_fract_f32 v183, v183
    v_cos_f32 v184, v182
    v_cos_f32 v185, v183
    v_sin_f32 v186, v182
    v_sin_f32 v187, v183
    v_mul_f32 v184, 0x3f805bc0, v184
    v_mul_f32 v185, 0x3f805bc0, v185
    v_mul_f32 v186, 0x3f805bc0, v186
    v_mul_f32 v187, 0x3f805bc0, v187
    v_cvt_pk_bf16_f32 v56, v184, v185
    v_cvt_pk_bf16_f32 v60, -v186, -v187
    v_fmamk_f32 v182, v23, 0x42c40000, v22
    v_fract_f32 v182, v182
    v_fmamk_f32 v183, v23, 0x42c60000, v22
    v_fract_f32 v183, v183
    v_cos_f32 v184, v182
    v_cos_f32 v185, v183
    v_sin_f32 v186, v182
    v_sin_f32 v187, v183
    v_mul_f32 v184, 0x3f805bc0, v184
    v_mul_f32 v185, 0x3f805bc0, v185
    v_mul_f32 v186, 0x3f805bc0, v186
    v_mul_f32 v187, 0x3f805bc0, v187
    v_cvt_pk_bf16_f32 v57, v184, v185
    v_cvt_pk_bf16_f32 v61, -v186, -v187
    v_fmamk_f32 v182, v23, 0x42e00000, v22
    v_fract_f32 v182, v182
    v_fmamk_f32 v183, v23, 0x42e20000, v22
    v_fract_f32 v183, v183
    v_cos_f32 v184, v182
    v_cos_f32 v185, v183
    v_sin_f32 v186, v182
    v_sin_f32 v187, v183
    v_mul_f32 v184, 0x3f805bc0, v184
    v_mul_f32 v185, 0x3f805bc0, v185
    v_mul_f32 v186, 0x3f805bc0, v186
    v_mul_f32 v187, 0x3f805bc0, v187
    v_cvt_pk_bf16_f32 v58, v184, v185
    v_cvt_pk_bf16_f32 v62, -v186, -v187
    v_fmamk_f32 v182, v23, 0x42e40000, v22
    v_fract_f32 v182, v182
    v_fmamk_f32 v183, v23, 0x42e60000, v22
    v_fract_f32 v183, v183
    v_cos_f32 v184, v182
    v_cos_f32 v185, v183
    v_sin_f32 v186, v182
    v_sin_f32 v187, v183
    v_mul_f32 v184, 0x3f805bc0, v184
    v_mul_f32 v185, 0x3f805bc0, v185
    v_mul_f32 v186, 0x3f805bc0, v186
    v_mul_f32 v187, 0x3f805bc0, v187
    v_cvt_pk_bf16_f32 v59, v184, v185
    v_cvt_pk_bf16_f32 v63, -v186, -v187
    v_fmamk_f32 v182, v23, 0x43000000, v22
    v_fract_f32 v182, v182
    v_fmamk_f32 v183, v23, 0x43010000, v22
    v_fract_f32 v183, v183
    v_cos_f32 v184, v182
    v_cos_f32 v185, v183
    v_sin_f32 v186, v182
    v_sin_f32 v187, v183
    v_mul_f32 v184, 0x3f805bc0, v184
    v_mul_f32 v185, 0x3f805bc0, v185
    v_mul_f32 v186, 0x3f805bc0, v186
    v_mul_f32 v187, 0x3f805bc0, v187
    v_cvt_pk_bf16_f32 v64, v184, v185
    v_cvt_pk_bf16_f32 v68, -v186, -v187
    v_fmamk_f32 v182, v23, 0x43020000, v22
    v_fract_f32 v182, v182
    v_fmamk_f32 v183, v23, 0x43030000, v22
    v_fract_f32 v183, v183
    v_cos_f32 v184, v182
    v_cos_f32 v185, v183
    v_sin_f32 v186, v182
    v_sin_f32 v187, v183
    v_mul_f32 v184, 0x3f805bc0, v184
    v_mul_f32 v185, 0x3f805bc0, v185
    v_mul_f32 v186, 0x3f805bc0, v186
    v_mul_f32 v187, 0x3f805bc0, v187
    v_cvt_pk_bf16_f32 v65, v184, v185
    v_cvt_pk_bf16_f32 v69, -v186, -v187
    v_fmamk_f32 v182, v23, 0x43100000, v22
    v_fract_f32 v182, v182
    v_fmamk_f32 v183, v23, 0x43110000, v22
    v_fract_f32 v183, v183
    v_cos_f32 v184, v182
    v_cos_f32 v185, v183
    v_sin_f32 v186, v182
    v_sin_f32 v187, v183
    v_mul_f32 v184, 0x3f805bc0, v184
    v_mul_f32 v185, 0x3f805bc0, v185
    v_mul_f32 v186, 0x3f805bc0, v186
    v_mul_f32 v187, 0x3f805bc0, v187
    v_cvt_pk_bf16_f32 v66, v184, v185
    v_cvt_pk_bf16_f32 v70, -v186, -v187
    v_fmamk_f32 v182, v23, 0x43120000, v22
    v_fract_f32 v182, v182
    v_fmamk_f32 v183, v23, 0x43130000, v22
    v_fract_f32 v183, v183
    v_cos_f32 v184, v182
    v_cos_f32 v185, v183
    v_sin_f32 v186, v182
    v_sin_f32 v187, v183
    v_mul_f32 v184, 0x3f805bc0, v184
    v_mul_f32 v185, 0x3f805bc0, v185
    v_mul_f32 v186, 0x3f805bc0, v186
    v_mul_f32 v187, 0x3f805bc0, v187
    v_cvt_pk_bf16_f32 v67, v184, v185
    v_cvt_pk_bf16_f32 v71, -v186, -v187
    v_lshrrev_b32 v180, 2, v21
    v_lshlrev_b32 v180, 2, v180
    v_bfe_u32 v181, v21, 1, 1
    v_add_u32 v180, v180, v181
    v_cvt_f32_u32 v180, v180
    v_and_b32 v181, 1, v21
    v_cvt_f32_u32 v181, v181
    v_mul_f32 v181, 0x3e800000, v181
    s_bfe_u32 s50, s43, 0x10001
    s_lshl_b32 s50, s50, 4
    v_add_u32 v188, s50, v20
    v_cvt_f32_u32 v188, v188
    v_add_f32 v189, 0x0, v180
    v_mul_f32 v189, 0x3d000000, v189
    v_fma_f32 v22, v189, v188, v181
    v_mul_f32 v23, 4.0, v189
    v_fmamk_f32 v182, v23, 0x0, v22
    v_fract_f32 v182, v182
    v_fmamk_f32 v183, v23, 0x3f800000, v22
    v_fract_f32 v183, v183
    v_cos_f32 v184, v182
    v_cos_f32 v185, v183
    v_sin_f32 v186, v182
    v_sin_f32 v187, v183
    v_cvt_pk_bf16_f32 v72, v184, v185
    v_cvt_pk_bf16_f32 v76, v186, v187
    v_fmamk_f32 v182, v23, 0x40000000, v22
    v_fract_f32 v182, v182
    v_fmamk_f32 v183, v23, 0x40400000, v22
    v_fract_f32 v183, v183
    v_cos_f32 v184, v182
    v_cos_f32 v185, v183
    v_sin_f32 v186, v182
    v_sin_f32 v187, v183
    v_cvt_pk_bf16_f32 v73, v184, v185
    v_cvt_pk_bf16_f32 v77, v186, v187
    v_fmamk_f32 v182, v23, 0x40800000, v22
    v_fract_f32 v182, v182
    v_fmamk_f32 v183, v23, 0x40a00000, v22
    v_fract_f32 v183, v183
    v_cos_f32 v184, v182
    v_cos_f32 v185, v183
    v_sin_f32 v186, v182
    v_sin_f32 v187, v183
    v_cvt_pk_bf16_f32 v74, v184, v185
    v_cvt_pk_bf16_f32 v78, v186, v187
    v_fmamk_f32 v182, v23, 0x40c00000, v22
    v_fract_f32 v182, v182
    v_fmamk_f32 v183, v23, 0x40e00000, v22
    v_fract_f32 v183, v183
    v_cos_f32 v184, v182
    v_cos_f32 v185, v183
    v_sin_f32 v186, v182
    v_sin_f32 v187, v183
    v_cvt_pk_bf16_f32 v75, v184, v185
    v_cvt_pk_bf16_f32 v79, v186, v187
    v_add_f32 v189, 0x40000000, v180
    v_mul_f32 v189, 0x3d000000, v189
    v_fma_f32 v22, v189, v188, v181
    v_mul_f32 v23, 4.0, v189
    v_fmamk_f32 v182, v23, 0x0, v22
    v_fract_f32 v182, v182
    v_fmamk_f32 v183, v23, 0x3f800000, v22
    v_fract_f32 v183, v183
    v_cos_f32 v184, v182
    v_cos_f32 v185, v183
    v_sin_f32 v186, v182
    v_sin_f32 v187, v183
    v_cvt_pk_bf16_f32 v80, v184, v185
    v_cvt_pk_bf16_f32 v84, v186, v187
    v_fmamk_f32 v182, v23, 0x40000000, v22
    v_fract_f32 v182, v182
    v_fmamk_f32 v183, v23, 0x40400000, v22
    v_fract_f32 v183, v183
    v_cos_f32 v184, v182
    v_cos_f32 v185, v183
    v_sin_f32 v186, v182
    v_sin_f32 v187, v183
    v_cvt_pk_bf16_f32 v81, v184, v185
    v_cvt_pk_bf16_f32 v85, v186, v187
    v_fmamk_f32 v182, v23, 0x40800000, v22
    v_fract_f32 v182, v182
    v_fmamk_f32 v183, v23, 0x40a00000, v22
    v_fract_f32 v183, v183
    v_cos_f32 v184, v182
    v_cos_f32 v185, v183
    v_sin_f32 v186, v182
    v_sin_f32 v187, v183
    v_cvt_pk_bf16_f32 v82, v184, v185
    v_cvt_pk_bf16_f32 v86, v186, v187
    v_fmamk_f32 v182, v23, 0x40c00000, v22
    v_fract_f32 v182, v182
    v_fmamk_f32 v183, v23, 0x40e00000, v22
    v_fract_f32 v183, v183
    v_cos_f32 v184, v182
    v_cos_f32 v185, v183
    v_sin_f32 v186, v182
    v_sin_f32 v187, v183
    v_cvt_pk_bf16_f32 v83, v184, v185
    v_cvt_pk_bf16_f32 v87, v186, v187
    v_add_f32 v189, 0x41800000, v180
    v_mul_f32 v189, 0x3d000000, v189
    v_fma_f32 v22, v189, v188, v181
    v_mul_f32 v23, 4.0, v189
    v_fmamk_f32 v182, v23, 0x0, v22
    v_fract_f32 v182, v182
    v_fmamk_f32 v183, v23, 0x3f800000, v22
    v_fract_f32 v183, v183
    v_cos_f32 v184, v182
    v_cos_f32 v185, v183
    v_sin_f32 v186, v182
    v_sin_f32 v187, v183
    v_cvt_pk_bf16_f32 v88, v184, v185
    v_cvt_pk_bf16_f32 v92, v186, v187
    v_fmamk_f32 v182, v23, 0x40000000, v22
    v_fract_f32 v182, v182
    v_fmamk_f32 v183, v23, 0x40400000, v22
    v_fract_f32 v183, v183
    v_cos_f32 v184, v182
    v_cos_f32 v185, v183
    v_sin_f32 v186, v182
    v_sin_f32 v187, v183
    v_cvt_pk_bf16_f32 v89, v184, v185
    v_cvt_pk_bf16_f32 v93, v186, v187
    v_fmamk_f32 v182, v23, 0x40800000, v22
    v_fract_f32 v182, v182
    v_fmamk_f32 v183, v23, 0x40a00000, v22
    v_fract_f32 v183, v183
    v_cos_f32 v184, v182
    v_cos_f32 v185, v183
    v_sin_f32 v186, v182
    v_sin_f32 v187, v183
    v_cvt_pk_bf16_f32 v90, v184, v185
    v_cvt_pk_bf16_f32 v94, v186, v187
    v_fmamk_f32 v182, v23, 0x40c00000, v22
    v_fract_f32 v182, v182
    v_fmamk_f32 v183, v23, 0x40e00000, v22
    v_fract_f32 v183, v183
    v_cos_f32 v184, v182
    v_cos_f32 v185, v183
    v_sin_f32 v186, v182
    v_sin_f32 v187, v183
    v_cvt_pk_bf16_f32 v91, v184, v185
    v_cvt_pk_bf16_f32 v95, v186, v187
    v_add_f32 v189, 0x41900000, v180
    v_mul_f32 v189, 0x3d000000, v189
    v_fma_f32 v22, v189, v188, v181
    v_mul_f32 v23, 4.0, v189
    v_fmamk_f32 v182, v23, 0x0, v22
    v_fract_f32 v182, v182
    v_fmamk_f32 v183, v23, 0x3f800000, v22
    v_fract_f32 v183, v183
    v_cos_f32 v184, v182
    v_cos_f32 v185, v183
    v_sin_f32 v186, v182
    v_sin_f32 v187, v183
    v_cvt_pk_bf16_f32 v96, v184, v185
    v_cvt_pk_bf16_f32 v100, v186, v187
    v_fmamk_f32 v182, v23, 0x40000000, v22
    v_fract_f32 v182, v182
    v_fmamk_f32 v183, v23, 0x40400000, v22
    v_fract_f32 v183, v183
    v_cos_f32 v184, v182
    v_cos_f32 v185, v183
    v_sin_f32 v186, v182
    v_sin_f32 v187, v183
    v_cvt_pk_bf16_f32 v97, v184, v185
    v_cvt_pk_bf16_f32 v101, v186, v187
    v_fmamk_f32 v182, v23, 0x40800000, v22
    v_fract_f32 v182, v182
    v_fmamk_f32 v183, v23, 0x40a00000, v22
    v_fract_f32 v183, v183
    v_cos_f32 v184, v182
    v_cos_f32 v185, v183
    v_sin_f32 v186, v182
    v_sin_f32 v187, v183
    v_cvt_pk_bf16_f32 v98, v184, v185
    v_cvt_pk_bf16_f32 v102, v186, v187
    v_fmamk_f32 v182, v23, 0x40c00000, v22
    v_fract_f32 v182, v182
    v_fmamk_f32 v183, v23, 0x40e00000, v22
    v_fract_f32 v183, v183
    v_cos_f32 v184, v182
    v_cos_f32 v185, v183
    v_sin_f32 v186, v182
    v_sin_f32 v187, v183
    v_cvt_pk_bf16_f32 v99, v184, v185
    v_cvt_pk_bf16_f32 v103, v186, v187
    s_cmp_ge_u32 s47, 3
    s_cbranch_scc1 WD_167
WF_166:
    s_sleep 2
    ds_read_b32 v28, v17 offset:0
    s_sub_u32 s46, s46, 1
    s_cselect_b32 s46, 0, s46
    s_cbranch_scc1 WD_167
    s_waitcnt lgkmcnt(0)
    v_readfirstlane_b32 s47, v28
    s_cmp_ge_u32 s47, 3
    s_cbranch_scc0 WF_166
WD_167:
    s_mul_i32 s50, s44, 20
    s_add_u32 s50, s50, s74
    s_mul_i32 s50, s50, 1280
    s_and_b32 s51, s45, 1
    s_mul_i32 s51, s51, 640
    s_add_u32 s50, s50, s51
    s_add_u32 s50, s50, 0
    s_add_u32 s4, s20, s50
    s_addc_u32 s5, s21, 0
    s_cmp_eq_u32 s74, 2
    s_cselect_b32 s50, 6, 7
PF_168:
    s_load_dword s6, s[4:5], 0
    s_load_dword s6, s[4:5], 64
    s_load_dword s6, s[4:5], 128
    s_load_dword s6, s[4:5], 192
    s_load_dword s6, s[4:5], 256
    s_load_dword s6, s[4:5], 320
    s_load_dword s6, s[4:5], 384
    s_load_dword s6, s[4:5], 448
    s_load_dword s6, s[4:5], 512
    s_load_dword s6, s[4:5], 576
    s_add_u32 s4, s4, 3840
    s_addc_u32 s5, s5, 0
    s_sub_u32 s50, s50, 1
    s_cmp_lg_u32 s50, 0
    s_cbranch_scc1 PF_168
    s_mov_b32 s70, 0x3fb8aa3b
    s_mov_b32 s71, 0x3fb8aa3b
    v_mul_u32_u24 v29, 9216, v20
    v_mul_u32_u24 v31, 144, v21
    s_mul_i32 s50, s74, 2304
    s_add_u32 s50, s50, 71680
    v_add3_u32 v3, v29, v31, s50
    s_lshl_b32 s50, s74, 2
    v_add_u32 v4, s50, v17
    s_mov_b32 s52, s74
    s_setprio 2
    s_waitcnt lgkmcnt(0)
    s_mov_b32 s49, 0
    s_cmp_ge_u32 s49, 10
    s_cbranch_scc1 WD_172
WF_171:
    s_sleep 1
    ds_read_b32 v28, v4 offset:16
    s_sub_u32 s46, s46, 1
    s_cselect_b32 s46, 0, s46
    s_cbranch_scc1 WD_172
    s_waitcnt lgkmcnt(0)
    v_readfirstlane_b32 s49, v28
    s_cmp_ge_u32 s49, 10
    s_cbranch_scc0 WF_171
WD_172:
    ds_read_b128 v[180:183], v3 offset:0
    ds_read_b128 v[184:187], v3 offset:16
    ds_read_b128 v[188:191], v3 offset:32
    ds_read_b128 v[192:195], v3 offset:48
    ds_read_b128 v[196:199], v3 offset:64
    s_waitcnt lgkmcnt(0)
    v_max3_f32 v230, v180, v181, v182
    v_min3_f32 v232, v180, v181, v182
    v_max3_f32 v231, v183, v184, v185
    v_min3_f32 v233, v183, v184, v185
    v_max3_f32 v230, v230, v186, v187
    v_min3_f32 v232, v232, v186, v187
    v_max3_f32 v231, v231, v188, v189
    v_min3_f32 v233, v233, v188, v189
    v_max3_f32 v230, v230, v190, v191
    v_min3_f32 v232, v232, v190, v191
    v_max3_f32 v231, v231, v192, v193
    v_min3_f32 v233, v233, v192, v193
    v_max3_f32 v230, v230, v194, v195
    v_min3_f32 v232, v232, v194, v195
    v_max3_f32 v231, v231, v196, v197
    v_min3_f32 v233, v233, v196, v197
    v_max3_f32 v230, v230, v198, v199
    v_min3_f32 v232, v232, v198, v199
    v_max_f32 v230, v230, v231
    v_min_f32 v232, v232, v233
    v_mul_f32 v230, s70, v230
    v_mul_f32 v232, s70, v232
    v_fma_f32 v200, -v180, s70, v232
    v_fma_f32 v201, -v181, s70, v232
    v_fma_f32 v180, v180, s70, -v230
    v_fma_f32 v181, v181, s70, -v230
    v_fma_f32 v202, -v182, s70, v232
    v_fma_f32 v203, -v183, s70, v232
    v_fma_f32 v182, v182, s70, -v230
    v_fma_f32 v183, v183, s70, -v230
    v_fma_f32 v204, -v184, s70, v232
    v_fma_f32 v205, -v185, s70, v232
    v_fma_f32 v184, v184, s70, -v230
    v_fma_f32 v185, v185, s70, -v230
    v_fma_f32 v206, -v186, s70, v232
    v_fma_f32 v207, -v187, s70, v232
    v_fma_f32 v186, v186, s70, -v230
    v_fma_f32 v187, v187, s70, -v230
    v_fma_f32 v208, -v188, s70, v232
    v_fma_f32 v209, -v189, s70, v232
    v_fma_f32 v188, v188, s70, -v230
    v_fma_f32 v189, v189, s70, -v230
    v_fma_f32 v210, -v190, s70, v232
    v_fma_f32 v211, -v191, s70, v232
    v_fma_f32 v190, v190, s70, -v230
    v_fma_f32 v191, v191, s70, -v230
    v_fma_f32 v212, -v192, s70, v232
    v_fma_f32 v213, -v193, s70, v232
    v_fma_f32 v192, v192, s70, -v230
    v_fma_f32 v193, v193, s70, -v230
    v_fma_f32 v214, -v194, s70, v232
    v_fma_f32 v215, -v195, s70, v232
    v_fma_f32 v194, v194, s70, -v230
    v_fma_f32 v195, v195, s70, -v230
    v_fma_f32 v216, -v196, s70, v232
    v_fma_f32 v217, -v197, s70, v232
    v_fma_f32 v196, v196, s70, -v230
    v_fma_f32 v197, v197, s70, -v230
    v_fma_f32 v218, -v198, s70, v232
    v_fma_f32 v219, -v199, s70, v232
    v_fma_f32 v198, v198, s70, -v230
    v_fma_f32 v199, v199, s70, -v230
    v_exp_f32 v180, v180
    v_exp_f32 v200, v200
    v_exp_f32 v181, v181
    v_exp_f32 v201, v201
    v_exp_f32 v182, v182
    v_exp_f32 v202, v202
    v_exp_f32 v183, v183
    v_exp_f32 v203, v203
    v_exp_f32 v184, v184
    v_exp_f32 v204, v204
    v_exp_f32 v185, v185
    v_exp_f32 v205, v205
    v_exp_f32 v186, v186
    v_exp_f32 v206, v206
    v_exp_f32 v187, v187
    v_exp_f32 v207, v207
    v_exp_f32 v188, v188
    v_exp_f32 v208, v208
    v_exp_f32 v189, v189
    v_exp_f32 v209, v209
    v_exp_f32 v190, v190
    v_exp_f32 v210, v210
    v_exp_f32 v191, v191
    v_exp_f32 v211, v211
    v_exp_f32 v192, v192
    v_exp_f32 v212, v212
    v_exp_f32 v193, v193
    v_exp_f32 v213, v213
    v_exp_f32 v194, v194
    v_exp_f32 v214, v214
    v_exp_f32 v195, v195
    v_exp_f32 v215, v215
    v_exp_f32 v196, v196
    v_exp_f32 v216, v216
    v_exp_f32 v197, v197
    v_exp_f32 v217, v217
    v_exp_f32 v198, v198
    v_exp_f32 v218, v218
    v_exp_f32 v199, v199
    v_exp_f32 v219, v219
    v_add_f32 v230, v180, v182
    v_add_f32 v231, v181, v183
    v_add_f32 v232, v200, v202
    v_add_f32 v233, v201, v203
    v_add_f32 v234, v184, v186
    v_add_f32 v235, v185, v187
    v_add_f32 v236, v204, v206
    v_add_f32 v237, v205, v207
    v_add_f32 v230, v230, v188
    v_add_f32 v231, v231, v189
    v_add_f32 v232, v232, v208
    v_add_f32 v233, v233, v209
    v_add_f32 v234, v234, v190
    v_add_f32 v235, v235, v191
    v_add_f32 v236, v236, v210
    v_add_f32 v237, v237, v211
    v_add_f32 v230, v230, v192
    v_add_f32 v231, v231, v193
    v_add_f32 v232, v232, v212
    v_add_f32 v233, v233, v213
    v_add_f32 v234, v234, v194
    v_add_f32 v235, v235, v195
    v_add_f32 v236, v236, v214
    v_add_f32 v237, v237, v215
    v_add_f32 v230, v230, v196
    v_add_f32 v231, v231, v197
    v_add_f32 v232, v232, v216
    v_add_f32 v233, v233, v217
    v_add_f32 v234, v234, v198
    v_add_f32 v235, v235, v199
    v_add_f32 v236, v236, v218
    v_add_f32 v237, v237, v219
    v_add_f32 v230, v230, v234
    v_add_f32 v231, v231, v235
    v_add_f32 v232, v232, v236
    v_add_f32 v233, v233, v237
    v_add_f32 v230, v230, v231
    v_add_f32 v232, v232, v233
    v_rcp_f32 v230, v230
    v_rcp_f32 v232, v232
    s_nop 0
    v_mul_f32 v180, v180, v230
    v_mul_f32 v181, v181, v230
    v_mul_f32 v200, v200, v232
    v_mul_f32 v201, v201, v232
    v_mul_f32 v182, v182, v230
    v_mul_f32 v183, v183, v230
    v_mul_f32 v202, v202, v232
    v_mul_f32 v203, v203, v232
    v_mul_f32 v184, v184, v230
    v_mul_f32 v185, v185, v230
    v_mul_f32 v204, v204, v232
    v_mul_f32 v205, v205, v232
    v_mul_f32 v186, v186, v230
    v_mul_f32 v187, v187, v230
    v_mul_f32 v206, v206, v232
    v_mul_f32 v207, v207, v232
    v_mul_f32 v188, v188, v230
    v_mul_f32 v189, v189, v230
    v_mul_f32 v208, v208, v232
    v_mul_f32 v209, v209, v232
    v_mul_f32 v190, v190, v230
    v_mul_f32 v191, v191, v230
    v_mul_f32 v210, v210, v232
    v_mul_f32 v211, v211, v232
    v_mul_f32 v192, v192, v230
    v_mul_f32 v193, v193, v230
    v_mul_f32 v212, v212, v232
    v_mul_f32 v213, v213, v232
    v_mul_f32 v194, v194, v230
    v_mul_f32 v195, v195, v230
    v_mul_f32 v214, v214, v232
    v_mul_f32 v215, v215, v232
    v_mul_f32 v196, v196, v230
    v_mul_f32 v197, v197, v230
    v_mul_f32 v216, v216, v232
    v_mul_f32 v217, v217, v232
    v_mul_f32 v198, v198, v230
    v_mul_f32 v199, v199, v230
    v_mul_f32 v218, v218, v232
    v_mul_f32 v219, v219, v232
    v_cvt_pk_bf16_f32 v236, v180, v181
    v_cvt_pk_bf16_f32 v246, v200, v201
    v_cvt_pk_bf16_f32 v237, v182, v183
    v_cvt_pk_bf16_f32 v247, v202, v203
    v_cvt_pk_bf16_f32 v238, v184, v185
    v_cvt_pk_bf16_f32 v248, v204, v205
    v_cvt_pk_bf16_f32 v239, v186, v187
    v_cvt_pk_bf16_f32 v249, v206, v207
    v_cvt_pk_bf16_f32 v240, v188, v189
    v_cvt_pk_bf16_f32 v250, v208, v209
    v_cvt_pk_bf16_f32 v241, v190, v191
    v_cvt_pk_bf16_f32 v251, v210, v211
    v_cvt_pk_bf16_f32 v242, v192, v193
    v_cvt_pk_bf16_f32 v252, v212, v213
    v_cvt_pk_bf16_f32 v243, v194, v195
    v_cvt_pk_bf16_f32 v253, v214, v215
    v_cvt_pk_bf16_f32 v244, v196, v197
    v_cvt_pk_bf16_f32 v254, v216, v217
    v_cvt_pk_bf16_f32 v245, v198, v199
    v_cvt_pk_bf16_f32 v255, v218, v219
    ds_write_b128 v3, v[236:239] offset:0
    ds_write_b128 v3, v[240:243] offset:16
    ds_write_b128 v3, v[244:247] offset:32
    ds_write_b128 v3, v[248:251] offset:48
    ds_write_b128 v3, v[252:255] offset:64
    v_mov_b32 v28, 2
    ds_write_b32 v4, v28 offset:64
    s_cmp_eq_u32 s74, 0
    s_cbranch_scc1 KD_169
    s_sub_u32 s50, 3, s74
    s_mul_i32 s50, s50, 2304
    v_add_u32 v3, s50, v3
    v_mul_u32_u24 v2, 80, v1
    v_add_u32 v2, 154752, v2
    v_add_u32 v4, 12, v17
    s_cmp_eq_u32 s74, 1
    s_cbranch_scc0 KM_170
    s_waitcnt lgkmcnt(0)
    s_mov_b32 s49, 0
    s_cmp_ge_u32 s49, 10
    s_cbranch_scc1 WD_174
WF_173:
    s_sleep 1
    ds_read_b32 v28, v4 offset:16
    s_sub_u32 s46, s46, 1
    s_cselect_b32 s46, 0, s46
    s_cbranch_scc1 WD_174
    s_waitcnt lgkmcnt(0)
    v_readfirstlane_b32 s49, v28
    s_cmp_ge_u32 s49, 10
    s_cbranch_scc0 WF_173
WD_174:
    ds_read_b128 v[180:183], v2 offset:0
    ds_read_b128 v[184:187], v2 offset:16
    ds_read_b128 v[188:191], v2 offset:32
    ds_read_b128 v[192:195], v2 offset:48
    ds_read_b128 v[196:199], v2 offset:64
    s_waitcnt lgkmcnt(0)
    v_max3_f32 v230, v180, v181, v182
    v_max3_f32 v231, v183, v184, v185
    v_max3_f32 v230, v230, v186, v187
    v_max3_f32 v231, v231, v188, v189
    v_max3_f32 v230, v230, v190, v191
    v_max3_f32 v231, v231, v192, v193
    v_max3_f32 v230, v230, v194, v195
    v_max3_f32 v231, v231, v196, v197
    v_max3_f32 v230, v230, v198, v199
    v_max_f32 v230, v230, v231
    v_mul_f32 v230, s70, v230
    v_fma_f32 v180, v180, s70, -v230
    v_fma_f32 v181, v181, s70, -v230
    v_fma_f32 v182, v182, s70, -v230
    v_fma_f32 v183, v183, s70, -v230
    v_fma_f32 v184, v184, s70, -v230
    v_fma_f32 v185, v185, s70, -v230
    v_fma_f32 v186, v186, s70, -v230
    v_fma_f32 v187, v187, s70, -v230
    v_fma_f32 v188, v188, s70, -v230
    v_fma_f32 v189, v189, s70, -v230
    v_fma_f32 v190, v190, s70, -v230
    v_fma_f32 v191, v191, s70, -v230
    v_fma_f32 v192, v192, s70, -v230
    v_fma_f32 v193, v193, s70, -v230
    v_fma_f32 v194, v194, s70, -v230
    v_fma_f32 v195, v195, s70, -v230
    v_fma_f32 v196, v196, s70, -v230
    v_fma_f32 v197, v197, s70, -v230
    v_fma_f32 v198, v198, s70, -v230
    v_fma_f32 v199, v199, s70, -v230
    v_exp_f32 v180, v180
    v_exp_f32 v181, v181
    v_exp_f32 v182, v182
    v_exp_f32 v183, v183
    v_exp_f32 v184, v184
    v_exp_f32 v185, v185
    v_exp_f32 v186, v186
    v_exp_f32 v187, v187
    v_exp_f32 v188, v188
    v_exp_f32 v189, v189
    v_exp_f32 v190, v190
    v_exp_f32 v191, v191
    v_exp_f32 v192, v192
    v_exp_f32 v193, v193
    v_exp_f32 v194, v194
    v_exp_f32 v195, v195
    v_exp_f32 v196, v196
    v_exp_f32 v197, v197
    v_exp_f32 v198, v198
    v_exp_f32 v199, v199
    s_nop 0
    v_add_f32 v230, v180, v182
    v_add_f32 v231, v181, v183
    v_add_f32 v234, v184, v186
    v_add_f32 v235, v185, v187
    v_add_f32 v230, v230, v188
    v_add_f32 v231, v231, v189
    v_add_f32 v234, v234, v190
    v_add_f32 v235, v235, v191
    v_add_f32 v230, v230, v192
    v_add_f32 v231, v231, v193
    v_add_f32 v234, v234, v194
    v_add_f32 v235, v235, v195
    v_add_f32 v230, v230, v196
    v_add_f32 v231, v231, v197
    v_add_f32 v234, v234, v198
    v_add_f32 v235, v235, v199
    v_add_f32 v230, v230, v234
    v_add_f32 v231, v231, v235
    v_add_f32 v230, v230, v231
    v_rcp_f32 v230, v230
    s_nop 0
    v_mul_f32 v180, v180, v230
    v_mul_f32 v181, v181, v230
    v_mul_f32 v182, v182, v230
    v_mul_f32 v183, v183, v230
    v_mul_f32 v184, v184, v230
    v_mul_f32 v185, v185, v230
    v_mul_f32 v186, v186, v230
    v_mul_f32 v187, v187, v230
    v_mul_f32 v188, v188, v230
    v_mul_f32 v189, v189, v230
    v_mul_f32 v190, v190, v230
    v_mul_f32 v191, v191, v230
    v_mul_f32 v192, v192, v230
    v_mul_f32 v193, v193, v230
    v_mul_f32 v194, v194, v230
    v_mul_f32 v195, v195, v230
    v_mul_f32 v196, v196, v230
    v_mul_f32 v197, v197, v230
    v_mul_f32 v198, v198, v230
    v_mul_f32 v199, v199, v230
    v_cvt_pk_bf16_f32 v236, v180, v181
    v_cvt_pk_bf16_f32 v237, v182, v183
    v_cvt_pk_bf16_f32 v238, v184, v185
    v_cvt_pk_bf16_f32 v239, v186, v187
    v_cvt_pk_bf16_f32 v240, v188, v189
    v_cvt_pk_bf16_f32 v241, v190, v191
    v_cvt_pk_bf16_f32 v242, v192, v193
    v_cvt_pk_bf16_f32 v243, v194, v195
    v_cvt_pk_bf16_f32 v244, v196, v197
    v_cvt_pk_bf16_f32 v245, v198, v199
    ds_write_b128 v3, v[236:239]
    ds_write_b128 v3, v[240:243] offset:16
    ds_write_b64 v3, v[244:245] offset:32
    v_mov_b32 v28, 1
    s_mov_b64 exec, 1
    ds_add_u32 v17, v28 offset:76
    s_mov_b64 exec, -1
    s_branch KD_169
KM_170:
    s_waitcnt lgkmcnt(0)
    s_mov_b32 s49, 0
    s_cmp_ge_u32 s49, 10
    s_cbranch_scc1 WD_176
WF_175:
    s_sleep 1
    ds_read_b32 v28, v4 offset:16
    s_sub_u32 s46, s46, 1
    s_cselect_b32 s46, 0, s46
    s_cbranch_scc1 WD_176
    s_waitcnt lgkmcnt(0)
    v_readfirstlane_b32 s49, v28
    s_cmp_ge_u32 s49, 10
    s_cbranch_scc0 WF_175
WD_176:
    ds_read_b128 v[180:183], v2 offset:0
    ds_read_b128 v[184:187], v2 offset:16
    ds_read_b128 v[188:191], v2 offset:32
    ds_read_b128 v[192:195], v2 offset:48
    ds_read_b128 v[196:199], v2 offset:64
    s_waitcnt lgkmcnt(0)
    v_min3_f32 v232, v180, v181, v182
    v_min3_f32 v233, v183, v184, v185
    v_min3_f32 v232, v232, v186, v187
    v_min3_f32 v233, v233, v188, v189
    v_min3_f32 v232, v232, v190, v191
    v_min3_f32 v233, v233, v192, v193
    v_min3_f32 v232, v232, v194, v195
    v_min3_f32 v233, v233, v196, v197
    v_min3_f32 v232, v232, v198, v199
    v_min_f32 v232, v232, v233
    v_mul_f32 v232, s70, v232
    v_fma_f32 v200, -v180, s70, v232
    v_fma_f32 v201, -v181, s70, v232
    v_fma_f32 v202, -v182, s70, v232
    v_fma_f32 v203, -v183, s70, v232
    v_fma_f32 v204, -v184, s70, v232
    v_fma_f32 v205, -v185, s70, v232
    v_fma_f32 v206, -v186, s70, v232
    v_fma_f32 v207, -v187, s70, v232
    v_fma_f32 v208, -v188, s70, v232
    v_fma_f32 v209, -v189, s70, v232
    v_fma_f32 v210, -v190, s70, v232
    v_fma_f32 v211, -v191, s70, v232
    v_fma_f32 v212, -v192, s70, v232
    v_fma_f32 v213, -v193, s70, v232
    v_fma_f32 v214, -v194, s70, v232
    v_fma_f32 v215, -v195, s70, v232
    v_fma_f32 v216, -v196, s70, v232
    v_fma_f32 v217, -v197, s70, v232
    v_fma_f32 v218, -v198, s70, v232
    v_fma_f32 v219, -v199, s70, v232
    v_exp_f32 v200, v200
    v_exp_f32 v201, v201
    v_exp_f32 v202, v202
    v_exp_f32 v203, v203
    v_exp_f32 v204, v204
    v_exp_f32 v205, v205
    v_exp_f32 v206, v206
    v_exp_f32 v207, v207
    v_exp_f32 v208, v208
    v_exp_f32 v209, v209
    v_exp_f32 v210, v210
    v_exp_f32 v211, v211
    v_exp_f32 v212, v212
    v_exp_f32 v213, v213
    v_exp_f32 v214, v214
    v_exp_f32 v215, v215
    v_exp_f32 v216, v216
    v_exp_f32 v217, v217
    v_exp_f32 v218, v218
    v_exp_f32 v219, v219
    s_nop 0
    v_add_f32 v232, v200, v202
    v_add_f32 v233, v201, v203
    v_add_f32 v236, v204, v206
    v_add_f32 v237, v205, v207
    v_add_f32 v232, v232, v208
    v_add_f32 v233, v233, v209
    v_add_f32 v236, v236, v210
    v_add_f32 v237, v237, v211
    v_add_f32 v232, v232, v212
    v_add_f32 v233, v233, v213
    v_add_f32 v236, v236, v214
    v_add_f32 v237, v237, v215
    v_add_f32 v232, v232, v216
    v_add_f32 v233, v233, v217
    v_add_f32 v236, v236, v218
    v_add_f32 v237, v237, v219
    v_add_f32 v232, v232, v236
    v_add_f32 v233, v233, v237
    v_add_f32 v232, v232, v233
    v_rcp_f32 v232, v232
    s_nop 0
    v_mul_f32 v200, v200, v232
    v_mul_f32 v201, v201, v232
    v_mul_f32 v202, v202, v232
    v_mul_f32 v203, v203, v232
    v_mul_f32 v204, v204, v232
    v_mul_f32 v205, v205, v232
    v_mul_f32 v206, v206, v232
    v_mul_f32 v207, v207, v232
    v_mul_f32 v208, v208, v232
    v_mul_f32 v209, v209, v232
    v_mul_f32 v210, v210, v232
    v_mul_f32 v211, v211, v232
    v_mul_f32 v212, v212, v232
    v_mul_f32 v213, v213, v232
    v_mul_f32 v214, v214, v232
    v_mul_f32 v215, v215, v232
    v_mul_f32 v216, v216, v232
    v_mul_f32 v217, v217, v232
    v_mul_f32 v218, v218, v232
    v_mul_f32 v219, v219, v232
    v_cvt_pk_bf16_f32 v246, v200, v201
    v_cvt_pk_bf16_f32 v247, v202, v203
    v_cvt_pk_bf16_f32 v248, v204, v205
    v_cvt_pk_bf16_f32 v249, v206, v207
    v_cvt_pk_bf16_f32 v250, v208, v209
    v_cvt_pk_bf16_f32 v251, v210, v211
    v_cvt_pk_bf16_f32 v252, v212, v213
    v_cvt_pk_bf16_f32 v253, v214, v215
    v_cvt_pk_bf16_f32 v254, v216, v217
    v_cvt_pk_bf16_f32 v255, v218, v219
    ds_write_b64 v3, v[246:247] offset:40
    ds_write_b128 v3, v[248:251] offset:48
    ds_write_b128 v3, v[252:255] offset:64
    v_mov_b32 v28, 1
    s_mov_b64 exec, 1
    ds_add_u32 v17, v28 offset:76
    s_mov_b64 exec, -1
KD_169:
    s_waitcnt lgkmcnt(0)
    s_mov_b32 s49, 0
    s_setprio 3
GT_177:
    ds_read_b64 v[28:29], v17 offset:8
    s_waitcnt lgkmcnt(0)
    v_readfirstlane_b32 s34, v28
    v_readfirstlane_b32 s32, v29
    s_sub_u32 s46, s46, 1
    s_cselect_b32 s46, 0, s46
    s_cbranch_scc1 GD_178
    s_cmp_eq_u32 s32, 0
    s_cbranch_scc1 GT_177
GD_178:
    s_and_b32 s32, s34, 1
    s_mul_i32 s32, s32, 0x10001
    s_mov_b32 s33, 0xfffefffe
    v_mov_b32 v18, s32
    v_lshrrev_b32 v28, 3, v21
    v_lshl_add_u32 v28, v20, 1, v28
    v_bfe_u32 v29, v21, 1, 1
    v_lshlrev_b32 v29, 2, v29
    v_xor_b32 v28, v28, v29
    v_lshlrev_b32 v28, 4, v28
    v_bfe_u32 v29, v21, 2, 1
    v_lshl_add_u32 v28, v29, 3, v28
    v_and_b32 v29, 3, v21
    v_lshl_add_u32 v28, v29, 7, v28
    v_add_u32 v114, 108544, v28
    s_lshl_b32 s50, s73, 8
    v_lshl_add_u32 v28, v21, 4, s50
    v_mul_u32_u24 v29, 335872, v20
    v_add_u32 v110, v29, v28
    v_add_u32 v111, 2560, v110
    v_sub_u32 v112, v29, v28
    v_add_u32 v113, 2544, v112
    v_add_u32 v112, 5104, v112
    s_mul_i32 s76, s76, 5248
    s_add_u32 s76, s76, 6291456
    s_add_u32 s75, s76, 1343488
    s_cmp_eq_u32 s73, 5
    s_cselect_b32 s68, 0x000f000f, -1
    s_mov_b32 s69, s68
    s_cselect_b32 s52, 0, -1
    s_mov_b32 s53, s52
    s_cselect_b32 s50, 3840, 0
    s_cselect_b32 s51, 1344, 0
    v_add_u32 v110, s50, v110
    v_add_u32 v111, s51, v111
    s_cmp_ge_u32 s49, 1
    s_cbranch_scc1 WD_180
WF_179:
    s_sleep 1
    ds_read_b32 v28, v17 offset:4
    s_sub_u32 s46, s46, 1
    s_cselect_b32 s46, 0, s46
    s_cbranch_scc1 WD_180
    s_waitcnt lgkmcnt(0)
    v_readfirstlane_b32 s49, v28
    s_cmp_ge_u32 s49, 1
    s_cbranch_scc0 WF_179
WD_180:
    ds_read_b64_tr_b16 v[116:117], v114 offset:0
    ds_read_b64_tr_b16 v[118:119], v114 offset:1024
    ds_read_b64_tr_b16 v[120:121], v114 offset:2048
    ds_read_b64_tr_b16 v[122:123], v114 offset:3072
    ds_read_b64_tr_b16 v[124:125], v114 offset:4096
    ds_read_b64_tr_b16 v[126:127], v114 offset:5120
    ds_read_b64_tr_b16 v[128:129], v114 offset:6144
    ds_read_b64_tr_b16 v[130:131], v114 offset:7168
    ds_read_b64_tr_b16 v[132:133], v114 offset:8192
    ds_read_b64_tr_b16 v[134:135], v114 offset:9216
    s_waitcnt lgkmcnt(8)
    v_mfma_f32_16x16x32_bf16 v[156:159], v[116:119], v[32:35], 0
    v_mfma_f32_16x16x32_bf16 v[160:163], v[116:119], v[36:39], 0
    s_waitcnt lgkmcnt(6)
    v_mfma_f32_16x16x32_bf16 v[156:159], v[120:123], v[40:43], v[156:159]
    v_mfma_f32_16x16x32_bf16 v[160:163], v[120:123], v[44:47], v[160:163]
    s_waitcnt lgkmcnt(4)
    v_mfma_f32_16x16x32_bf16 v[156:159], v[124:127], v[48:51], v[156:159]
    v_mfma_f32_16x16x32_bf16 v[160:163], v[124:127], v[52:55], v[160:163]
    s_waitcnt lgkmcnt(2)
    v_mfma_f32_16x16x32_bf16 v[156:159], v[128:131], v[56:59], v[156:159]
    v_mfma_f32_16x16x32_bf16 v[160:163], v[128:131], v[60:63], v[160:163]
    s_waitcnt lgkmcnt(0)
    v_mfma_f32_16x16x32_bf16 v[156:159], v[132:135], v[64:67], v[156:159]
    v_mfma_f32_16x16x32_bf16 v[160:163], v[132:135], v[68:71], v[160:163]
    ds_read_b64_tr_b16 v[136:137], v114 offset:512
    ds_read_b64_tr_b16 v[138:139], v114 offset:1536
    ds_read_b64_tr_b16 v[140:141], v114 offset:2560
    ds_read_b64_tr_b16 v[142:143], v114 offset:3584
    ds_read_b64_tr_b16 v[144:145], v114 offset:4608
    ds_read_b64_tr_b16 v[146:147], v114 offset:5632
    ds_read_b64_tr_b16 v[148:149], v114 offset:6656
    ds_read_b64_tr_b16 v[150:151], v114 offset:7680
    ds_read_b64_tr_b16 v[152:153], v114 offset:8704
    ds_read_b64_tr_b16 v[154:155], v114 offset:9728
    s_waitcnt lgkmcnt(8)
    v_mfma_f32_16x16x32_bf16 v[164:167], v[136:139], v[32:35], 0
    v_mfma_f32_16x16x32_bf16 v[168:171], v[136:139], v[36:39], 0
    s_waitcnt lgkmcnt(6)
    v_mfma_f32_16x16x32_bf16 v[164:167], v[140:143], v[40:43], v[164:167]
    v_mfma_f32_16x16x32_bf16 v[168:171], v[140:143], v[44:47], v[168:171]
    s_waitcnt lgkmcnt(4)
    v_mfma_f32_16x16x32_bf16 v[164:167], v[144:147], v[48:51], v[164:167]
    v_mfma_f32_16x16x32_bf16 v[168:171], v[144:147], v[52:55], v[168:171]
    s_waitcnt lgkmcnt(2)
    v_mfma_f32_16x16x32_bf16 v[164:167], v[148:151], v[56:59], v[164:167]
    v_mfma_f32_16x16x32_bf16 v[168:171], v[148:151], v[60:63], v[168:171]
    s_waitcnt lgkmcnt(0)
    v_mfma_f32_16x16x32_bf16 v[164:167], v[152:155], v[64:67], v[164:167]
    v_mfma_f32_16x16x32_bf16 v[168:171], v[152:155], v[68:71], v[168:171]
    v_mul_f32 v180, v104, v157
    v_mul_f32 v181, v104, v161
    v_mul_f32 v182, v106, v158
    v_mul_f32 v183, v106, v162
    v_mul_f32 v184, v108, v159
    v_mul_f32 v185, v108, v163
    v_fmac_f32 v180, v105, v161
    v_fma_f32 v181, -v105, v157, v181
    v_fmac_f32 v182, v107, v162
    v_fma_f32 v183, -v107, v158, v183
    v_fmac_f32 v184, v109, v163
    v_fma_f32 v185, -v109, v159, v185
    v_add_f32 v186, v156, v182
    v_add_f32 v187, v160, v183
    v_sub_f32 v188, v156, v182
    v_sub_f32 v189, v160, v183
    v_add_f32 v190, v180, v184
    v_add_f32 v191, v181, v185
    v_sub_f32 v192, v180, v184
    v_sub_f32 v193, v181, v185
    v_add_f32 v172, v186, v190
    v_add_f32 v173, v187, v191
    v_add_f32 v174, v188, v193
    v_sub_f32 v175, v189, v192
    v_sub_f32 v176, v186, v190
    v_sub_f32 v177, v191, v187
    v_sub_f32 v178, v188, v193
    v_sub_f32 v179, -v189, v192
    s_nop 0
    s_cmp_ge_u32 s49, 2
    s_cbranch_scc1 WD_182
WF_181:
    s_sleep 1
    ds_read_b32 v28, v17 offset:4
    s_sub_u32 s46, s46, 1
    s_cselect_b32 s46, 0, s46
    s_cbranch_scc1 WD_182
    s_waitcnt lgkmcnt(0)
    v_readfirstlane_b32 s49, v28
    s_cmp_ge_u32 s49, 2
    s_cbranch_scc0 WF_181
WD_182:
    ds_read_b64_tr_b16 v[116:117], v114 offset:10240
    ds_read_b64_tr_b16 v[118:119], v114 offset:11264
    ds_read_b64_tr_b16 v[120:121], v114 offset:12288
    ds_read_b64_tr_b16 v[122:123], v114 offset:13312
    ds_read_b64_tr_b16 v[124:125], v114 offset:14336
    ds_read_b64_tr_b16 v[126:127], v114 offset:15360
    ds_read_b64_tr_b16 v[128:129], v114 offset:16384
    ds_read_b64_tr_b16 v[130:131], v114 offset:17408
    ds_read_b64_tr_b16 v[132:133], v114 offset:18432
    ds_read_b64_tr_b16 v[134:135], v114 offset:19456
    s_waitcnt lgkmcnt(8)
    v_mfma_f32_16x16x32_bf16 v[156:159], v[116:119], v[32:35], 0
    v_mfma_f32_16x16x32_bf16 v[160:163], v[116:119], v[36:39], 0
    s_waitcnt lgkmcnt(6)
    v_mfma_f32_16x16x32_bf16 v[156:159], v[120:123], v[40:43], v[156:159]
    v_mfma_f32_16x16x32_bf16 v[160:163], v[120:123], v[44:47], v[160:163]
    s_waitcnt lgkmcnt(4)
    v_mfma_f32_16x16x32_bf16 v[156:159], v[124:127], v[48:51], v[156:159]
    v_mfma_f32_16x16x32_bf16 v[160:163], v[124:127], v[52:55], v[160:163]
    s_waitcnt lgkmcnt(2)
    v_mfma_f32_16x16x32_bf16 v[156:159], v[128:131], v[56:59], v[156:159]
    v_mfma_f32_16x16x32_bf16 v[160:163], v[128:131], v[60:63], v[160:163]
    s_waitcnt lgkmcnt(0)
    v_mfma_f32_16x16x32_bf16 v[156:159], v[132:135], v[64:67], v[156:159]
    v_mfma_f32_16x16x32_bf16 v[160:163], v[132:135], v[68:71], v[160:163]
    v_mul_f32 v180, v104, v165
    v_mul_f32 v181, v104, v169
    v_mul_f32 v182, v106, v166
    v_mul_f32 v183, v106, v170
    v_mul_f32 v184, v108, v167
    v_mul_f32 v185, v108, v171
    v_fmac_f32 v180, v105, v169
    v_fma_f32 v181, -v105, v165, v181
    v_fmac_f32 v182, v107, v170
    v_fma_f32 v183, -v107, v166, v183
    v_fmac_f32 v184, v109, v171
    v_fma_f32 v185, -v109, v167, v185
    v_add_f32 v186, v164, v182
    v_add_f32 v187, v168, v183
    v_sub_f32 v188, v164, v182
    v_sub_f32 v189, v168, v183
    v_add_f32 v190, v180, v184
    v_add_f32 v191, v181, v185
    v_sub_f32 v192, v180, v184
    v_sub_f32 v193, v181, v185
    v_add_f32 v164, v186, v190
    v_add_f32 v165, v187, v191
    v_add_f32 v166, v188, v193
    v_sub_f32 v167, v189, v192
    v_sub_f32 v168, v186, v190
    v_sub_f32 v169, v191, v187
    v_sub_f32 v170, v188, v193
    v_sub_f32 v171, -v189, v192
    v_cvt_pk_bf16_f32 v200, v172, v164
    v_cvt_pk_bf16_f32 v204, v173, v165
    v_cvt_pk_bf16_f32 v208, v174, v166
    v_cvt_pk_bf16_f32 v212, v175, v167
    v_cvt_pk_bf16_f32 v216, v176, v168
    v_cvt_pk_bf16_f32 v220, v177, v169
    v_cvt_pk_bf16_f32 v224, v178, v170
    v_cvt_pk_bf16_f32 v228, v179, v171
    s_nop 0
    ds_read_b64_tr_b16 v[136:137], v114 offset:10752
    ds_read_b64_tr_b16 v[138:139], v114 offset:11776
    ds_read_b64_tr_b16 v[140:141], v114 offset:12800
    ds_read_b64_tr_b16 v[142:143], v114 offset:13824
    ds_read_b64_tr_b16 v[144:145], v114 offset:14848
    ds_read_b64_tr_b16 v[146:147], v114 offset:15872
    ds_read_b64_tr_b16 v[148:149], v114 offset:16896
    ds_read_b64_tr_b16 v[150:151], v114 offset:17920
    ds_read_b64_tr_b16 v[152:153], v114 offset:18944
    ds_read_b64_tr_b16 v[154:155], v114 offset:19968
    s_waitcnt lgkmcnt(8)
    v_mfma_f32_16x16x32_bf16 v[164:167], v[136:139], v[32:35], 0
    v_mfma_f32_16x16x32_bf16 v[168:171], v[136:139], v[36:39], 0
    s_waitcnt lgkmcnt(6)
    v_mfma_f32_16x16x32_bf16 v[164:167], v[140:143], v[40:43], v[164:167]
    v_mfma_f32_16x16x32_bf16 v[168:171], v[140:143], v[44:47], v[168:171]
    s_waitcnt lgkmcnt(4)
    v_mfma_f32_16x16x32_bf16 v[164:167], v[144:147], v[48:51], v[164:167]
    v_mfma_f32_16x16x32_bf16 v[168:171], v[144:147], v[52:55], v[168:171]
    s_waitcnt lgkmcnt(2)
    v_mfma_f32_16x16x32_bf16 v[164:167], v[148:151], v[56:59], v[164:167]
    v_mfma_f32_16x16x32_bf16 v[168:171], v[148:151], v[60:63], v[168:171]
    s_waitcnt lgkmcnt(0)
    v_mfma_f32_16x16x32_bf16 v[164:167], v[152:155], v[64:67], v[164:167]
    v_mfma_f32_16x16x32_bf16 v[168:171], v[152:155], v[68:71], v[168:171]
    v_mul_f32 v180, v104, v157
    v_mul_f32 v181, v104, v161
    v_mul_f32 v182, v106, v158
    v_mul_f32 v183, v106, v162
    v_mul_f32 v184, v108, v159
    v_mul_f32 v185, v108, v163
    v_fmac_f32 v180, v105, v161
    v_fma_f32 v181, -v105, v157, v181
    v_fmac_f32 v182, v107, v162
    v_fma_f32 v183, -v107, v158, v183
    v_fmac_f32 v184, v109, v163
    v_fma_f32 v185, -v109, v159, v185
    v_add_f32 v186, v156, v182
    v_add_f32 v187, v160, v183
    v_sub_f32 v188, v156, v182
    v_sub_f32 v189, v160, v183
    v_add_f32 v190, v180, v184
    v_add_f32 v191, v181, v185
    v_sub_f32 v192, v180, v184
    v_sub_f32 v193, v181, v185
    v_add_f32 v172, v186, v190
    v_add_f32 v173, v187, v191
    v_add_f32 v174, v188, v193
    v_sub_f32 v175, v189, v192
    v_sub_f32 v176, v186, v190
    v_sub_f32 v177, v191, v187
    v_sub_f32 v178, v188, v193
    v_sub_f32 v179, -v189, v192
    s_nop 0
    s_cmp_ge_u32 s49, 3
    s_cbranch_scc1 WD_184
WF_183:
    s_sleep 1
    ds_read_b32 v28, v17 offset:4
    s_sub_u32 s46, s46, 1
    s_cselect_b32 s46, 0, s46
    s_cbranch_scc1 WD_184
    s_waitcnt lgkmcnt(0)
    v_readfirstlane_b32 s49, v28
    s_cmp_ge_u32 s49, 3
    s_cbranch_scc0 WF_183
WD_184:
    ds_read_b64_tr_b16 v[116:117], v114 offset:20480
    ds_read_b64_tr_b16 v[118:119], v114 offset:21504
    ds_read_b64_tr_b16 v[120:121], v114 offset:22528
    ds_read_b64_tr_b16 v[122:123], v114 offset:23552
    ds_read_b64_tr_b16 v[124:125], v114 offset:24576
    ds_read_b64_tr_b16 v[126:127], v114 offset:25600
    ds_read_b64_tr_b16 v[128:129], v114 offset:26624
    ds_read_b64_tr_b16 v[130:131], v114 offset:27648
    ds_read_b64_tr_b16 v[132:133], v114 offset:28672
    ds_read_b64_tr_b16 v[134:135], v114 offset:29696
    s_waitcnt lgkmcnt(8)
    v_mfma_f32_16x16x32_bf16 v[156:159], v[116:119], v[32:35], 0
    v_mfma_f32_16x16x32_bf16 v[160:163], v[116:119], v[36:39], 0
    s_waitcnt lgkmcnt(6)
    v_mfma_f32_16x16x32_bf16 v[156:159], v[120:123], v[40:43], v[156:159]
    v_mfma_f32_16x16x32_bf16 v[160:163], v[120:123], v[44:47], v[160:163]
    s_waitcnt lgkmcnt(4)
    v_mfma_f32_16x16x32_bf16 v[156:159], v[124:127], v[48:51], v[156:159]
    v_mfma_f32_16x16x32_bf16 v[160:163], v[124:127], v[52:55], v[160:163]
    s_waitcnt lgkmcnt(2)
    v_mfma_f32_16x16x32_bf16 v[156:159], v[128:131], v[56:59], v[156:159]
    v_mfma_f32_16x16x32_bf16 v[160:163], v[128:131], v[60:63], v[160:163]
    s_waitcnt lgkmcnt(0)
    v_mfma_f32_16x16x32_bf16 v[156:159], v[132:135], v[64:67], v[156:159]
    v_mfma_f32_16x16x32_bf16 v[160:163], v[132:135], v[68:71], v[160:163]
    v_mul_f32 v180, v104, v165
    v_mul_f32 v181, v104, v169
    v_mul_f32 v182, v106, v166
    v_mul_f32 v183, v106, v170
    v_mul_f32 v184, v108, v167
    v_mul_f32 v185, v108, v171
    v_fmac_f32 v180, v105, v169
    v_fma_f32 v181, -v105, v165, v181
    v_fmac_f32 v182, v107, v170
    v_fma_f32 v183, -v107, v166, v183
    v_fmac_f32 v184, v109, v171
    v_fma_f32 v185, -v109, v167, v185
    v_add_f32 v186, v164, v182
    v_add_f32 v187, v168, v183
    v_sub_f32 v188, v164, v182
    v_sub_f32 v189, v168, v183
    v_add_f32 v190, v180, v184
    v_add_f32 v191, v181, v185
    v_sub_f32 v192, v180, v184
    v_sub_f32 v193, v181, v185
    v_add_f32 v164, v186, v190
    v_add_f32 v165, v187, v191
    v_add_f32 v166, v188, v193
    v_sub_f32 v167, v189, v192
    v_sub_f32 v168, v186, v190
    v_sub_f32 v169, v191, v187
    v_sub_f32 v170, v188, v193
    v_sub_f32 v171, -v189, v192
    v_cvt_pk_bf16_f32 v201, v172, v164
    v_cvt_pk_bf16_f32 v205, v173, v165
    v_cvt_pk_bf16_f32 v209, v174, v166
    v_cvt_pk_bf16_f32 v213, v175, v167
    v_cvt_pk_bf16_f32 v217, v176, v168
    v_cvt_pk_bf16_f32 v221, v177, v169
    v_cvt_pk_bf16_f32 v225, v178, v170
    v_cvt_pk_bf16_f32 v229, v179, v171
    s_nop 0
    ds_read_b64_tr_b16 v[136:137], v114 offset:20992
    ds_read_b64_tr_b16 v[138:139], v114 offset:22016
    ds_read_b64_tr_b16 v[140:141], v114 offset:23040
    ds_read_b64_tr_b16 v[142:143], v114 offset:24064
    ds_read_b64_tr_b16 v[144:145], v114 offset:25088
    ds_read_b64_tr_b16 v[146:147], v114 offset:26112
    ds_read_b64_tr_b16 v[148:149], v114 offset:27136
    ds_read_b64_tr_b16 v[150:151], v114 offset:28160
    ds_read_b64_tr_b16 v[152:153], v114 offset:29184
    ds_read_b64_tr_b16 v[154:155], v114 offset:30208
    s_waitcnt lgkmcnt(8)
    v_mfma_f32_16x16x32_bf16 v[164:167], v[136:139], v[32:35], 0
    v_mfma_f32_16x16x32_bf16 v[168:171], v[136:139], v[36:39], 0
    s_waitcnt lgkmcnt(6)
    v_mfma_f32_16x16x32_bf16 v[164:167], v[140:143], v[40:43], v[164:167]
    v_mfma_f32_16x16x32_bf16 v[168:171], v[140:143], v[44:47], v[168:171]
    s_waitcnt lgkmcnt(4)
    v_mfma_f32_16x16x32_bf16 v[164:167], v[144:147], v[48:51], v[164:167]
    v_mfma_f32_16x16x32_bf16 v[168:171], v[144:147], v[52:55], v[168:171]
    s_waitcnt lgkmcnt(2)
    v_mfma_f32_16x16x32_bf16 v[164:167], v[148:151], v[56:59], v[164:167]
    v_mfma_f32_16x16x32_bf16 v[168:171], v[148:151], v[60:63], v[168:171]
    s_waitcnt lgkmcnt(0)
    v_mfma_f32_16x16x32_bf16 v[164:167], v[152:155], v[64:67], v[164:167]
    v_mfma_f32_16x16x32_bf16 v[168:171], v[152:155], v[68:71], v[168:171]
    v_mul_f32 v180, v104, v157
    v_mul_f32 v181, v104, v161
    v_mul_f32 v182, v106, v158
    v_mul_f32 v183, v106, v162
    v_mul_f32 v184, v108, v159
    v_mul_f32 v185, v108, v163
    v_fmac_f32 v180, v105, v161
    v_fma_f32 v181, -v105, v157, v181
    v_fmac_f32 v182, v107, v162
    v_fma_f32 v183, -v107, v158, v183
    v_fmac_f32 v184, v109, v163
    v_fma_f32 v185, -v109, v159, v185
    v_add_f32 v186, v156, v182
    v_add_f32 v187, v160, v183
    v_sub_f32 v188, v156, v182
    v_sub_f32 v189, v160, v183
    v_add_f32 v190, v180, v184
    v_add_f32 v191, v181, v185
    v_sub_f32 v192, v180, v184
    v_sub_f32 v193, v181, v185
    v_add_f32 v172, v186, v190
    v_add_f32 v173, v187, v191
    v_add_f32 v174, v188, v193
    v_sub_f32 v175, v189, v192
    v_sub_f32 v176, v186, v190
    v_sub_f32 v177, v191, v187
    v_sub_f32 v178, v188, v193
    v_sub_f32 v179, -v189, v192
    s_nop 0
    s_cmp_ge_u32 s49, 4
    s_cbranch_scc1 WD_186
WF_185:
    s_sleep 1
    ds_read_b32 v28, v17 offset:4
    s_sub_u32 s46, s46, 1
    s_cselect_b32 s46, 0, s46
    s_cbranch_scc1 WD_186
    s_waitcnt lgkmcnt(0)
    v_readfirstlane_b32 s49, v28
    s_cmp_ge_u32 s49, 4
    s_cbranch_scc0 WF_185
WD_186:
    ds_read_b64_tr_b16 v[116:117], v114 offset:30720
    ds_read_b64_tr_b16 v[118:119], v114 offset:31744
    ds_read_b64_tr_b16 v[120:121], v114 offset:32768
    ds_read_b64_tr_b16 v[122:123], v114 offset:33792
    ds_read_b64_tr_b16 v[124:125], v114 offset:34816
    ds_read_b64_tr_b16 v[126:127], v114 offset:35840
    ds_read_b64_tr_b16 v[128:129], v114 offset:36864
    ds_read_b64_tr_b16 v[130:131], v114 offset:37888
    ds_read_b64_tr_b16 v[132:133], v114 offset:38912
    ds_read_b64_tr_b16 v[134:135], v114 offset:39936
    s_waitcnt lgkmcnt(8)
    v_mfma_f32_16x16x32_bf16 v[156:159], v[116:119], v[32:35], 0
    v_mfma_f32_16x16x32_bf16 v[160:163], v[116:119], v[36:39], 0
    s_waitcnt lgkmcnt(6)
    v_mfma_f32_16x16x32_bf16 v[156:159], v[120:123], v[40:43], v[156:159]
    v_mfma_f32_16x16x32_bf16 v[160:163], v[120:123], v[44:47], v[160:163]
    s_waitcnt lgkmcnt(4)
    v_mfma_f32_16x16x32_bf16 v[156:159], v[124:127], v[48:51], v[156:159]
    v_mfma_f32_16x16x32_bf16 v[160:163], v[124:127], v[52:55], v[160:163]
    s_waitcnt lgkmcnt(2)
    v_mfma_f32_16x16x32_bf16 v[156:159], v[128:131], v[56:59], v[156:159]
    v_mfma_f32_16x16x32_bf16 v[160:163], v[128:131], v[60:63], v[160:163]
    s_waitcnt lgkmcnt(0)
    v_mfma_f32_16x16x32_bf16 v[156:159], v[132:135], v[64:67], v[156:159]
    v_mfma_f32_16x16x32_bf16 v[160:163], v[132:135], v[68:71], v[160:163]
    v_mul_f32 v180, v104, v165
    v_mul_f32 v181, v104, v169
    v_mul_f32 v182, v106, v166
    v_mul_f32 v183, v106, v170
    v_mul_f32 v184, v108, v167
    v_mul_f32 v185, v108, v171
    v_fmac_f32 v180, v105, v169
    v_fma_f32 v181, -v105, v165, v181
    v_fmac_f32 v182, v107, v170
    v_fma_f32 v183, -v107, v166, v183
    v_fmac_f32 v184, v109, v171
    v_fma_f32 v185, -v109, v167, v185
    v_add_f32 v186, v164, v182
    v_add_f32 v187, v168, v183
    v_sub_f32 v188, v164, v182
    v_sub_f32 v189, v168, v183
    v_add_f32 v190, v180, v184
    v_add_f32 v191, v181, v185
    v_sub_f32 v192, v180, v184
    v_sub_f32 v193, v181, v185
    v_add_f32 v164, v186, v190
    v_add_f32 v165, v187, v191
    v_add_f32 v166, v188, v193
    v_sub_f32 v167, v189, v192
    v_sub_f32 v168, v186, v190
    v_sub_f32 v169, v191, v187
    v_sub_f32 v170, v188, v193
    v_sub_f32 v171, -v189, v192
    v_cvt_pk_bf16_f32 v202, v172, v164
    v_cvt_pk_bf16_f32 v206, v173, v165
    v_cvt_pk_bf16_f32 v210, v174, v166
    v_cvt_pk_bf16_f32 v214, v175, v167
    v_cvt_pk_bf16_f32 v218, v176, v168
    v_cvt_pk_bf16_f32 v222, v177, v169
    v_cvt_pk_bf16_f32 v226, v178, v170
    v_cvt_pk_bf16_f32 v230, v179, v171
    s_nop 0
    ds_read_b64_tr_b16 v[136:137], v114 offset:31232
    ds_read_b64_tr_b16 v[138:139], v114 offset:32256
    ds_read_b64_tr_b16 v[140:141], v114 offset:33280
    ds_read_b64_tr_b16 v[142:143], v114 offset:34304
    ds_read_b64_tr_b16 v[144:145], v114 offset:35328
    ds_read_b64_tr_b16 v[146:147], v114 offset:36352
    ds_read_b64_tr_b16 v[148:149], v114 offset:37376
    ds_read_b64_tr_b16 v[150:151], v114 offset:38400
    ds_read_b64_tr_b16 v[152:153], v114 offset:39424
    ds_read_b64_tr_b16 v[154:155], v114 offset:40448
    s_waitcnt lgkmcnt(8)
    v_mfma_f32_16x16x32_bf16 v[164:167], v[136:139], v[32:35], 0
    v_mfma_f32_16x16x32_bf16 v[168:171], v[136:139], v[36:39], 0
    s_waitcnt lgkmcnt(6)
    v_mfma_f32_16x16x32_bf16 v[164:167], v[140:143], v[40:43], v[164:167]
    v_mfma_f32_16x16x32_bf16 v[168:171], v[140:143], v[44:47], v[168:171]
    s_waitcnt lgkmcnt(4)
    v_mfma_f32_16x16x32_bf16 v[164:167], v[144:147], v[48:51], v[164:167]
    v_mfma_f32_16x16x32_bf16 v[168:171], v[144:147], v[52:55], v[168:171]
    s_waitcnt lgkmcnt(2)
    v_mfma_f32_16x16x32_bf16 v[164:167], v[148:151], v[56:59], v[164:167]
    v_mfma_f32_16x16x32_bf16 v[168:171], v[148:151], v[60:63], v[168:171]
    s_waitcnt lgkmcnt(0)
    v_mfma_f32_16x16x32_bf16 v[164:167], v[152:155], v[64:67], v[164:167]
    v_mfma_f32_16x16x32_bf16 v[168:171], v[152:155], v[68:71], v[168:171]
    v_mul_f32 v180, v104, v157
    v_mul_f32 v181, v104, v161
    v_mul_f32 v182, v106, v158
    v_mul_f32 v183, v106, v162
    v_mul_f32 v184, v108, v159
    v_mul_f32 v185, v108, v163
    v_fmac_f32 v180, v105, v161
    v_fma_f32 v181, -v105, v157, v181
    v_fmac_f32 v182, v107, v162
    v_fma_f32 v183, -v107, v158, v183
    v_fmac_f32 v184, v109, v163
    v_fma_f32 v185, -v109, v159, v185
    v_add_f32 v186, v156, v182
    v_add_f32 v187, v160, v183
    v_sub_f32 v188, v156, v182
    v_sub_f32 v189, v160, v183
    v_add_f32 v190, v180, v184
    v_add_f32 v191, v181, v185
    v_sub_f32 v192, v180, v184
    v_sub_f32 v193, v181, v185
    v_add_f32 v172, v186, v190
    v_add_f32 v173, v187, v191
    v_add_f32 v174, v188, v193
    v_sub_f32 v175, v189, v192
    v_sub_f32 v176, v186, v190
    v_sub_f32 v177, v191, v187
    v_sub_f32 v178, v188, v193
    v_sub_f32 v179, -v189, v192
    s_nop 7
    v_mul_f32 v180, v104, v165
    v_mul_f32 v181, v104, v169
    v_mul_f32 v182, v106, v166
    v_mul_f32 v183, v106, v170
    v_mul_f32 v184, v108, v167
    v_mul_f32 v185, v108, v171
    v_fmac_f32 v180, v105, v169
    v_fma_f32 v181, -v105, v165, v181
    v_fmac_f32 v182, v107, v170
    v_fma_f32 v183, -v107, v166, v183
    v_fmac_f32 v184, v109, v171
    v_fma_f32 v185, -v109, v167, v185
    v_add_f32 v186, v164, v182
    v_add_f32 v187, v168, v183
    v_sub_f32 v188, v164, v182
    v_sub_f32 v189, v168, v183
    v_add_f32 v190, v180, v184
    v_add_f32 v191, v181, v185
    v_sub_f32 v192, v180, v184
    v_sub_f32 v193, v181, v185
    v_add_f32 v164, v186, v190
    v_add_f32 v165, v187, v191
    v_add_f32 v166, v188, v193
    v_sub_f32 v167, v189, v192
    v_sub_f32 v168, v186, v190
    v_sub_f32 v169, v191, v187
    v_sub_f32 v170, v188, v193
    v_sub_f32 v171, -v189, v192
    v_cvt_pk_bf16_f32 v203, v172, v164
    v_cvt_pk_bf16_f32 v207, v173, v165
    v_cvt_pk_bf16_f32 v211, v174, v166
    v_cvt_pk_bf16_f32 v215, v175, v167
    v_cvt_pk_bf16_f32 v219, v176, v168
    v_cvt_pk_bf16_f32 v223, v177, v169
    v_cvt_pk_bf16_f32 v227, v178, v170
    v_cvt_pk_bf16_f32 v231, v179, v171
    s_nop 1
    v_mfma_f32_16x16x32_bf16 v[232:235], v[72:75], v[200:203], 0
    v_mfma_f32_16x16x32_bf16 v[236:239], v[80:83], v[200:203], 0
    v_mfma_f32_16x16x32_bf16 v[240:243], v[88:91], v[200:203], 0
    v_mfma_f32_16x16x32_bf16 v[244:247], v[96:99], v[200:203], 0
    v_mfma_f32_16x16x32_bf16 v[232:235], v[76:79], v[204:207], v[232:235]
    v_mfma_f32_16x16x32_bf16 v[236:239], v[84:87], v[204:207], v[236:239]
    v_mfma_f32_16x16x32_bf16 v[240:243], v[92:95], v[204:207], v[240:243]
    v_mfma_f32_16x16x32_bf16 v[244:247], v[100:103], v[204:207], v[244:247]
    s_nop 7
    v_cvt_pk_bf16_f32 v116, v232, v233
    v_cvt_pk_bf16_f32 v117, v234, v235
    v_cvt_pk_bf16_f32 v118, v236, v237
    v_cvt_pk_bf16_f32 v119, v238, v239
    v_cvt_pk_bf16_f32 v120, v240, v241
    v_cvt_pk_bf16_f32 v121, v242, v243
    v_cvt_pk_bf16_f32 v122, v244, v245
    v_cvt_pk_bf16_f32 v123, v246, v247
    v_and_or_b32 v116, v116, s33, v18
    v_and_or_b32 v117, v117, s33, v18
    v_and_or_b32 v118, v118, s33, v18
    v_and_or_b32 v119, v119, s33, v18
    v_and_or_b32 v120, v120, s33, v18
    v_and_or_b32 v121, v121, s33, v18
    v_and_or_b32 v122, v122, s33, v18
    v_and_or_b32 v123, v123, s33, v18
    s_mov_b64 exec, s[68:69]
    buffer_store_dwordx4 v[116:119], v110, s[36:39], s76 offen sc1
    buffer_store_dwordx4 v[120:123], v110, s[36:39], s75 offen sc1
    s_mov_b64 exec, -1
    s_nop 2
    v_mfma_f32_16x16x32_bf16 v[232:235], v[72:75], v[208:211], 0
    v_mfma_f32_16x16x32_bf16 v[236:239], v[80:83], v[208:211], 0
    v_mfma_f32_16x16x32_bf16 v[240:243], v[88:91], v[208:211], 0
    v_mfma_f32_16x16x32_bf16 v[244:247], v[96:99], v[208:211], 0
    v_mfma_f32_16x16x32_bf16 v[232:235], v[76:79], v[212:215], v[232:235]
    v_mfma_f32_16x16x32_bf16 v[236:239], v[84:87], v[212:215], v[236:239]
    v_mfma_f32_16x16x32_bf16 v[240:243], v[92:95], v[212:215], v[240:243]
    v_mfma_f32_16x16x32_bf16 v[244:247], v[100:103], v[212:215], v[244:247]
    s_nop 7
    v_cvt_pk_bf16_f32 v124, v232, v233
    v_cvt_pk_bf16_f32 v125, v234, v235
    v_cvt_pk_bf16_f32 v126, v236, v237
    v_cvt_pk_bf16_f32 v127, v238, v239
    v_cvt_pk_bf16_f32 v128, v240, v241
    v_cvt_pk_bf16_f32 v129, v242, v243
    v_cvt_pk_bf16_f32 v130, v244, v245
    v_cvt_pk_bf16_f32 v131, v246, v247
    v_and_or_b32 v124, v124, s33, v18
    v_and_or_b32 v125, v125, s33, v18
    v_and_or_b32 v126, v126, s33, v18
    v_and_or_b32 v127, v127, s33, v18
    v_and_or_b32 v128, v128, s33, v18
    v_and_or_b32 v129, v129, s33, v18
    v_and_or_b32 v130, v130, s33, v18
    v_and_or_b32 v131, v131, s33, v18
    s_mov_b64 exec, s[68:69]
    buffer_store_dwordx4 v[124:127], v111, s[36:39], s76 offen sc1
    buffer_store_dwordx4 v[128:131], v111, s[36:39], s75 offen sc1
    s_mov_b64 exec, -1
    s_nop 2
    v_mfma_f32_16x16x32_bf16 v[232:235], v[72:75], v[216:219], 0
    v_mfma_f32_16x16x32_bf16 v[236:239], v[80:83], v[216:219], 0
    v_mfma_f32_16x16x32_bf16 v[240:243], v[88:91], v[216:219], 0
    v_mfma_f32_16x16x32_bf16 v[244:247], v[96:99], v[216:219], 0
    v_mfma_f32_16x16x32_bf16 v[232:235], v[76:79], v[220:223], v[232:235]
    v_mfma_f32_16x16x32_bf16 v[236:239], v[84:87], v[220:223], v[236:239]
    v_mfma_f32_16x16x32_bf16 v[240:243], v[92:95], v[220:223], v[240:243]
    v_mfma_f32_16x16x32_bf16 v[244:247], v[100:103], v[220:223], v[244:247]
    s_nop 7
    v_cvt_pk_bf16_f32 v132, v232, v233
    v_cvt_pk_bf16_f32 v133, v234, v235
    v_cvt_pk_bf16_f32 v134, v236, v237
    v_cvt_pk_bf16_f32 v135, v238, v239
    v_cvt_pk_bf16_f32 v136, v240, v241
    v_cvt_pk_bf16_f32 v137, v242, v243
    v_cvt_pk_bf16_f32 v138, v244, v245
    v_cvt_pk_bf16_f32 v139, v246, v247
    v_and_or_b32 v132, v132, s33, v18
    v_and_or_b32 v133, v133, s33, v18
    v_and_or_b32 v134, v134, s33, v18
    v_and_or_b32 v135, v135, s33, v18
    v_and_or_b32 v136, v136, s33, v18
    v_and_or_b32 v137, v137, s33, v18
    v_and_or_b32 v138, v138, s33, v18
    v_and_or_b32 v139, v139, s33, v18
    s_cmp_eq_u32 s73, 5
    s_cbranch_scc1 L_B1done
    s_mov_b64 exec, s[68:69]
    buffer_store_dwordx4 v[132:135], v112, s[36:39], s76 offen sc1
    buffer_store_dwordx4 v[136:139], v112, s[36:39], s75 offen sc1
    s_mov_b64 exec, -1
    s_nop 2
    v_mfma_f32_16x16x32_bf16 v[232:235], v[72:75], v[224:227], 0
    v_mfma_f32_16x16x32_bf16 v[236:239], v[80:83], v[224:227], 0
    v_mfma_f32_16x16x32_bf16 v[240:243], v[88:91], v[224:227], 0
    v_mfma_f32_16x16x32_bf16 v[244:247], v[96:99], v[224:227], 0
    v_mfma_f32_16x16x32_bf16 v[232:235], v[76:79], v[228:231], v[232:235]
    v_mfma_f32_16x16x32_bf16 v[236:239], v[84:87], v[228:231], v[236:239]
    v_mfma_f32_16x16x32_bf16 v[240:243], v[92:95], v[228:231], v[240:243]
    v_mfma_f32_16x16x32_bf16 v[244:247], v[100:103], v[228:231], v[244:247]
    s_nop 7
    v_cvt_pk_bf16_f32 v140, v232, v233
    v_cvt_pk_bf16_f32 v141, v234, v235
    v_cvt_pk_bf16_f32 v142, v236, v237
    v_cvt_pk_bf16_f32 v143, v238, v239
    v_cvt_pk_bf16_f32 v144, v240, v241
    v_cvt_pk_bf16_f32 v145, v242, v243
    v_cvt_pk_bf16_f32 v146, v244, v245
    v_cvt_pk_bf16_f32 v147, v246, v247
    v_and_or_b32 v140, v140, s33, v18
    v_and_or_b32 v141, v141, s33, v18
    v_and_or_b32 v142, v142, s33, v18
    v_and_or_b32 v143, v143, s33, v18
    v_and_or_b32 v144, v144, s33, v18
    v_and_or_b32 v145, v145, s33, v18
    v_and_or_b32 v146, v146, s33, v18
    v_and_or_b32 v147, v147, s33, v18
    s_mov_b64 exec, s[68:69]
    buffer_store_dwordx4 v[140:143], v113, s[36:39], s76 offen sc1
    buffer_store_dwordx4 v[144:147], v113, s[36:39], s75 offen sc1
    s_mov_b64 exec, -1
    s_nop 2
L_B1done:
    s_setprio 0
    s_lshl_b32 s51, s45, 2
    s_lshl_b32 s50, s72, 10
    s_sub_u32 s50, 1024, s50
    s_add_u32 s51, s51, s50
    s_mul_i32 s50, s74, 3
    s_add_u32 s52, s50, 0
    s_and_b32 s53, s52, 3
    s_lshr_b32 s52, s52, 2
    s_lshl_b32 s52, s52, 9
    s_add_u32 s52, s52, s53
    s_add_u32 s8, s52, s51
    s_add_u32 s52, s50, 1
    s_and_b32 s53, s52, 3
    s_lshr_b32 s52, s52, 2
    s_lshl_b32 s52, s52, 9
    s_add_u32 s52, s52, s53
    s_add_u32 s9, s52, s51
    s_add_u32 s52, s50, 2
    s_and_b32 s53, s52, 3
    s_lshr_b32 s52, s52, 2
    s_lshl_b32 s52, s52, 9
    s_add_u32 s52, s52, s53
    s_add_u32 s10, s52, s51
    v_lshl_add_u32 v180, v21, 5, s8
    v_cvt_f32_u32 v180, v180
    v_cvt_f32_u32 v181, v20
    v_mul_f32 v181, 4.0, v181
    v_add_f32 v23, 0x0, v180
    v_mul_f32 v23, 0x3a000000, v23
    v_mul_f32 v22, v181, v23
    v_fmamk_f32 v182, v23, 0x0, v22
    v_fmamk_f32 v183, v23, 0x3f800000, v22
    v_fract_f32 v182, v182
    v_fract_f32 v183, v183
    v_cos_f32 v184, v182
    v_sin_f32 v185, v182
    v_cos_f32 v186, v183
    v_sin_f32 v187, v183
    v_cvt_pk_bf16_f32 v32, v184, v185
    v_cvt_pk_bf16_f32 v33, v186, v187
    v_fmamk_f32 v182, v23, 0x40000000, v22
    v_fmamk_f32 v183, v23, 0x40400000, v22
    v_fract_f32 v182, v182
    v_fract_f32 v183, v183
    v_cos_f32 v184, v182
    v_sin_f32 v185, v182
    v_cos_f32 v186, v183
    v_sin_f32 v187, v183
    v_cvt_pk_bf16_f32 v34, v184, v185
    v_cvt_pk_bf16_f32 v35, v186, v187
    v_fmamk_f32 v182, v23, 0x41800000, v22
    v_fmamk_f32 v183, v23, 0x41880000, v22
    v_fract_f32 v182, v182
    v_fract_f32 v183, v183
    v_cos_f32 v184, v182
    v_sin_f32 v185, v182
    v_cos_f32 v186, v183
    v_sin_f32 v187, v183
    v_cvt_pk_bf16_f32 v36, v184, v185
    v_cvt_pk_bf16_f32 v37, v186, v187
    v_fmamk_f32 v182, v23, 0x41900000, v22
    v_fmamk_f32 v183, v23, 0x41980000, v22
    v_fract_f32 v182, v182
    v_fract_f32 v183, v183
    v_cos_f32 v184, v182
    v_sin_f32 v185, v182
    v_cos_f32 v186, v183
    v_sin_f32 v187, v183
    v_cvt_pk_bf16_f32 v38, v184, v185
    v_cvt_pk_bf16_f32 v39, v186, v187
    v_fmamk_f32 v182, v23, 0x42000000, v22
    v_fmamk_f32 v183, v23, 0x42040000, v22
    v_fract_f32 v182, v182
    v_fract_f32 v183, v183
    v_cos_f32 v184, v182
    v_sin_f32 v185, v182
    v_cos_f32 v186, v183
    v_sin_f32 v187, v183
    v_cvt_pk_bf16_f32 v40, v184, v185
    v_cvt_pk_bf16_f32 v41, v186, v187
    v_fmamk_f32 v182, v23, 0x42080000, v22
    v_fmamk_f32 v183, v23, 0x420c0000, v22
    v_fract_f32 v182, v182
    v_fract_f32 v183, v183
    v_cos_f32 v184, v182
    v_sin_f32 v185, v182
    v_cos_f32 v186, v183
    v_sin_f32 v187, v183
    v_cvt_pk_bf16_f32 v42, v184, v185
    v_cvt_pk_bf16_f32 v43, v186, v187
    v_fmamk_f32 v182, v23, 0x42400000, v22
    v_fmamk_f32 v183, v23, 0x42440000, v22
    v_fract_f32 v182, v182
    v_fract_f32 v183, v183
    v_cos_f32 v184, v182
    v_sin_f32 v185, v182
    v_cos_f32 v186, v183
    v_sin_f32 v187, v183
    v_cvt_pk_bf16_f32 v44, v184, v185
    v_cvt_pk_bf16_f32 v45, v186, v187
    v_fmamk_f32 v182, v23, 0x42480000, v22
    v_fmamk_f32 v183, v23, 0x424c0000, v22
    v_fract_f32 v182, v182
    v_fract_f32 v183, v183
    v_cos_f32 v184, v182
    v_sin_f32 v185, v182
    v_cos_f32 v186, v183
    v_sin_f32 v187, v183
    v_cvt_pk_bf16_f32 v46, v184, v185
    v_cvt_pk_bf16_f32 v47, v186, v187
    v_lshl_add_u32 v180, v21, 5, s9
    v_cvt_f32_u32 v180, v180
    v_cvt_f32_u32 v181, v20
    v_mul_f32 v181, 4.0, v181
    v_add_f32 v23, 0x0, v180
    v_mul_f32 v23, 0x3a000000, v23
    v_mul_f32 v22, v181, v23
    v_fmamk_f32 v182, v23, 0x0, v22
    v_fmamk_f32 v183, v23, 0x3f800000, v22
    v_fract_f32 v182, v182
    v_fract_f32 v183, v183
    v_cos_f32 v184, v182
    v_sin_f32 v185, v182
    v_cos_f32 v186, v183
    v_sin_f32 v187, v183
    v_cvt_pk_bf16_f32 v48, v184, v185
    v_cvt_pk_bf16_f32 v49, v186, v187
    v_fmamk_f32 v182, v23, 0x40000000, v22
    v_fmamk_f32 v183, v23, 0x40400000, v22
    v_fract_f32 v182, v182
    v_fract_f32 v183, v183
    v_cos_f32 v184, v182
    v_sin_f32 v185, v182
    v_cos_f32 v186, v183
    v_sin_f32 v187, v183
    v_cvt_pk_bf16_f32 v50, v184, v185
    v_cvt_pk_bf16_f32 v51, v186, v187
    v_fmamk_f32 v182, v23, 0x41800000, v22
    v_fmamk_f32 v183, v23, 0x41880000, v22
    v_fract_f32 v182, v182
    v_fract_f32 v183, v183
    v_cos_f32 v184, v182
    v_sin_f32 v185, v182
    v_cos_f32 v186, v183
    v_sin_f32 v187, v183
    v_cvt_pk_bf16_f32 v52, v184, v185
    v_cvt_pk_bf16_f32 v53, v186, v187
    v_fmamk_f32 v182, v23, 0x41900000, v22
    v_fmamk_f32 v183, v23, 0x41980000, v22
    v_fract_f32 v182, v182
    v_fract_f32 v183, v183
    v_cos_f32 v184, v182
    v_sin_f32 v185, v182
    v_cos_f32 v186, v183
    v_sin_f32 v187, v183
    v_cvt_pk_bf16_f32 v54, v184, v185
    v_cvt_pk_bf16_f32 v55, v186, v187
    v_fmamk_f32 v182, v23, 0x42000000, v22
    v_fmamk_f32 v183, v23, 0x42040000, v22
    v_fract_f32 v182, v182
    v_fract_f32 v183, v183
    v_cos_f32 v184, v182
    v_sin_f32 v185, v182
    v_cos_f32 v186, v183
    v_sin_f32 v187, v183
    v_cvt_pk_bf16_f32 v56, v184, v185
    v_cvt_pk_bf16_f32 v57, v186, v187
    v_fmamk_f32 v182, v23, 0x42080000, v22
    v_fmamk_f32 v183, v23, 0x420c0000, v22
    v_fract_f32 v182, v182
    v_fract_f32 v183, v183
    v_cos_f32 v184, v182
    v_sin_f32 v185, v182
    v_cos_f32 v186, v183
    v_sin_f32 v187, v183
    v_cvt_pk_bf16_f32 v58, v184, v185
    v_cvt_pk_bf16_f32 v59, v186, v187
    v_fmamk_f32 v182, v23, 0x42400000, v22
    v_fmamk_f32 v183, v23, 0x42440000, v22
    v_fract_f32 v182, v182
    v_fract_f32 v183, v183
    v_cos_f32 v184, v182
    v_sin_f32 v185, v182
    v_cos_f32 v186, v183
    v_sin_f32 v187, v183
    v_cvt_pk_bf16_f32 v60, v184, v185
    v_cvt_pk_bf16_f32 v61, v186, v187
    v_fmamk_f32 v182, v23, 0x42480000, v22
    v_fmamk_f32 v183, v23, 0x424c0000, v22
    v_fract_f32 v182, v182
    v_fract_f32 v183, v183
    v_cos_f32 v184, v182
    v_sin_f32 v185, v182
    v_cos_f32 v186, v183
    v_sin_f32 v187, v183
    v_cvt_pk_bf16_f32 v62, v184, v185
    v_cvt_pk_bf16_f32 v63, v186, v187
    v_lshl_add_u32 v180, v21, 5, s10
    v_cvt_f32_u32 v180, v180
    v_cvt_f32_u32 v181, v20
    v_mul_f32 v181, 4.0, v181
    v_add_f32 v23, 0x0, v180
    v_mul_f32 v23, 0x3a000000, v23
    v_mul_f32 v22, v181, v23
    v_fmamk_f32 v182, v23, 0x0, v22
    v_fmamk_f32 v183, v23, 0x3f800000, v22
    v_fract_f32 v182, v182
    v_fract_f32 v183, v183
    v_cos_f32 v184, v182
    v_sin_f32 v185, v182
    v_cos_f32 v186, v183
    v_sin_f32 v187, v183
    v_cvt_pk_bf16_f32 v64, v184, v185
    v_cvt_pk_bf16_f32 v65, v186, v187
    v_fmamk_f32 v182, v23, 0x40000000, v22
    v_fmamk_f32 v183, v23, 0x40400000, v22
    v_fract_f32 v182, v182
    v_fract_f32 v183, v183
    v_cos_f32 v184, v182
    v_sin_f32 v185, v182
    v_cos_f32 v186, v183
    v_sin_f32 v187, v183
    v_cvt_pk_bf16_f32 v66, v184, v185
    v_cvt_pk_bf16_f32 v67, v186, v187
    v_fmamk_f32 v182, v23, 0x41800000, v22
    v_fmamk_f32 v183, v23, 0x41880000, v22
    v_fract_f32 v182, v182
    v_fract_f32 v183, v183
    v_cos_f32 v184, v182
    v_sin_f32 v185, v182
    v_cos_f32 v186, v183
    v_sin_f32 v187, v183
    v_cvt_pk_bf16_f32 v68, v184, v185
    v_cvt_pk_bf16_f32 v69, v186, v187
    v_fmamk_f32 v182, v23, 0x41900000, v22
    v_fmamk_f32 v183, v23, 0x41980000, v22
    v_fract_f32 v182, v182
    v_fract_f32 v183, v183
    v_cos_f32 v184, v182
    v_sin_f32 v185, v182
    v_cos_f32 v186, v183
    v_sin_f32 v187, v183
    v_cvt_pk_bf16_f32 v70, v184, v185
    v_cvt_pk_bf16_f32 v71, v186, v187
    v_fmamk_f32 v182, v23, 0x42000000, v22
    v_fmamk_f32 v183, v23, 0x42040000, v22
    v_fract_f32 v182, v182
    v_fract_f32 v183, v183
    v_cos_f32 v184, v182
    v_sin_f32 v185, v182
    v_cos_f32 v186, v183
    v_sin_f32 v187, v183
    v_cvt_pk_bf16_f32 v72, v184, v185
    v_cvt_pk_bf16_f32 v73, v186, v187
    v_fmamk_f32 v182, v23, 0x42080000, v22
    v_fmamk_f32 v183, v23, 0x420c0000, v22
    v_fract_f32 v182, v182
    v_fract_f32 v183, v183
    v_cos_f32 v184, v182
    v_sin_f32 v185, v182
    v_cos_f32 v186, v183
    v_sin_f32 v187, v183
    v_cvt_pk_bf16_f32 v74, v184, v185
    v_cvt_pk_bf16_f32 v75, v186, v187
    v_fmamk_f32 v182, v23, 0x42400000, v22
    v_fmamk_f32 v183, v23, 0x42440000, v22
    v_fract_f32 v182, v182
    v_fract_f32 v183, v183
    v_cos_f32 v184, v182
    v_sin_f32 v185, v182
    v_cos_f32 v186, v183
    v_sin_f32 v187, v183
    v_cvt_pk_bf16_f32 v76, v184, v185
    v_cvt_pk_bf16_f32 v77, v186, v187
    v_fmamk_f32 v182, v23, 0x42480000, v22
    v_fmamk_f32 v183, v23, 0x424c0000, v22
    v_fract_f32 v182, v182
    v_fract_f32 v183, v183
    v_cos_f32 v184, v182
    v_sin_f32 v185, v182
    v_cos_f32 v186, v183
    v_sin_f32 v187, v183
    v_cvt_pk_bf16_f32 v78, v184, v185
    v_cvt_pk_bf16_f32 v79, v186, v187
    v_mov_b32 v28, 1
    ds_write_b32 v19, v28
    s_waitcnt lgkmcnt(0)
    s_branch L_b2
L_hC:
    s_lshl_b32 s50, s45, 4
    s_lshr_b32 s51, s43, 1
    s_add_u32 s50, s50, s51
    s_lshl_b32 s50, s50, 1
    s_add_u32 s51, s50, s74
    s_lshl_b32 s76, s51, 13
    s_cmp_lt_u32 s51, 224
    s_cselect_b32 s73, 1, 0
    s_cmp_lt_u32 s74, 2
    s_cselect_b32 s73, s73, 0
    s_mul_i32 s52, s51, 2341
    s_lshr_b32 s52, s52, 16
    s_mul_i32 s53, s52, 28
    s_sub_u32 s53, s51, s53
    s_mul_i32 s56, s53, 37
    s_lshr_b32 s56, s56, 8
    s_lshl_b32 s57, s52, 2
    s_add_u32 s56, s56, s57
    s_lshl_b32 s56, s56, 9
    s_add_u32 s56, s56, 9043968
    s_mul_i32 s35, s53, 37
    s_lshr_b32 s35, s35, 8
    s_lshl_b32 s57, s35, 7
    s_mul_i32 s35, s35, 7
    s_sub_u32 s58, s53, s35
    s_add_u32 s57, s57, s58
    s_lshl_b32 s35, s52, 11
    s_add_u32 s57, s57, s35
    s_cmp_eq_u32 s58, 6
    s_cselect_b32 s77, 255, 15
    s_add_u32 s57, s57, 9109504
    s_lshl_b32 s52, s52, 13
    s_lshl_b32 s53, s53, 8
    s_add_u32 s75, s52, s53
    s_add_u32 s75, s75, 2097152
    v_lshlrev_b32 v5, 4, v21
    v_and_b32 v28, 1, v20
    v_lshl_add_u32 v5, v28, 3, v5
    v_lshrrev_b32 v28, 1, v20
    v_lshl_add_u32 v5, v28, 16, v5
    s_lshl_b32 s51, s45, 2
    s_lshl_b32 s50, s72, 10
    s_sub_u32 s50, 1024, s50
    s_add_u32 s51, s51, s50
    s_mul_i32 s50, s74, 3
    s_add_u32 s52, s50, 0
    s_and_b32 s53, s52, 3
    s_lshr_b32 s52, s52, 2
    s_lshl_b32 s52, s52, 9
    s_add_u32 s52, s52, s53
    s_add_u32 s8, s52, s51
    s_add_u32 s52, s50, 1
    s_and_b32 s53, s52, 3
    s_lshr_b32 s52, s52, 2
    s_lshl_b32 s52, s52, 9
    s_add_u32 s52, s52, s53
    s_add_u32 s9, s52, s51
    s_add_u32 s52, s50, 2
    s_and_b32 s53, s52, 3
    s_lshr_b32 s52, s52, 2
    s_lshl_b32 s52, s52, 9
    s_add_u32 s52, s52, s53
    s_add_u32 s10, s52, s51
    v_lshl_add_u32 v180, v21, 5, s8
    v_cvt_f32_u32 v180, v180
    v_cvt_f32_u32 v181, v20
    v_mul_f32 v181, 4.0, v181
    v_add_f32 v23, 0x0, v180
    v_mul_f32 v23, 0x3a000000, v23
    v_mul_f32 v22, v181, v23
    v_fmamk_f32 v182, v23, 0x0, v22
    v_fmamk_f32 v183, v23, 0x3f800000, v22
    v_fract_f32 v182, v182
    v_fract_f32 v183, v183
    v_cos_f32 v184, v182
    v_sin_f32 v185, v182
    v_cos_f32 v186, v183
    v_sin_f32 v187, v183
    v_cvt_pk_bf16_f32 v32, v184, v185
    v_cvt_pk_bf16_f32 v33, v186, v187
    v_fmamk_f32 v182, v23, 0x40000000, v22
    v_fmamk_f32 v183, v23, 0x40400000, v22
    v_fract_f32 v182, v182
    v_fract_f32 v183, v183
    v_cos_f32 v184, v182
    v_sin_f32 v185, v182
    v_cos_f32 v186, v183
    v_sin_f32 v187, v183
    v_cvt_pk_bf16_f32 v34, v184, v185
    v_cvt_pk_bf16_f32 v35, v186, v187
    v_fmamk_f32 v182, v23, 0x41800000, v22
    v_fmamk_f32 v183, v23, 0x41880000, v22
    v_fract_f32 v182, v182
    v_fract_f32 v183, v183
    v_cos_f32 v184, v182
    v_sin_f32 v185, v182
    v_cos_f32 v186, v183
    v_sin_f32 v187, v183
    v_cvt_pk_bf16_f32 v36, v184, v185
    v_cvt_pk_bf16_f32 v37, v186, v187
    v_fmamk_f32 v182, v23, 0x41900000, v22
    v_fmamk_f32 v183, v23, 0x41980000, v22
    v_fract_f32 v182, v182
    v_fract_f32 v183, v183
    v_cos_f32 v184, v182
    v_sin_f32 v185, v182
    v_cos_f32 v186, v183
    v_sin_f32 v187, v183
    v_cvt_pk_bf16_f32 v38, v184, v185
    v_cvt_pk_bf16_f32 v39, v186, v187
    v_fmamk_f32 v182, v23, 0x42000000, v22
    v_fmamk_f32 v183, v23, 0x42040000, v22
    v_fract_f32 v182, v182
    v_fract_f32 v183, v183
    v_cos_f32 v184, v182
    v_sin_f32 v185, v182
    v_cos_f32 v186, v183
    v_sin_f32 v187, v183
    v_cvt_pk_bf16_f32 v40, v184, v185
    v_cvt_pk_bf16_f32 v41, v186, v187
    v_fmamk_f32 v182, v23, 0x42080000, v22
    v_fmamk_f32 v183, v23, 0x420c0000, v22
    v_fract_f32 v182, v182
    v_fract_f32 v183, v183
    v_cos_f32 v184, v182
    v_sin_f32 v185, v182
    v_cos_f32 v186, v183
    v_sin_f32 v187, v183
    v_cvt_pk_bf16_f32 v42, v184, v185
    v_cvt_pk_bf16_f32 v43, v186, v187
    v_fmamk_f32 v182, v23, 0x42400000, v22
    v_fmamk_f32 v183, v23, 0x42440000, v22
    v_fract_f32 v182, v182
    v_fract_f32 v183, v183
    v_cos_f32 v184, v182
    v_sin_f32 v185, v182
    v_cos_f32 v186, v183
    v_sin_f32 v187, v183
    v_cvt_pk_bf16_f32 v44, v184, v185
    v_cvt_pk_bf16_f32 v45, v186, v187
    v_fmamk_f32 v182, v23, 0x42480000, v22
    v_fmamk_f32 v183, v23, 0x424c0000, v22
    v_fract_f32 v182, v182
    v_fract_f32 v183, v183
    v_cos_f32 v184, v182
    v_sin_f32 v185, v182
    v_cos_f32 v186, v183
    v_sin_f32 v187, v183
    v_cvt_pk_bf16_f32 v46, v184, v185
    v_cvt_pk_bf16_f32 v47, v186, v187
    v_lshl_add_u32 v180, v21, 5, s9
    v_cvt_f32_u32 v180, v180
    v_cvt_f32_u32 v181, v20
    v_mul_f32 v181, 4.0, v181
    v_add_f32 v23, 0x0, v180
    v_mul_f32 v23, 0x3a000000, v23
    v_mul_f32 v22, v181, v23
    v_fmamk_f32 v182, v23, 0x0, v22
    v_fmamk_f32 v183, v23, 0x3f800000, v22
    v_fract_f32 v182, v182
    v_fract_f32 v183, v183
    v_cos_f32 v184, v182
    v_sin_f32 v185, v182
    v_cos_f32 v186, v183
    v_sin_f32 v187, v183
    v_cvt_pk_bf16_f32 v48, v184, v185
    v_cvt_pk_bf16_f32 v49, v186, v187
    v_fmamk_f32 v182, v23, 0x40000000, v22
    v_fmamk_f32 v183, v23, 0x40400000, v22
    v_fract_f32 v182, v182
    v_fract_f32 v183, v183
    v_cos_f32 v184, v182
    v_sin_f32 v185, v182
    v_cos_f32 v186, v183
    v_sin_f32 v187, v183
    v_cvt_pk_bf16_f32 v50, v184, v185
    v_cvt_pk_bf16_f32 v51, v186, v187
    v_fmamk_f32 v182, v23, 0x41800000, v22
    v_fmamk_f32 v183, v23, 0x41880000, v22
    v_fract_f32 v182, v182
    v_fract_f32 v183, v183
    v_cos_f32 v184, v182
    v_sin_f32 v185, v182
    v_cos_f32 v186, v183
    v_sin_f32 v187, v183
    v_cvt_pk_bf16_f32 v52, v184, v185
    v_cvt_pk_bf16_f32 v53, v186, v187
    v_fmamk_f32 v182, v23, 0x41900000, v22
    v_fmamk_f32 v183, v23, 0x41980000, v22
    v_fract_f32 v182, v182
    v_fract_f32 v183, v183
    v_cos_f32 v184, v182
    v_sin_f32 v185, v182
    v_cos_f32 v186, v183
    v_sin_f32 v187, v183
    v_cvt_pk_bf16_f32 v54, v184, v185
    v_cvt_pk_bf16_f32 v55, v186, v187
    v_fmamk_f32 v182, v23, 0x42000000, v22
    v_fmamk_f32 v183, v23, 0x42040000, v22
    v_fract_f32 v182, v182
    v_fract_f32 v183, v183
    v_cos_f32 v184, v182
    v_sin_f32 v185, v182
    v_cos_f32 v186, v183
    v_sin_f32 v187, v183
    v_cvt_pk_bf16_f32 v56, v184, v185
    v_cvt_pk_bf16_f32 v57, v186, v187
    v_fmamk_f32 v182, v23, 0x42080000, v22
    v_fmamk_f32 v183, v23, 0x420c0000, v22
    v_fract_f32 v182, v182
    v_fract_f32 v183, v183
    v_cos_f32 v184, v182
    v_sin_f32 v185, v182
    v_cos_f32 v186, v183
    v_sin_f32 v187, v183
    v_cvt_pk_bf16_f32 v58, v184, v185
    v_cvt_pk_bf16_f32 v59, v186, v187
    v_fmamk_f32 v182, v23, 0x42400000, v22
    v_fmamk_f32 v183, v23, 0x42440000, v22
    v_fract_f32 v182, v182
    v_fract_f32 v183, v183
    v_cos_f32 v184, v182
    v_sin_f32 v185, v182
    v_cos_f32 v186, v183
    v_sin_f32 v187, v183
    v_cvt_pk_bf16_f32 v60, v184, v185
    v_cvt_pk_bf16_f32 v61, v186, v187
    v_fmamk_f32 v182, v23, 0x42480000, v22
    v_fmamk_f32 v183, v23, 0x424c0000, v22
    v_fract_f32 v182, v182
    v_fract_f32 v183, v183
    v_cos_f32 v184, v182
    v_sin_f32 v185, v182
    v_cos_f32 v186, v183
    v_sin_f32 v187, v183
    v_cvt_pk_bf16_f32 v62, v184, v185
    v_cvt_pk_bf16_f32 v63, v186, v187
    v_lshl_add_u32 v180, v21, 5, s10
    v_cvt_f32_u32 v180, v180
    v_cvt_f32_u32 v181, v20
    v_mul_f32 v181, 4.0, v181
    v_add_f32 v23, 0x0, v180
    v_mul_f32 v23, 0x3a000000, v23
    v_mul_f32 v22, v181, v23
    v_fmamk_f32 v182, v23, 0x0, v22
    v_fmamk_f32 v183, v23, 0x3f800000, v22
    v_fract_f32 v182, v182
    v_fract_f32 v183, v183
    v_cos_f32 v184, v182
    v_sin_f32 v185, v182
    v_cos_f32 v186, v183
    v_sin_f32 v187, v183
    v_cvt_pk_bf16_f32 v64, v184, v185
    v_cvt_pk_bf16_f32 v65, v186, v187
    v_fmamk_f32 v182, v23, 0x40000000, v22
    v_fmamk_f32 v183, v23, 0x40400000, v22
    v_fract_f32 v182, v182
    v_fract_f32 v183, v183
    v_cos_f32 v184, v182
    v_sin_f32 v185, v182
    v_cos_f32 v186, v183
    v_sin_f32 v187, v183
    v_cvt_pk_bf16_f32 v66, v184, v185
    v_cvt_pk_bf16_f32 v67, v186, v187
    v_fmamk_f32 v182, v23, 0x41800000, v22
    v_fmamk_f32 v183, v23, 0x41880000, v22
    v_fract_f32 v182, v182
    v_fract_f32 v183, v183
    v_cos_f32 v184, v182
    v_sin_f32 v185, v182
    v_cos_f32 v186, v183
    v_sin_f32 v187, v183
    v_cvt_pk_bf16_f32 v68, v184, v185
    v_cvt_pk_bf16_f32 v69, v186, v187
    v_fmamk_f32 v182, v23, 0x41900000, v22
    v_fmamk_f32 v183, v23, 0x41980000, v22
    v_fract_f32 v182, v182
    v_fract_f32 v183, v183
    v_cos_f32 v184, v182
    v_sin_f32 v185, v182
    v_cos_f32 v186, v183
    v_sin_f32 v187, v183
    v_cvt_pk_bf16_f32 v70, v184, v185
    v_cvt_pk_bf16_f32 v71, v186, v187
    v_fmamk_f32 v182, v23, 0x42000000, v22
    v_fmamk_f32 v183, v23, 0x42040000, v22
    v_fract_f32 v182, v182
    v_fract_f32 v183, v183
    v_cos_f32 v184, v182
    v_sin_f32 v185, v182
    v_cos_f32 v186, v183
    v_sin_f32 v187, v183
    v_cvt_pk_bf16_f32 v72, v184, v185
    v_cvt_pk_bf16_f32 v73, v186, v187
    v_fmamk_f32 v182, v23, 0x42080000, v22
    v_fmamk_f32 v183, v23, 0x420c0000, v22
    v_fract_f32 v182, v182
    v_fract_f32 v183, v183
    v_cos_f32 v184, v182
    v_sin_f32 v185, v182
    v_cos_f32 v186, v183
    v_sin_f32 v187, v183
    v_cvt_pk_bf16_f32 v74, v184, v185
    v_cvt_pk_bf16_f32 v75, v186, v187
    v_fmamk_f32 v182, v23, 0x42400000, v22
    v_fmamk_f32 v183, v23, 0x42440000, v22
    v_fract_f32 v182, v182
    v_fract_f32 v183, v183
    v_cos_f32 v184, v182
    v_sin_f32 v185, v182
    v_cos_f32 v186, v183
    v_sin_f32 v187, v183
    v_cvt_pk_bf16_f32 v76, v184, v185
    v_cvt_pk_bf16_f32 v77, v186, v187
    v_fmamk_f32 v182, v23, 0x42480000, v22
    v_fmamk_f32 v183, v23, 0x424c0000, v22
    v_fract_f32 v182, v182
    v_fract_f32 v183, v183
    v_cos_f32 v184, v182
    v_sin_f32 v185, v182
    v_cos_f32 v186, v183
    v_sin_f32 v187, v183
    v_cvt_pk_bf16_f32 v78, v184, v185
    v_cvt_pk_bf16_f32 v79, v186, v187
    s_cmp_ge_u32 s47, 3
    s_cbranch_scc1 WD_189
WF_188:
    s_sleep 2
    ds_read_b32 v28, v17 offset:0
    s_sub_u32 s46, s46, 1
    s_cselect_b32 s46, 0, s46
    s_cbranch_scc1 WD_189
    s_waitcnt lgkmcnt(0)
    v_readfirstlane_b32 s47, v28
    s_cmp_ge_u32 s47, 3
    s_cbranch_scc0 WF_188
WD_189:
    s_mul_i32 s50, s44, 20
    s_add_u32 s50, s50, s74
    s_mul_i32 s50, s50, 1280
    s_and_b32 s51, s45, 1
    s_mul_i32 s51, s51, 640
    s_add_u32 s50, s50, s51
    s_add_u32 s50, s50, 0
    s_add_u32 s4, s20, s50
    s_addc_u32 s5, s21, 0
    s_cmp_eq_u32 s74, 2
    s_cselect_b32 s50, 6, 7
PF_190:
    s_load_dword s6, s[4:5], 0
    s_load_dword s6, s[4:5], 64
    s_load_dword s6, s[4:5], 128
    s_load_dword s6, s[4:5], 192
    s_load_dword s6, s[4:5], 256
    s_load_dword s6, s[4:5], 320
    s_load_dword s6, s[4:5], 384
    s_load_dword s6, s[4:5], 448
    s_load_dword s6, s[4:5], 512
    s_load_dword s6, s[4:5], 576
    s_add_u32 s4, s4, 3840
    s_addc_u32 s5, s5, 0
    s_sub_u32 s50, s50, 1
    s_cmp_lg_u32 s50, 0
    s_cbranch_scc1 PF_190
    s_mov_b32 s70, 0x3fb8aa3b
    s_mov_b32 s71, 0x3fb8aa3b
    v_mul_u32_u24 v29, 9216, v20
    v_mul_u32_u24 v31, 144, v21
    s_mul_i32 s50, s74, 2304
    s_add_u32 s50, s50, 71680
    v_add3_u32 v3, v29, v31, s50
    s_lshl_b32 s50, s74, 2
    v_add_u32 v4, s50, v17
    s_mov_b32 s52, s74
    s_setprio 2
    s_waitcnt lgkmcnt(0)
    s_mov_b32 s49, 0
    s_cmp_ge_u32 s49, 10
    s_cbranch_scc1 WD_194
WF_193:
    s_sleep 1
    ds_read_b32 v28, v4 offset:16
    s_sub_u32 s46, s46, 1
    s_cselect_b32 s46, 0, s46
    s_cbranch_scc1 WD_194
    s_waitcnt lgkmcnt(0)
    v_readfirstlane_b32 s49, v28
    s_cmp_ge_u32 s49, 10
    s_cbranch_scc0 WF_193
WD_194:
    ds_read_b128 v[180:183], v3 offset:0
    ds_read_b128 v[184:187], v3 offset:16
    ds_read_b128 v[188:191], v3 offset:32
    ds_read_b128 v[192:195], v3 offset:48
    ds_read_b128 v[196:199], v3 offset:64
    s_waitcnt lgkmcnt(0)
    v_max3_f32 v230, v180, v181, v182
    v_min3_f32 v232, v180, v181, v182
    v_max3_f32 v231, v183, v184, v185
    v_min3_f32 v233, v183, v184, v185
    v_max3_f32 v230, v230, v186, v187
    v_min3_f32 v232, v232, v186, v187
    v_max3_f32 v231, v231, v188, v189
    v_min3_f32 v233, v233, v188, v189
    v_max3_f32 v230, v230, v190, v191
    v_min3_f32 v232, v232, v190, v191
    v_max3_f32 v231, v231, v192, v193
    v_min3_f32 v233, v233, v192, v193
    v_max3_f32 v230, v230, v194, v195
    v_min3_f32 v232, v232, v194, v195
    v_max3_f32 v231, v231, v196, v197
    v_min3_f32 v233, v233, v196, v197
    v_max3_f32 v230, v230, v198, v199
    v_min3_f32 v232, v232, v198, v199
    v_max_f32 v230, v230, v231
    v_min_f32 v232, v232, v233
    v_mul_f32 v230, s70, v230
    v_mul_f32 v232, s70, v232
    v_fma_f32 v200, -v180, s70, v232
    v_fma_f32 v201, -v181, s70, v232
    v_fma_f32 v180, v180, s70, -v230
    v_fma_f32 v181, v181, s70, -v230
    v_fma_f32 v202, -v182, s70, v232
    v_fma_f32 v203, -v183, s70, v232
    v_fma_f32 v182, v182, s70, -v230
    v_fma_f32 v183, v183, s70, -v230
    v_fma_f32 v204, -v184, s70, v232
    v_fma_f32 v205, -v185, s70, v232
    v_fma_f32 v184, v184, s70, -v230
    v_fma_f32 v185, v185, s70, -v230
    v_fma_f32 v206, -v186, s70, v232
    v_fma_f32 v207, -v187, s70, v232
    v_fma_f32 v186, v186, s70, -v230
    v_fma_f32 v187, v187, s70, -v230
    v_fma_f32 v208, -v188, s70, v232
    v_fma_f32 v209, -v189, s70, v232
    v_fma_f32 v188, v188, s70, -v230
    v_fma_f32 v189, v189, s70, -v230
    v_fma_f32 v210, -v190, s70, v232
    v_fma_f32 v211, -v191, s70, v232
    v_fma_f32 v190, v190, s70, -v230
    v_fma_f32 v191, v191, s70, -v230
    v_fma_f32 v212, -v192, s70, v232
    v_fma_f32 v213, -v193, s70, v232
    v_fma_f32 v192, v192, s70, -v230
    v_fma_f32 v193, v193, s70, -v230
    v_fma_f32 v214, -v194, s70, v232
    v_fma_f32 v215, -v195, s70, v232
    v_fma_f32 v194, v194, s70, -v230
    v_fma_f32 v195, v195, s70, -v230
    v_fma_f32 v216, -v196, s70, v232
    v_fma_f32 v217, -v197, s70, v232
    v_fma_f32 v196, v196, s70, -v230
    v_fma_f32 v197, v197, s70, -v230
    v_fma_f32 v218, -v198, s70, v232
    v_fma_f32 v219, -v199, s70, v232
    v_fma_f32 v198, v198, s70, -v230
    v_fma_f32 v199, v199, s70, -v230
    v_exp_f32 v180, v180
    v_exp_f32 v200, v200
    v_exp_f32 v181, v181
    v_exp_f32 v201, v201
    v_exp_f32 v182, v182
    v_exp_f32 v202, v202
    v_exp_f32 v183, v183
    v_exp_f32 v203, v203
    v_exp_f32 v184, v184
    v_exp_f32 v204, v204
    v_exp_f32 v185, v185
    v_exp_f32 v205, v205
    v_exp_f32 v186, v186
    v_exp_f32 v206, v206
    v_exp_f32 v187, v187
    v_exp_f32 v207, v207
    v_exp_f32 v188, v188
    v_exp_f32 v208, v208
    v_exp_f32 v189, v189
    v_exp_f32 v209, v209
    v_exp_f32 v190, v190
    v_exp_f32 v210, v210
    v_exp_f32 v191, v191
    v_exp_f32 v211, v211
    v_exp_f32 v192, v192
    v_exp_f32 v212, v212
    v_exp_f32 v193, v193
    v_exp_f32 v213, v213
    v_exp_f32 v194, v194
    v_exp_f32 v214, v214
    v_exp_f32 v195, v195
    v_exp_f32 v215, v215
    v_exp_f32 v196, v196
    v_exp_f32 v216, v216
    v_exp_f32 v197, v197
    v_exp_f32 v217, v217
    v_exp_f32 v198, v198
    v_exp_f32 v218, v218
    v_exp_f32 v199, v199
    v_exp_f32 v219, v219
    v_add_f32 v230, v180, v182
    v_add_f32 v231, v181, v183
    v_add_f32 v232, v200, v202
    v_add_f32 v233, v201, v203
    v_add_f32 v234, v184, v186
    v_add_f32 v235, v185, v187
    v_add_f32 v236, v204, v206
    v_add_f32 v237, v205, v207
    v_add_f32 v230, v230, v188
    v_add_f32 v231, v231, v189
    v_add_f32 v232, v232, v208
    v_add_f32 v233, v233, v209
    v_add_f32 v234, v234, v190
    v_add_f32 v235, v235, v191
    v_add_f32 v236, v236, v210
    v_add_f32 v237, v237, v211
    v_add_f32 v230, v230, v192
    v_add_f32 v231, v231, v193
    v_add_f32 v232, v232, v212
    v_add_f32 v233, v233, v213
    v_add_f32 v234, v234, v194
    v_add_f32 v235, v235, v195
    v_add_f32 v236, v236, v214
    v_add_f32 v237, v237, v215
    v_add_f32 v230, v230, v196
    v_add_f32 v231, v231, v197
    v_add_f32 v232, v232, v216
    v_add_f32 v233, v233, v217
    v_add_f32 v234, v234, v198
    v_add_f32 v235, v235, v199
    v_add_f32 v236, v236, v218
    v_add_f32 v237, v237, v219
    v_add_f32 v230, v230, v234
    v_add_f32 v231, v231, v235
    v_add_f32 v232, v232, v236
    v_add_f32 v233, v233, v237
    v_add_f32 v230, v230, v231
    v_add_f32 v232, v232, v233
    v_rcp_f32 v230, v230
    v_rcp_f32 v232, v232
    s_nop 0
    v_mul_f32 v180, v180, v230
    v_mul_f32 v181, v181, v230
    v_mul_f32 v200, v200, v232
    v_mul_f32 v201, v201, v232
    v_mul_f32 v182, v182, v230
    v_mul_f32 v183, v183, v230
    v_mul_f32 v202, v202, v232
    v_mul_f32 v203, v203, v232
    v_mul_f32 v184, v184, v230
    v_mul_f32 v185, v185, v230
    v_mul_f32 v204, v204, v232
    v_mul_f32 v205, v205, v232
    v_mul_f32 v186, v186, v230
    v_mul_f32 v187, v187, v230
    v_mul_f32 v206, v206, v232
    v_mul_f32 v207, v207, v232
    v_mul_f32 v188, v188, v230
    v_mul_f32 v189, v189, v230
    v_mul_f32 v208, v208, v232
    v_mul_f32 v209, v209, v232
    v_mul_f32 v190, v190, v230
    v_mul_f32 v191, v191, v230
    v_mul_f32 v210, v210, v232
    v_mul_f32 v211, v211, v232
    v_mul_f32 v192, v192, v230
    v_mul_f32 v193, v193, v230
    v_mul_f32 v212, v212, v232
    v_mul_f32 v213, v213, v232
    v_mul_f32 v194, v194, v230
    v_mul_f32 v195, v195, v230
    v_mul_f32 v214, v214, v232
    v_mul_f32 v215, v215, v232
    v_mul_f32 v196, v196, v230
    v_mul_f32 v197, v197, v230
    v_mul_f32 v216, v216, v232
    v_mul_f32 v217, v217, v232
    v_mul_f32 v198, v198, v230
    v_mul_f32 v199, v199, v230
    v_mul_f32 v218, v218, v232
    v_mul_f32 v219, v219, v232
    v_cvt_pk_bf16_f32 v236, v180, v181
    v_cvt_pk_bf16_f32 v246, v200, v201
    v_cvt_pk_bf16_f32 v237, v182, v183
    v_cvt_pk_bf16_f32 v247, v202, v203
    v_cvt_pk_bf16_f32 v238, v184, v185
    v_cvt_pk_bf16_f32 v248, v204, v205
    v_cvt_pk_bf16_f32 v239, v186, v187
    v_cvt_pk_bf16_f32 v249, v206, v207
    v_cvt_pk_bf16_f32 v240, v188, v189
    v_cvt_pk_bf16_f32 v250, v208, v209
    v_cvt_pk_bf16_f32 v241, v190, v191
    v_cvt_pk_bf16_f32 v251, v210, v211
    v_cvt_pk_bf16_f32 v242, v192, v193
    v_cvt_pk_bf16_f32 v252, v212, v213
    v_cvt_pk_bf16_f32 v243, v194, v195
    v_cvt_pk_bf16_f32 v253, v214, v215
    v_cvt_pk_bf16_f32 v244, v196, v197
    v_cvt_pk_bf16_f32 v254, v216, v217
    v_cvt_pk_bf16_f32 v245, v198, v199
    v_cvt_pk_bf16_f32 v255, v218, v219
    ds_write_b128 v3, v[236:239] offset:0
    ds_write_b128 v3, v[240:243] offset:16
    ds_write_b128 v3, v[244:247] offset:32
    ds_write_b128 v3, v[248:251] offset:48
    ds_write_b128 v3, v[252:255] offset:64
    v_mov_b32 v28, 2
    ds_write_b32 v4, v28 offset:64
    s_cmp_eq_u32 s74, 0
    s_cbranch_scc1 KD_191
    s_sub_u32 s50, 3, s74
    s_mul_i32 s50, s50, 2304
    v_add_u32 v3, s50, v3
    v_mul_u32_u24 v2, 80, v1
    v_add_u32 v2, 154752, v2
    v_add_u32 v4, 12, v17
    s_cmp_eq_u32 s74, 1
    s_cbranch_scc0 KM_192
    s_waitcnt lgkmcnt(0)
    s_mov_b32 s49, 0
    s_cmp_ge_u32 s49, 10
    s_cbranch_scc1 WD_196
WF_195:
    s_sleep 1
    ds_read_b32 v28, v4 offset:16
    s_sub_u32 s46, s46, 1
    s_cselect_b32 s46, 0, s46
    s_cbranch_scc1 WD_196
    s_waitcnt lgkmcnt(0)
    v_readfirstlane_b32 s49, v28
    s_cmp_ge_u32 s49, 10
    s_cbranch_scc0 WF_195
WD_196:
    ds_read_b128 v[180:183], v2 offset:0
    ds_read_b128 v[184:187], v2 offset:16
    ds_read_b128 v[188:191], v2 offset:32
    ds_read_b128 v[192:195], v2 offset:48
    ds_read_b128 v[196:199], v2 offset:64
    s_waitcnt lgkmcnt(0)
    v_max3_f32 v230, v180, v181, v182
    v_max3_f32 v231, v183, v184, v185
    v_max3_f32 v230, v230, v186, v187
    v_max3_f32 v231, v231, v188, v189
    v_max3_f32 v230, v230, v190, v191
    v_max3_f32 v231, v231, v192, v193
    v_max3_f32 v230, v230, v194, v195
    v_max3_f32 v231, v231, v196, v197
    v_max3_f32 v230, v230, v198, v199
    v_max_f32 v230, v230, v231
    v_mul_f32 v230, s70, v230
    v_fma_f32 v180, v180, s70, -v230
    v_fma_f32 v181, v181, s70, -v230
    v_fma_f32 v182, v182, s70, -v230
    v_fma_f32 v183, v183, s70, -v230
    v_fma_f32 v184, v184, s70, -v230
    v_fma_f32 v185, v185, s70, -v230
    v_fma_f32 v186, v186, s70, -v230
    v_fma_f32 v187, v187, s70, -v230
    v_fma_f32 v188, v188, s70, -v230
    v_fma_f32 v189, v189, s70, -v230
    v_fma_f32 v190, v190, s70, -v230
    v_fma_f32 v191, v191, s70, -v230
    v_fma_f32 v192, v192, s70, -v230
    v_fma_f32 v193, v193, s70, -v230
    v_fma_f32 v194, v194, s70, -v230
    v_fma_f32 v195, v195, s70, -v230
    v_fma_f32 v196, v196, s70, -v230
    v_fma_f32 v197, v197, s70, -v230
    v_fma_f32 v198, v198, s70, -v230
    v_fma_f32 v199, v199, s70, -v230
    v_exp_f32 v180, v180
    v_exp_f32 v181, v181
    v_exp_f32 v182, v182
    v_exp_f32 v183, v183
    v_exp_f32 v184, v184
    v_exp_f32 v185, v185
    v_exp_f32 v186, v186
    v_exp_f32 v187, v187
    v_exp_f32 v188, v188
    v_exp_f32 v189, v189
    v_exp_f32 v190, v190
    v_exp_f32 v191, v191
    v_exp_f32 v192, v192
    v_exp_f32 v193, v193
    v_exp_f32 v194, v194
    v_exp_f32 v195, v195
    v_exp_f32 v196, v196
    v_exp_f32 v197, v197
    v_exp_f32 v198, v198
    v_exp_f32 v199, v199
    s_nop 0
    v_add_f32 v230, v180, v182
    v_add_f32 v231, v181, v183
    v_add_f32 v234, v184, v186
    v_add_f32 v235, v185, v187
    v_add_f32 v230, v230, v188
    v_add_f32 v231, v231, v189
    v_add_f32 v234, v234, v190
    v_add_f32 v235, v235, v191
    v_add_f32 v230, v230, v192
    v_add_f32 v231, v231, v193
    v_add_f32 v234, v234, v194
    v_add_f32 v235, v235, v195
    v_add_f32 v230, v230, v196
    v_add_f32 v231, v231, v197
    v_add_f32 v234, v234, v198
    v_add_f32 v235, v235, v199
    v_add_f32 v230, v230, v234
    v_add_f32 v231, v231, v235
    v_add_f32 v230, v230, v231
    v_rcp_f32 v230, v230
    s_nop 0
    v_mul_f32 v180, v180, v230
    v_mul_f32 v181, v181, v230
    v_mul_f32 v182, v182, v230
    v_mul_f32 v183, v183, v230
    v_mul_f32 v184, v184, v230
    v_mul_f32 v185, v185, v230
    v_mul_f32 v186, v186, v230
    v_mul_f32 v187, v187, v230
    v_mul_f32 v188, v188, v230
    v_mul_f32 v189, v189, v230
    v_mul_f32 v190, v190, v230
    v_mul_f32 v191, v191, v230
    v_mul_f32 v192, v192, v230
    v_mul_f32 v193, v193, v230
    v_mul_f32 v194, v194, v230
    v_mul_f32 v195, v195, v230
    v_mul_f32 v196, v196, v230
    v_mul_f32 v197, v197, v230
    v_mul_f32 v198, v198, v230
    v_mul_f32 v199, v199, v230
    v_cvt_pk_bf16_f32 v236, v180, v181
    v_cvt_pk_bf16_f32 v237, v182, v183
    v_cvt_pk_bf16_f32 v238, v184, v185
    v_cvt_pk_bf16_f32 v239, v186, v187
    v_cvt_pk_bf16_f32 v240, v188, v189
    v_cvt_pk_bf16_f32 v241, v190, v191
    v_cvt_pk_bf16_f32 v242, v192, v193
    v_cvt_pk_bf16_f32 v243, v194, v195
    v_cvt_pk_bf16_f32 v244, v196, v197
    v_cvt_pk_bf16_f32 v245, v198, v199
    ds_write_b128 v3, v[236:239]
    ds_write_b128 v3, v[240:243] offset:16
    ds_write_b64 v3, v[244:245] offset:32
    v_mov_b32 v28, 1
    s_mov_b64 exec, 1
    ds_add_u32 v17, v28 offset:76
    s_mov_b64 exec, -1
    s_branch KD_191
KM_192:
    s_waitcnt lgkmcnt(0)
    s_mov_b32 s49, 0
    s_cmp_ge_u32 s49, 10
    s_cbranch_scc1 WD_198
WF_197:
    s_sleep 1
    ds_read_b32 v28, v4 offset:16
    s_sub_u32 s46, s46, 1
    s_cselect_b32 s46, 0, s46
    s_cbranch_scc1 WD_198
    s_waitcnt lgkmcnt(0)
    v_readfirstlane_b32 s49, v28
    s_cmp_ge_u32 s49, 10
    s_cbranch_scc0 WF_197
WD_198:
    ds_read_b128 v[180:183], v2 offset:0
    ds_read_b128 v[184:187], v2 offset:16
    ds_read_b128 v[188:191], v2 offset:32
    ds_read_b128 v[192:195], v2 offset:48
    ds_read_b128 v[196:199], v2 offset:64
    s_waitcnt lgkmcnt(0)
    v_min3_f32 v232, v180, v181, v182
    v_min3_f32 v233, v183, v184, v185
    v_min3_f32 v232, v232, v186, v187
    v_min3_f32 v233, v233, v188, v189
    v_min3_f32 v232, v232, v190, v191
    v_min3_f32 v233, v233, v192, v193
    v_min3_f32 v232, v232, v194, v195
    v_min3_f32 v233, v233, v196, v197
    v_min3_f32 v232, v232, v198, v199
    v_min_f32 v232, v232, v233
    v_mul_f32 v232, s70, v232
    v_fma_f32 v200, -v180, s70, v232
    v_fma_f32 v201, -v181, s70, v232
    v_fma_f32 v202, -v182, s70, v232
    v_fma_f32 v203, -v183, s70, v232
    v_fma_f32 v204, -v184, s70, v232
    v_fma_f32 v205, -v185, s70, v232
    v_fma_f32 v206, -v186, s70, v232
    v_fma_f32 v207, -v187, s70, v232
    v_fma_f32 v208, -v188, s70, v232
    v_fma_f32 v209, -v189, s70, v232
    v_fma_f32 v210, -v190, s70, v232
    v_fma_f32 v211, -v191, s70, v232
    v_fma_f32 v212, -v192, s70, v232
    v_fma_f32 v213, -v193, s70, v232
    v_fma_f32 v214, -v194, s70, v232
    v_fma_f32 v215, -v195, s70, v232
    v_fma_f32 v216, -v196, s70, v232
    v_fma_f32 v217, -v197, s70, v232
    v_fma_f32 v218, -v198, s70, v232
    v_fma_f32 v219, -v199, s70, v232
    v_exp_f32 v200, v200
    v_exp_f32 v201, v201
    v_exp_f32 v202, v202
    v_exp_f32 v203, v203
    v_exp_f32 v204, v204
    v_exp_f32 v205, v205
    v_exp_f32 v206, v206
    v_exp_f32 v207, v207
    v_exp_f32 v208, v208
    v_exp_f32 v209, v209
    v_exp_f32 v210, v210
    v_exp_f32 v211, v211
    v_exp_f32 v212, v212
    v_exp_f32 v213, v213
    v_exp_f32 v214, v214
    v_exp_f32 v215, v215
    v_exp_f32 v216, v216
    v_exp_f32 v217, v217
    v_exp_f32 v218, v218
    v_exp_f32 v219, v219
    s_nop 0
    v_add_f32 v232, v200, v202
    v_add_f32 v233, v201, v203
    v_add_f32 v236, v204, v206
    v_add_f32 v237, v205, v207
    v_add_f32 v232, v232, v208
    v_add_f32 v233, v233, v209
    v_add_f32 v236, v236, v210
    v_add_f32 v237, v237, v211
    v_add_f32 v232, v232, v212
    v_add_f32 v233, v233, v213
    v_add_f32 v236, v236, v214
    v_add_f32 v237, v237, v215
    v_add_f32 v232, v232, v216
    v_add_f32 v233, v233, v217
    v_add_f32 v236, v236, v218
    v_add_f32 v237, v237, v219
    v_add_f32 v232, v232, v236
    v_add_f32 v233, v233, v237
    v_add_f32 v232, v232, v233
    v_rcp_f32 v232, v232
    s_nop 0
    v_mul_f32 v200, v200, v232
    v_mul_f32 v201, v201, v232
    v_mul_f32 v202, v202, v232
    v_mul_f32 v203, v203, v232
    v_mul_f32 v204, v204, v232
    v_mul_f32 v205, v205, v232
    v_mul_f32 v206, v206, v232
    v_mul_f32 v207, v207, v232
    v_mul_f32 v208, v208, v232
    v_mul_f32 v209, v209, v232
    v_mul_f32 v210, v210, v232
    v_mul_f32 v211, v211, v232
    v_mul_f32 v212, v212, v232
    v_mul_f32 v213, v213, v232
    v_mul_f32 v214, v214, v232
    v_mul_f32 v215, v215, v232
    v_mul_f32 v216, v216, v232
    v_mul_f32 v217, v217, v232
    v_mul_f32 v218, v218, v232
    v_mul_f32 v219, v219, v232
    v_cvt_pk_bf16_f32 v246, v200, v201
    v_cvt_pk_bf16_f32 v247, v202, v203
    v_cvt_pk_bf16_f32 v248, v204, v205
    v_cvt_pk_bf16_f32 v249, v206, v207
    v_cvt_pk_bf16_f32 v250, v208, v209
    v_cvt_pk_bf16_f32 v251, v210, v211
    v_cvt_pk_bf16_f32 v252, v212, v213
    v_cvt_pk_bf16_f32 v253, v214, v215
    v_cvt_pk_bf16_f32 v254, v216, v217
    v_cvt_pk_bf16_f32 v255, v218, v219
    ds_write_b64 v3, v[246:247] offset:40
    ds_write_b128 v3, v[248:251] offset:48
    ds_write_b128 v3, v[252:255] offset:64
    v_mov_b32 v28, 1
    s_mov_b64 exec, 1
    ds_add_u32 v17, v28 offset:76
    s_mov_b64 exec, -1
KD_191:
    s_waitcnt lgkmcnt(0)
    s_mov_b32 s49, 0
    s_setprio 3
GT_200:
    ds_read_b64 v[28:29], v17 offset:8
    s_waitcnt lgkmcnt(0)
    v_readfirstlane_b32 s34, v28
    v_readfirstlane_b32 s32, v29
    s_sub_u32 s46, s46, 1
    s_cselect_b32 s46, 0, s46
    s_cbranch_scc1 GD_201
    s_cmp_eq_u32 s32, 0
    s_cbranch_scc1 GT_200
GD_201:
    s_and_b32 s32, s34, 1
    s_mul_i32 s32, s32, 0x10001
    s_mov_b32 s33, 0xfffefffe
    v_mov_b32 v18, s32
    s_cmp_eq_u32 s73, 1
    s_cbranch_scc0 H1D_199
    v_and_b32 v29, 1, v21
    v_lshlrev_b32 v29, 4, v29
    v_mov_b32 v30, 0x3f80
    v_lshlrev_b32 v29, v29, v30
    v_bfe_u32 v28, v21, 1, 2
    v_lshlrev_b32 v4, 4, v1
    v_cmp_eq_u32 vcc, 0, v28
    v_mov_b32 v160, 0
    s_nop 0
    v_cndmask_b32 v160, v160, v29, vcc
    v_cmp_eq_u32 vcc, 1, v28
    v_mov_b32 v161, 0
    s_nop 0
    v_cndmask_b32 v161, v161, v29, vcc
    v_cmp_eq_u32 vcc, 2, v28
    v_mov_b32 v162, 0
    s_nop 0
    v_cndmask_b32 v162, v162, v29, vcc
    v_cmp_eq_u32 vcc, 3, v28
    v_mov_b32 v163, 0
    s_nop 0
    v_cndmask_b32 v163, v163, v29, vcc
    s_add_u32 s51, s76, 4096
    s_add_u32 s4, s36, s56
    s_addc_u32 s5, s37, 0
    s_and_b32 s35, s34, 0xff
    s_mul_i32 s35, s35, 0x01010101
    s_add_u32 s16, s75, 0x20000
    v_and_b32 v170, 3, v1
    v_lshlrev_b32 v170, 9, v170
    v_lshrrev_b32 v171, 2, v1
    v_add3_u32 v170, v170, v171, s57
    v_mov_b32 v171, s34
    s_cmp_ge_u32 s48, 21
    s_cbranch_scc1 WD_203
WF_202:
    s_sleep 2
    ds_read_b128 v[28:31], v17 offset:16
    s_waitcnt lgkmcnt(0)
    v_min3_u32 v28, v28, v29, v30
    v_min_u32 v28, v28, v31
    s_sub_u32 s46, s46, 1
    s_cselect_b32 s46, 0, s46
    s_cbranch_scc1 WD_203
    v_readfirstlane_b32 s48, v28
    s_cmp_ge_u32 s48, 21
    s_cbranch_scc0 WF_202
WD_203:
HW_204:
    s_load_dwordx2 s[58:59], s[4:5], 0 glc
    s_load_dwordx2 s[60:61], s[4:5], 128 glc
    s_load_dwordx2 s[62:63], s[4:5], 256 glc
    s_load_dwordx2 s[64:65], s[4:5], 384 glc
    s_waitcnt lgkmcnt(0)
    s_sub_u32 s46, s46, 8
    s_cselect_b32 s46, 0, s46
    s_cbranch_scc1 HD_205
    s_xor_b32 s58, s58, s35
    s_xor_b32 s59, s59, s35
    s_xor_b32 s60, s60, s35
    s_xor_b32 s61, s61, s35
    s_xor_b32 s62, s62, s35
    s_xor_b32 s63, s63, s35
    s_xor_b32 s64, s64, s35
    s_xor_b32 s65, s65, s35
    s_or_b32 s58, s58, s59
    s_or_b32 s58, s58, s60
    s_or_b32 s58, s58, s61
    s_or_b32 s58, s58, s62
    s_or_b32 s58, s58, s63
    s_or_b32 s58, s58, s64
    s_or_b32 s58, s58, s65
    s_cbranch_scc1 HW_204
HD_205:
P1_206:
    buffer_load_dwordx4 v[128:131], v4, s[36:39], s76 offen offset:0 sc1
    buffer_load_dwordx4 v[132:135], v4, s[36:39], s76 offen offset:1024 sc1
    buffer_load_dwordx4 v[136:139], v4, s[36:39], s76 offen offset:2048 sc1
    buffer_load_dwordx4 v[140:143], v4, s[36:39], s76 offen offset:3072 sc1
    buffer_load_dwordx4 v[144:147], v4, s[36:39], s51 offen offset:0 sc1
    buffer_load_dwordx4 v[148:151], v4, s[36:39], s51 offen offset:1024 sc1
    buffer_load_dwordx4 v[152:155], v4, s[36:39], s51 offen offset:2048 sc1
    buffer_load_dwordx4 v[156:159], v4, s[36:39], s51 offen offset:3072 sc1
    v_mov_b32 v28, 0
    s_waitcnt vmcnt(7)
    v_xor_b32 v128, s32, v128
    v_xor_b32 v129, s32, v129
    v_xor_b32 v130, s32, v130
    v_xor_b32 v131, s32, v131
    v_or3_b32 v28, v28, v128, v129
    v_or3_b32 v28, v28, v130, v131
    v_mfma_f32_16x16x32_bf16 v[164:167], v[160:163], v[128:131], 0
    s_waitcnt vmcnt(6)
    v_xor_b32 v132, s32, v132
    v_xor_b32 v133, s32, v133
    v_xor_b32 v134, s32, v134
    v_xor_b32 v135, s32, v135
    v_or3_b32 v28, v28, v132, v133
    v_or3_b32 v28, v28, v134, v135
    v_mfma_f32_16x16x32_bf16 v[164:167], v[160:163], v[132:135], v[164:167]
    s_waitcnt vmcnt(5)
    v_xor_b32 v136, s32, v136
    v_xor_b32 v137, s32, v137
    v_xor_b32 v138, s32, v138
    v_xor_b32 v139, s32, v139
    v_or3_b32 v28, v28, v136, v137
    v_or3_b32 v28, v28, v138, v139
    v_mfma_f32_16x16x32_bf16 v[164:167], v[160:163], v[136:139], v[164:167]
    s_waitcnt vmcnt(4)
    v_xor_b32 v140, s32, v140
    v_xor_b32 v141, s32, v141
    v_xor_b32 v142, s32, v142
    v_xor_b32 v143, s32, v143
    v_or3_b32 v28, v28, v140, v141
    v_or3_b32 v28, v28, v142, v143
    v_mfma_f32_16x16x32_bf16 v[164:167], v[160:163], v[140:143], v[164:167]
    s_waitcnt vmcnt(3)
    v_xor_b32 v144, s32, v144
    v_xor_b32 v145, s32, v145
    v_xor_b32 v146, s32, v146
    v_xor_b32 v147, s32, v147
    v_or3_b32 v28, v28, v144, v145
    v_or3_b32 v28, v28, v146, v147
    v_mfma_f32_16x16x32_bf16 v[164:167], v[160:163], v[144:147], v[164:167]
    s_waitcnt vmcnt(2)
    v_xor_b32 v148, s32, v148
    v_xor_b32 v149, s32, v149
    v_xor_b32 v150, s32, v150
    v_xor_b32 v151, s32, v151
    v_or3_b32 v28, v28, v148, v149
    v_or3_b32 v28, v28, v150, v151
    v_mfma_f32_16x16x32_bf16 v[164:167], v[160:163], v[148:151], v[164:167]
    s_waitcnt vmcnt(1)
    v_xor_b32 v152, s32, v152
    v_xor_b32 v153, s32, v153
    v_xor_b32 v154, s32, v154
    v_xor_b32 v155, s32, v155
    v_or3_b32 v28, v28, v152, v153
    v_or3_b32 v28, v28, v154, v155
    v_mfma_f32_16x16x32_bf16 v[164:167], v[160:163], v[152:155], v[164:167]
    s_waitcnt vmcnt(0)
    v_xor_b32 v156, s32, v156
    v_xor_b32 v157, s32, v157
    v_xor_b32 v158, s32, v158
    v_xor_b32 v159, s32, v159
    v_or3_b32 v28, v28, v156, v157
    v_or3_b32 v28, v28, v158, v159
    v_mfma_f32_16x16x32_bf16 v[164:167], v[160:163], v[156:159], v[164:167]
    v_and_b32 v28, 0x10001, v28
    v_cmp_ne_u32 vcc, 0, v28
    s_sub_u32 s46, s46, 64
    s_cselect_b32 s46, 0, s46
    s_cbranch_scc1 D1_207
    s_cbranch_vccz D1_207
    s_sleep 1
    s_branch P1_206
D1_207:
    s_nop 2
    v_cvt_pk_bf16_f32 v164, v164, v165
    v_cvt_pk_bf16_f32 v165, v166, v167
    v_and_or_b32 v164, v164, s33, v18
    v_and_or_b32 v165, v165, s33, v18
    buffer_store_dwordx2 v[164:165], v5, s[36:39], s75 offen sc1
    buffer_store_dwordx2 v[164:165], v5, s[36:39], s16 offen sc1
    s_mov_b32 exec_lo, s77
    s_mov_b32 exec_hi, 0
    buffer_store_byte v171, v170, s[36:39], 0 offen sc1
    s_mov_b64 exec, -1
H1D_199:
    v_mov_b32 v28, 1
    ds_write_b32 v19, v28
L_b2:
    v_mov_b32 v240, 0
    v_mov_b32 v241, 0
    v_mov_b32 v242, 0
    v_mov_b32 v243, 0
    v_mov_b32 v244, 0
    s_cmp_eq_u32 s40, 6
    s_cbranch_scc0 LS_208
    s_mov_b32 s49, 0
    s_cmp_ge_u32 s49, 1
    s_cbranch_scc1 WD_210
WF_209:
    s_sleep 1
    ds_read_b32 v28, v17 offset:32
    s_sub_u32 s46, s46, 1
    s_cselect_b32 s46, 0, s46
    s_cbranch_scc1 WD_210
    s_waitcnt lgkmcnt(0)
    v_readfirstlane_b32 s49, v28
    s_cmp_ge_u32 s49, 1
    s_cbranch_scc0 WF_209
WD_210:
    s_mov_b32 s49, 0
    s_cmp_ge_u32 s49, 1
    s_cbranch_scc1 WD_212
WF_211:
    s_sleep 1
    ds_read_b32 v28, v17 offset:36
    s_sub_u32 s46, s46, 1
    s_cselect_b32 s46, 0, s46
    s_cbranch_scc1 WD_212
    s_waitcnt lgkmcnt(0)
    v_readfirstlane_b32 s49, v28
    s_cmp_ge_u32 s49, 1
    s_cbranch_scc0 WF_211
WD_212:
    s_lshr_b32 s58, s43, 1
    s_and_b32 s50, s58, 7
    s_mul_i32 s50, s50, 40
    s_sub_u32 s51, 281, s50
    s_cmp_ge_u32 s58, 8
    s_cselect_b32 s51, s51, s50
    s_cselect_b32 s59, 1, 0
    s_add_u32 s59, s59, 79
    v_add_u32 v28, 0, v1
    v_mul_u32_u24 v29, 1639, v28
    v_lshrrev_b32 v29, 16, v29
    v_mul_u32_u24 v30, 40, v29
    v_sub_u32 v30, v28, v30
    v_mul_u32_u24 v29, 5248, v29
    v_add_u32 v30, s51, v30
    v_subrev_u32 v31, 81, v30
    v_cmp_gt_u32 vcc, s59, v31
    v_subrev_u32 v28, 241, v30
    s_nop 0
    v_subbrev_co_u32 v31, vcc, 0, v30, vcc
    v_cmp_gt_u32 vcc, 80, v28
    s_nop 1
    v_subbrev_co_u32 v31, vcc, 0, v31, vcc
    v_cmp_eq_u32 vcc, 80, v30
    v_mov_b32 v28, 320
    s_nop 0
    v_cndmask_b32 v31, v31, v28, vcc
    v_cmp_eq_u32 vcc, 240, v30
    v_mov_b32 v28, 324
    s_nop 0
    v_cndmask_b32 v31, v31, v28, vcc
    v_lshl_add_u32 v128, v31, 4, v29
    v_add_u32 v28, 64, v1
    v_mul_u32_u24 v29, 1639, v28
    v_lshrrev_b32 v29, 16, v29
    v_mul_u32_u24 v30, 40, v29
    v_sub_u32 v30, v28, v30
    v_mul_u32_u24 v29, 5248, v29
    v_add_u32 v30, s51, v30
    v_subrev_u32 v31, 81, v30
    v_cmp_gt_u32 vcc, s59, v31
    v_subrev_u32 v28, 241, v30
    s_nop 0
    v_subbrev_co_u32 v31, vcc, 0, v30, vcc
    v_cmp_gt_u32 vcc, 80, v28
    s_nop 1
    v_subbrev_co_u32 v31, vcc, 0, v31, vcc
    v_cmp_eq_u32 vcc, 80, v30
    v_mov_b32 v28, 320
    s_nop 0
    v_cndmask_b32 v31, v31, v28, vcc
    v_cmp_eq_u32 vcc, 240, v30
    v_mov_b32 v28, 324
    s_nop 0
    v_cndmask_b32 v31, v31, v28, vcc
    v_lshl_add_u32 v129, v31, 4, v29
    v_add_u32 v28, 128, v1
    v_mul_u32_u24 v29, 1639, v28
    v_lshrrev_b32 v29, 16, v29
    v_mul_u32_u24 v30, 40, v29
    v_sub_u32 v30, v28, v30
    v_mul_u32_u24 v29, 5248, v29
    v_add_u32 v30, s51, v30
    v_subrev_u32 v31, 81, v30
    v_cmp_gt_u32 vcc, s59, v31
    v_subrev_u32 v28, 241, v30
    s_nop 0
    v_subbrev_co_u32 v31, vcc, 0, v30, vcc
    v_cmp_gt_u32 vcc, 80, v28
    s_nop 1
    v_subbrev_co_u32 v31, vcc, 0, v31, vcc
    v_cmp_eq_u32 vcc, 80, v30
    v_mov_b32 v28, 320
    s_nop 0
    v_cndmask_b32 v31, v31, v28, vcc
    v_cmp_eq_u32 vcc, 240, v30
    v_mov_b32 v28, 324
    s_nop 0
    v_cndmask_b32 v31, v31, v28, vcc
    v_lshl_add_u32 v130, v31, 4, v29
    v_add_u32 v28, 192, v1
    v_mul_u32_u24 v29, 1639, v28
    v_lshrrev_b32 v29, 16, v29
    v_mul_u32_u24 v30, 40, v29
    v_sub_u32 v30, v28, v30
    v_mul_u32_u24 v29, 5248, v29
    v_add_u32 v30, s51, v30
    v_subrev_u32 v31, 81, v30
    v_cmp_gt_u32 vcc, s59, v31
    v_subrev_u32 v28, 241, v30
    s_nop 0
    v_subbrev_co_u32 v31, vcc, 0, v30, vcc
    v_cmp_gt_u32 vcc, 80, v28
    s_nop 1
    v_subbrev_co_u32 v31, vcc, 0, v31, vcc
    v_cmp_eq_u32 vcc, 80, v30
    v_mov_b32 v28, 320
    s_nop 0
    v_cndmask_b32 v31, v31, v28, vcc
    v_cmp_eq_u32 vcc, 240, v30
    v_mov_b32 v28, 324
    s_nop 0
    v_cndmask_b32 v31, v31, v28, vcc
    v_lshl_add_u32 v131, v31, 4, v29
    v_add_u32 v28, 256, v1
    v_mul_u32_u24 v29, 1639, v28
    v_lshrrev_b32 v29, 16, v29
    v_mul_u32_u24 v30, 40, v29
    v_sub_u32 v30, v28, v30
    v_mul_u32_u24 v29, 5248, v29
    v_add_u32 v30, s51, v30
    v_subrev_u32 v31, 81, v30
    v_cmp_gt_u32 vcc, s59, v31
    v_subrev_u32 v28, 241, v30
    s_nop 0
    v_subbrev_co_u32 v31, vcc, 0, v30, vcc
    v_cmp_gt_u32 vcc, 80, v28
    s_nop 1
    v_subbrev_co_u32 v31, vcc, 0, v31, vcc
    v_cmp_eq_u32 vcc, 80, v30
    v_mov_b32 v28, 320
    s_nop 0
    v_cndmask_b32 v31, v31, v28, vcc
    v_cmp_eq_u32 vcc, 240, v30
    v_mov_b32 v28, 324
    s_nop 0
    v_cndmask_b32 v31, v31, v28, vcc
    v_lshl_add_u32 v132, v31, 4, v29
    v_lshl_add_u32 v28, v1, 4, v17
    v_lshl_add_u32 v29, v1, 2, v17
    ds_write_b128 v28, v[128:131] offset:256
    ds_write_b32 v29, v132 offset:1280
    v_mov_b32 v28, 1
    ds_write_b32 v17, v28 offset:80
    s_waitcnt lgkmcnt(0)
    v_mov_b32 v240, v128
    v_mov_b32 v241, v129
    v_mov_b32 v242, v130
    v_mov_b32 v243, v131
    v_mov_b32 v244, v132
LS_208:
    s_setprio 2
    s_lshr_b32 s73, s43, 1
    s_and_b32 s50, s73, 7
    s_mul_i32 s50, s50, 40
    s_cmp_ge_u32 s73, 8
    s_cselect_b32 s52, 320, 0
    s_cselect_b64 s[68:69], -1, 0
    s_add_u32 s52, s52, 640
    s_add_u32 s52, s52, s50
    s_lshl_b32 s76, s52, 1
    v_mul_u32_u24 v29, 2560, v20
    v_add_u32 v29, 108544, v29
    v_add_u32 v28, 0, v21
    v_min_u32 v28, 39, v28
    v_sub_u32 v30, 39, v28
    v_cndmask_b32 v28, v28, v30, s[68:69]
    v_lshl_add_u32 v6, v28, 4, v29
    v_add_u32 v28, 16, v21
    v_min_u32 v28, 39, v28
    v_sub_u32 v30, 39, v28
    v_cndmask_b32 v28, v28, v30, s[68:69]
    v_lshl_add_u32 v7, v28, 4, v29
    v_add_u32 v28, 32, v21
    v_min_u32 v28, 39, v28
    v_sub_u32 v30, 39, v28
    v_cndmask_b32 v28, v28, v30, s[68:69]
    v_lshl_add_u32 v8, v28, 4, v29
    v_and_b32 v31, 1, v20
    v_lshlrev_b32 v31, 5, v31
    v_lshrrev_b32 v29, 1, v20
    v_lshl_add_u32 v31, v29, 4, v31
    v_lshl_add_u32 v29, v21, 5, s8
    v_sub_u32 v30, 2048, v29
    v_and_b32 v30, 2047, v30
    v_cndmask_b32 v29, v29, v30, s[68:69]
    v_mul_u32_u24 v29, 2560, v29
    v_add_u32 v9, v29, v31
    v_lshl_add_u32 v12, v20, 3, v29
    v_lshl_add_u32 v29, v21, 5, s9
    v_sub_u32 v30, 2048, v29
    v_and_b32 v30, 2047, v30
    v_cndmask_b32 v29, v29, v30, s[68:69]
    v_mul_u32_u24 v29, 2560, v29
    v_add_u32 v10, v29, v31
    v_lshl_add_u32 v13, v20, 3, v29
    v_lshl_add_u32 v29, v21, 5, s10
    v_sub_u32 v30, 2048, v29
    v_and_b32 v30, 2047, v30
    v_cndmask_b32 v29, v29, v30, s[68:69]
    v_mul_u32_u24 v29, 2560, v29
    v_add_u32 v11, v29, v31
    v_lshl_add_u32 v14, v20, 3, v29
    s_mov_b32 s49, 0
    s_mov_b32 s77, 1
    s_and_b32 s50, s73, 7
    s_mul_i32 s50, s50, 40
    s_sub_u32 s51, 320, s50
    s_cmp_ge_u32 s73, 8
    s_cselect_b32 s50, s51, s50
    s_sub_u32 s51, s50, 81
    s_cmp_lt_u32 s51, 80
    s_cselect_b32 s52, 1, 0
    s_sub_u32 s51, s50, 241
    s_cmp_lt_u32 s51, 80
    s_cselect_b32 s52, 1, s52
    s_sub_u32 s52, s50, s52
    s_cmp_eq_u32 s50, 80
    s_cselect_b32 s52, 320, s52
    s_cmp_eq_u32 s50, 240
    s_cselect_b32 s52, 324, s52
    v_add_u32 v28, s52, v1
    v_and_b32 v28, 3, v28
    s_and_b32 s52, s52, 0xfffc
    v_add_u32 v28, s52, v28
    v_lshlrev_b32 v28, 4, v28
    v_lshrrev_b32 v29, 2, v1
    v_mul_u32_u24 v30, 5248, v29
    v_add_u32 v5, v28, v30
    v_mul_u32_u24 v29, 640, v29
    s_cmp_ge_u32 s73, 8
    s_cselect_b32 s50, 624, 0
    s_add_u32 s50, s50, 108544
    v_add_u32 v4, s50, v29
    s_mul_i32 s11, s45, 335872
    s_add_u32 s11, s11, 6291456
    s_mov_b32 s14, 0x11111111
    s_mov_b32 s15, 0x11111111
    s_cmp_eq_u32 s74, 0
    s_cbranch_scc0 B2V_213
B2R_214:
    s_bitcmp1_b32 s73, 1
    s_cbranch_scc0 LN_218
    s_mov_b32 s16, 0
    s_cmp_ge_u32 s16, 1
    s_cbranch_scc1 WD_220
WF_219:
    s_sleep 1
    ds_read_b32 v28, v17 offset:92
    s_sub_u32 s46, s46, 1
    s_cselect_b32 s46, 0, s46
    s_cbranch_scc1 WD_220
    s_waitcnt lgkmcnt(0)
    v_readfirstlane_b32 s16, v28
    s_cmp_ge_u32 s16, 1
    s_cbranch_scc0 WF_219
WD_220:
    s_add_u32 s50, s11, 0
    buffer_load_dwordx4 v[80:83], v5, s[36:39], s50 offen sc1
    s_add_u32 s50, s11, 83968
    buffer_load_dwordx4 v[84:87], v5, s[36:39], s50 offen sc1
    s_add_u32 s50, s11, 167936
    buffer_load_dwordx4 v[88:91], v5, s[36:39], s50 offen sc1
    s_add_u32 s50, s11, 251904
    buffer_load_dwordx4 v[92:95], v5, s[36:39], s50 offen sc1
LN_218:
    v_mov_b32 v15, 0
    v_mov_b32 v16, 0
    s_lshl_b32 s53, s77, 2
    s_sub_u32 s53, s53, 4
    s_add_u32 s53, s53, 1
    s_cmp_ge_u32 s49, s53
    s_cbranch_scc1 WD_222
WF_221:
    s_sleep 1
    ds_read_b32 v28, v17 offset:88
    s_sub_u32 s46, s46, 1
    s_cselect_b32 s46, 0, s46
    s_cbranch_scc1 WD_222
    s_waitcnt lgkmcnt(0)
    v_readfirstlane_b32 s49, v28
    s_cmp_ge_u32 s49, s53
    s_cbranch_scc0 WF_221
WD_222:
    s_bitcmp1_b32 s73, 1
    s_cbranch_scc0 LM_223
    s_waitcnt vmcnt(3)
    s_mov_b64 exec, s[14:15]
    ds_write_b128 v4, v[80:83] offset:0
    s_mov_b64 exec, -1
    v_xor_b32 v28, s32, v80
    v_xor_b32 v29, s32, v81
    v_or3_b32 v15, v15, v28, v29
    v_xor_b32 v28, s32, v82
    v_xor_b32 v29, s32, v83
    v_or3_b32 v15, v15, v28, v29
LM_223:
    ds_read_b128 v[176:179], v6 offset:0
    ds_read_b128 v[180:183], v6 offset:640
    ds_read_b128 v[184:187], v6 offset:1280
    ds_read_b128 v[188:191], v6 offset:1920
    s_waitcnt lgkmcnt(0)
    v_xor_b32 v128, s32, v176
    v_xor_b32 v129, s32, v180
    v_xor_b32 v130, s32, v184
    v_xor_b32 v131, s32, v188
    ds_write_b128 v6, v[128:131] offset:0
    v_or3_b32 v15, v15, v128, v129
    v_or3_b32 v16, v16, v130, v131
    v_xor_b32 v132, s32, v177
    v_xor_b32 v133, s32, v181
    v_xor_b32 v134, s32, v185
    v_xor_b32 v135, s32, v189
    ds_write_b128 v6, v[132:135] offset:640
    v_or3_b32 v15, v15, v132, v133
    v_or3_b32 v16, v16, v134, v135
    v_xor_b32 v136, s32, v178
    v_xor_b32 v137, s32, v182
    v_xor_b32 v138, s32, v186
    v_xor_b32 v139, s32, v190
    ds_write_b128 v6, v[136:139] offset:1280
    v_or3_b32 v15, v15, v136, v137
    v_or3_b32 v16, v16, v138, v139
    v_xor_b32 v140, s32, v179
    v_xor_b32 v141, s32, v183
    v_xor_b32 v142, s32, v187
    v_xor_b32 v143, s32, v191
    ds_write_b128 v6, v[140:143] offset:1920
    v_or3_b32 v15, v15, v140, v141
    v_or3_b32 v16, v16, v142, v143
    s_add_u32 s53, s53, 1
    s_cmp_ge_u32 s49, s53
    s_cbranch_scc1 WD_225
WF_224:
    s_sleep 1
    ds_read_b32 v28, v17 offset:88
    s_sub_u32 s46, s46, 1
    s_cselect_b32 s46, 0, s46
    s_cbranch_scc1 WD_225
    s_waitcnt lgkmcnt(0)
    v_readfirstlane_b32 s49, v28
    s_cmp_ge_u32 s49, s53
    s_cbranch_scc0 WF_224
WD_225:
    s_bitcmp1_b32 s73, 1
    s_cbranch_scc0 LM_226
    s_waitcnt vmcnt(2)
    s_mov_b64 exec, s[14:15]
    ds_write_b128 v4, v[84:87] offset:10240
    s_mov_b64 exec, -1
    v_xor_b32 v28, s32, v84
    v_xor_b32 v29, s32, v85
    v_or3_b32 v15, v15, v28, v29
    v_xor_b32 v28, s32, v86
    v_xor_b32 v29, s32, v87
    v_or3_b32 v15, v15, v28, v29
LM_226:
    ds_read_b128 v[192:195], v6 offset:10240
    ds_read_b128 v[196:199], v6 offset:10880
    ds_read_b128 v[200:203], v6 offset:11520
    ds_read_b128 v[204:207], v6 offset:12160
    s_waitcnt lgkmcnt(0)
    v_xor_b32 v144, s32, v192
    v_xor_b32 v145, s32, v196
    v_xor_b32 v146, s32, v200
    v_xor_b32 v147, s32, v204
    ds_write_b128 v6, v[144:147] offset:10240
    v_or3_b32 v15, v15, v144, v145
    v_or3_b32 v16, v16, v146, v147
    v_xor_b32 v148, s32, v193
    v_xor_b32 v149, s32, v197
    v_xor_b32 v150, s32, v201
    v_xor_b32 v151, s32, v205
    ds_write_b128 v6, v[148:151] offset:10880
    v_or3_b32 v15, v15, v148, v149
    v_or3_b32 v16, v16, v150, v151
    v_xor_b32 v152, s32, v194
    v_xor_b32 v153, s32, v198
    v_xor_b32 v154, s32, v202
    v_xor_b32 v155, s32, v206
    ds_write_b128 v6, v[152:155] offset:11520
    v_or3_b32 v15, v15, v152, v153
    v_or3_b32 v16, v16, v154, v155
    v_xor_b32 v156, s32, v195
    v_xor_b32 v157, s32, v199
    v_xor_b32 v158, s32, v203
    v_xor_b32 v159, s32, v207
    ds_write_b128 v6, v[156:159] offset:12160
    v_or3_b32 v15, v15, v156, v157
    v_or3_b32 v16, v16, v158, v159
    s_add_u32 s53, s53, 1
    s_cmp_ge_u32 s49, s53
    s_cbranch_scc1 WD_228
WF_227:
    s_sleep 1
    ds_read_b32 v28, v17 offset:88
    s_sub_u32 s46, s46, 1
    s_cselect_b32 s46, 0, s46
    s_cbranch_scc1 WD_228
    s_waitcnt lgkmcnt(0)
    v_readfirstlane_b32 s49, v28
    s_cmp_ge_u32 s49, s53
    s_cbranch_scc0 WF_227
WD_228:
    s_bitcmp1_b32 s73, 1
    s_cbranch_scc0 LM_229
    s_waitcnt vmcnt(1)
    s_mov_b64 exec, s[14:15]
    ds_write_b128 v4, v[88:91] offset:20480
    s_mov_b64 exec, -1
    v_xor_b32 v28, s32, v88
    v_xor_b32 v29, s32, v89
    v_or3_b32 v15, v15, v28, v29
    v_xor_b32 v28, s32, v90
    v_xor_b32 v29, s32, v91
    v_or3_b32 v15, v15, v28, v29
LM_229:
    ds_read_b128 v[208:211], v6 offset:20480
    ds_read_b128 v[212:215], v6 offset:21120
    ds_read_b128 v[216:219], v6 offset:21760
    ds_read_b128 v[220:223], v6 offset:22400
    s_waitcnt lgkmcnt(0)
    v_xor_b32 v128, s32, v208
    v_xor_b32 v129, s32, v212
    v_xor_b32 v130, s32, v216
    v_xor_b32 v131, s32, v220
    ds_write_b128 v6, v[128:131] offset:20480
    v_or3_b32 v15, v15, v128, v129
    v_or3_b32 v16, v16, v130, v131
    v_xor_b32 v132, s32, v209
    v_xor_b32 v133, s32, v213
    v_xor_b32 v134, s32, v217
    v_xor_b32 v135, s32, v221
    ds_write_b128 v6, v[132:135] offset:21120
    v_or3_b32 v15, v15, v132, v133
    v_or3_b32 v16, v16, v134, v135
    v_xor_b32 v136, s32, v210
    v_xor_b32 v137, s32, v214
    v_xor_b32 v138, s32, v218
    v_xor_b32 v139, s32, v222
    ds_write_b128 v6, v[136:139] offset:21760
    v_or3_b32 v15, v15, v136, v137
    v_or3_b32 v16, v16, v138, v139
    v_xor_b32 v140, s32, v211
    v_xor_b32 v141, s32, v215
    v_xor_b32 v142, s32, v219
    v_xor_b32 v143, s32, v223
    ds_write_b128 v6, v[140:143] offset:22400
    v_or3_b32 v15, v15, v140, v141
    v_or3_b32 v16, v16, v142, v143
    s_add_u32 s53, s53, 1
    s_cmp_ge_u32 s49, s53
    s_cbranch_scc1 WD_231
WF_230:
    s_sleep 1
    ds_read_b32 v28, v17 offset:88
    s_sub_u32 s46, s46, 1
    s_cselect_b32 s46, 0, s46
    s_cbranch_scc1 WD_231
    s_waitcnt lgkmcnt(0)
    v_readfirstlane_b32 s49, v28
    s_cmp_ge_u32 s49, s53
    s_cbranch_scc0 WF_230
WD_231:
    s_bitcmp1_b32 s73, 1
    s_cbranch_scc0 LM_232
    s_waitcnt vmcnt(0)
    s_mov_b64 exec, s[14:15]
    ds_write_b128 v4, v[92:95] offset:30720
    s_mov_b64 exec, -1
    v_xor_b32 v28, s32, v92
    v_xor_b32 v29, s32, v93
    v_or3_b32 v15, v15, v28, v29
    v_xor_b32 v28, s32, v94
    v_xor_b32 v29, s32, v95
    v_or3_b32 v15, v15, v28, v29
LM_232:
    ds_read_b128 v[224:227], v6 offset:30720
    ds_read_b128 v[228:231], v6 offset:31360
    ds_read_b128 v[232:235], v6 offset:32000
    ds_read_b128 v[236:239], v6 offset:32640
    s_waitcnt lgkmcnt(0)
    v_xor_b32 v144, s32, v224
    v_xor_b32 v145, s32, v228
    v_xor_b32 v146, s32, v232
    v_xor_b32 v147, s32, v236
    ds_write_b128 v6, v[144:147] offset:30720
    v_or3_b32 v15, v15, v144, v145
    v_or3_b32 v16, v16, v146, v147
    v_xor_b32 v148, s32, v225
    v_xor_b32 v149, s32, v229
    v_xor_b32 v150, s32, v233
    v_xor_b32 v151, s32, v237
    ds_write_b128 v6, v[148:151] offset:31360
    v_or3_b32 v15, v15, v148, v149
    v_or3_b32 v16, v16, v150, v151
    v_xor_b32 v152, s32, v226
    v_xor_b32 v153, s32, v230
    v_xor_b32 v154, s32, v234
    v_xor_b32 v155, s32, v238
    ds_write_b128 v6, v[152:155] offset:32000
    v_or3_b32 v15, v15, v152, v153
    v_or3_b32 v16, v16, v154, v155
    v_xor_b32 v156, s32, v227
    v_xor_b32 v157, s32, v231
    v_xor_b32 v158, s32, v235
    v_xor_b32 v159, s32, v239
    ds_write_b128 v6, v[156:159] offset:32640
    v_or3_b32 v15, v15, v156, v157
    v_or3_b32 v16, v16, v158, v159
    v_or_b32 v15, v15, v16
    v_and_b32 v15, 0x10001, v15
    v_cmp_ne_u32 vcc, 0, v15
    s_lshl_b32 s50, s77, 2
    s_add_u32 s51, s50, 1
    s_cmp_eq_u64 vcc, 0
    s_cselect_b32 s52, 2, 1
    s_add_u32 s52, s52, s50
    v_mov_b32 v28, s52
    ds_write_b32 v19, v28
    v_lshl_add_u32 v29, v1, 2, v17
    s_mov_b64 exec, 7
B2S_216:
    ds_read_b32 v28, v29 offset:32
    s_sub_u32 s46, s46, 1
    s_cselect_b32 s46, 0, s46
    s_cbranch_scc1 B2T_217
    s_waitcnt lgkmcnt(0)
    v_cmp_gt_u32 vcc, s51, v28
    s_cbranch_vccnz B2S_216
B2T_217:
    v_cmp_eq_u32 vcc, s51, v28
    s_mov_b64 exec, -1
    s_sub_u32 s46, s46, 4096
    s_cselect_b32 s46, 0, s46
    s_cbranch_scc1 B2K_215
    s_cbranch_vccz B2K_215
    s_add_u32 s77, s77, 1
    s_mov_b32 s49, 0
    s_branch B2R_214
B2K_215:
    ds_read_b128 v[128:131], v6 offset:0
    ds_read_b128 v[132:135], v6 offset:640
    ds_read_b128 v[136:139], v6 offset:1280
    ds_read_b128 v[144:147], v6 offset:10240
    ds_read_b128 v[148:151], v6 offset:10880
    ds_read_b128 v[152:155], v6 offset:11520
    ds_read_b128 v[160:163], v6 offset:20480
    ds_read_b128 v[164:167], v6 offset:21120
    ds_read_b128 v[168:171], v6 offset:21760
    s_waitcnt lgkmcnt(6)
    v_mfma_f32_16x16x32_bf16 v[176:179], v[128:131], v[32:35], 0
    v_mfma_f32_16x16x32_bf16 v[180:183], v[132:135], v[48:51], 0
    v_mfma_f32_16x16x32_bf16 v[184:187], v[136:139], v[64:67], 0
    ds_read_b128 v[128:131], v6 offset:30720
    ds_read_b128 v[132:135], v6 offset:31360
    ds_read_b128 v[136:139], v6 offset:32000
    s_waitcnt lgkmcnt(6)
    v_mfma_f32_16x16x32_bf16 v[176:179], v[144:147], v[36:39], v[176:179]
    v_mfma_f32_16x16x32_bf16 v[180:183], v[148:151], v[52:55], v[180:183]
    v_mfma_f32_16x16x32_bf16 v[184:187], v[152:155], v[68:71], v[184:187]
    ds_read_b128 v[144:147], v7 offset:0
    ds_read_b128 v[148:151], v7 offset:640
    ds_read_b128 v[152:155], v7 offset:1280
    s_waitcnt lgkmcnt(6)
    v_mfma_f32_16x16x32_bf16 v[176:179], v[160:163], v[40:43], v[176:179]
    v_mfma_f32_16x16x32_bf16 v[180:183], v[164:167], v[56:59], v[180:183]
    v_mfma_f32_16x16x32_bf16 v[184:187], v[168:171], v[72:75], v[184:187]
    ds_read_b128 v[160:163], v7 offset:10240
    ds_read_b128 v[164:167], v7 offset:10880
    ds_read_b128 v[168:171], v7 offset:11520
    s_waitcnt lgkmcnt(6)
    v_mfma_f32_16x16x32_bf16 v[176:179], v[128:131], v[44:47], v[176:179]
    v_mfma_f32_16x16x32_bf16 v[180:183], v[132:135], v[60:63], v[180:183]
    v_mfma_f32_16x16x32_bf16 v[184:187], v[136:139], v[76:79], v[184:187]
    ds_read_b128 v[128:131], v7 offset:20480
    ds_read_b128 v[132:135], v7 offset:21120
    ds_read_b128 v[136:139], v7 offset:21760
    s_waitcnt lgkmcnt(6)
    v_mfma_f32_16x16x32_bf16 v[188:191], v[144:147], v[32:35], 0
    v_mfma_f32_16x16x32_bf16 v[192:195], v[148:151], v[48:51], 0
    v_mfma_f32_16x16x32_bf16 v[196:199], v[152:155], v[64:67], 0
    ds_read_b128 v[144:147], v7 offset:30720
    ds_read_b128 v[148:151], v7 offset:31360
    ds_read_b128 v[152:155], v7 offset:32000
    s_waitcnt lgkmcnt(6)
    v_mfma_f32_16x16x32_bf16 v[188:191], v[160:163], v[36:39], v[188:191]
    v_mfma_f32_16x16x32_bf16 v[192:195], v[164:167], v[52:55], v[192:195]
    v_mfma_f32_16x16x32_bf16 v[196:199], v[168:171], v[68:71], v[196:199]
    ds_read_b128 v[160:163], v8 offset:0
    ds_read_b128 v[164:167], v8 offset:640
    ds_read_b128 v[168:171], v8 offset:1280
    s_waitcnt lgkmcnt(6)
    v_mfma_f32_16x16x32_bf16 v[188:191], v[128:131], v[40:43], v[188:191]
    v_mfma_f32_16x16x32_bf16 v[192:195], v[132:135], v[56:59], v[192:195]
    v_mfma_f32_16x16x32_bf16 v[196:199], v[136:139], v[72:75], v[196:199]
    ds_read_b128 v[128:131], v8 offset:10240
    ds_read_b128 v[132:135], v8 offset:10880
    ds_read_b128 v[136:139], v8 offset:11520
    s_waitcnt lgkmcnt(6)
    v_mfma_f32_16x16x32_bf16 v[188:191], v[144:147], v[44:47], v[188:191]
    v_mfma_f32_16x16x32_bf16 v[192:195], v[148:151], v[60:63], v[192:195]
    v_mfma_f32_16x16x32_bf16 v[196:199], v[152:155], v[76:79], v[196:199]
    ds_read_b128 v[144:147], v8 offset:20480
    ds_read_b128 v[148:151], v8 offset:21120
    ds_read_b128 v[152:155], v8 offset:21760
    s_waitcnt lgkmcnt(6)
    v_mfma_f32_16x16x32_bf16 v[200:203], v[160:163], v[32:35], 0
    v_mfma_f32_16x16x32_bf16 v[204:207], v[164:167], v[48:51], 0
    v_mfma_f32_16x16x32_bf16 v[208:211], v[168:171], v[64:67], 0
    ds_read_b128 v[160:163], v8 offset:30720
    ds_read_b128 v[164:167], v8 offset:31360
    ds_read_b128 v[168:171], v8 offset:32000
    s_waitcnt lgkmcnt(6)
    v_mfma_f32_16x16x32_bf16 v[200:203], v[128:131], v[36:39], v[200:203]
    v_mfma_f32_16x16x32_bf16 v[204:207], v[132:135], v[52:55], v[204:207]
    v_mfma_f32_16x16x32_bf16 v[208:211], v[136:139], v[68:71], v[208:211]
    v_cvt_pk_bf16_f32 v176, v176, v177
    v_cvt_pk_bf16_f32 v177, v178, v179
    v_cvt_pk_bf16_f32 v178, v188, v189
    v_cvt_pk_bf16_f32 v179, v190, v191
    s_nop 1
    v_permlane16_swap_b32 v176, v178
    v_permlane16_swap_b32 v177, v179
    s_nop 1
    buffer_store_dwordx4 v[176:179], v9, s[28:31], s76 offen
    s_waitcnt lgkmcnt(3)
    v_mfma_f32_16x16x32_bf16 v[200:203], v[144:147], v[40:43], v[200:203]
    v_mfma_f32_16x16x32_bf16 v[204:207], v[148:151], v[56:59], v[204:207]
    v_mfma_f32_16x16x32_bf16 v[208:211], v[152:155], v[72:75], v[208:211]
    v_cvt_pk_bf16_f32 v180, v180, v181
    v_cvt_pk_bf16_f32 v181, v182, v183
    v_cvt_pk_bf16_f32 v182, v192, v193
    v_cvt_pk_bf16_f32 v183, v194, v195
    s_nop 1
    v_permlane16_swap_b32 v180, v182
    v_permlane16_swap_b32 v181, v183
    s_nop 1
    buffer_store_dwordx4 v[180:183], v10, s[28:31], s76 offen
    s_waitcnt lgkmcnt(0)
    v_mfma_f32_16x16x32_bf16 v[200:203], v[160:163], v[44:47], v[200:203]
    v_mfma_f32_16x16x32_bf16 v[204:207], v[164:167], v[60:63], v[204:207]
    v_mfma_f32_16x16x32_bf16 v[208:211], v[168:171], v[76:79], v[208:211]
    v_cvt_pk_bf16_f32 v184, v184, v185
    v_cvt_pk_bf16_f32 v185, v186, v187
    v_cvt_pk_bf16_f32 v186, v196, v197
    v_cvt_pk_bf16_f32 v187, v198, v199
    s_nop 1
    v_permlane16_swap_b32 v184, v186
    v_permlane16_swap_b32 v185, v187
    s_nop 1
    buffer_store_dwordx4 v[184:187], v11, s[28:31], s76 offen
    v_cvt_pk_bf16_f32 v200, v200, v201
    v_cvt_pk_bf16_f32 v201, v202, v203
    v_cvt_pk_bf16_f32 v204, v204, v205
    v_cvt_pk_bf16_f32 v205, v206, v207
    v_cvt_pk_bf16_f32 v208, v208, v209
    v_cvt_pk_bf16_f32 v209, v210, v211
    s_mov_b64 exec, s[66:67]
    buffer_store_dwordx2 v[200:201], v12, s[28:31], s76 offen offset:64
    buffer_store_dwordx2 v[204:205], v13, s[28:31], s76 offen offset:64
    buffer_store_dwordx2 v[208:209], v14, s[28:31], s76 offen offset:64
    s_mov_b64 exec, -1
    s_endpgm
B2V_213:
    s_cmp_eq_u32 s74, 1
    s_cbranch_scc0 B2V_233
B2R_234:
    v_mov_b32 v15, 0
    v_mov_b32 v16, 0
    s_lshl_b32 s53, s77, 2
    s_sub_u32 s53, s53, 4
    s_add_u32 s53, s53, 1
    s_cmp_ge_u32 s49, s53
    s_cbranch_scc1 WD_239
WF_238:
    s_sleep 1
    ds_read_b32 v28, v17 offset:88
    s_sub_u32 s46, s46, 1
    s_cselect_b32 s46, 0, s46
    s_cbranch_scc1 WD_239
    s_waitcnt lgkmcnt(0)
    v_readfirstlane_b32 s49, v28
    s_cmp_ge_u32 s49, s53
    s_cbranch_scc0 WF_238
WD_239:
    ds_read_b128 v[176:179], v7 offset:0
    ds_read_b128 v[180:183], v7 offset:640
    ds_read_b128 v[184:187], v7 offset:1280
    ds_read_b128 v[188:191], v7 offset:1920
    s_waitcnt lgkmcnt(0)
    v_xor_b32 v128, s32, v176
    v_xor_b32 v129, s32, v180
    v_xor_b32 v130, s32, v184
    v_xor_b32 v131, s32, v188
    ds_write_b128 v7, v[128:131] offset:0
    v_or3_b32 v15, v15, v128, v129
    v_or3_b32 v16, v16, v130, v131
    v_xor_b32 v132, s32, v177
    v_xor_b32 v133, s32, v181
    v_xor_b32 v134, s32, v185
    v_xor_b32 v135, s32, v189
    ds_write_b128 v7, v[132:135] offset:640
    v_or3_b32 v15, v15, v132, v133
    v_or3_b32 v16, v16, v134, v135
    v_xor_b32 v136, s32, v178
    v_xor_b32 v137, s32, v182
    v_xor_b32 v138, s32, v186
    v_xor_b32 v139, s32, v190
    ds_write_b128 v7, v[136:139] offset:1280
    v_or3_b32 v15, v15, v136, v137
    v_or3_b32 v16, v16, v138, v139
    v_xor_b32 v140, s32, v179
    v_xor_b32 v141, s32, v183
    v_xor_b32 v142, s32, v187
    v_xor_b32 v143, s32, v191
    ds_write_b128 v7, v[140:143] offset:1920
    v_or3_b32 v15, v15, v140, v141
    v_or3_b32 v16, v16, v142, v143
    s_add_u32 s53, s53, 1
    s_cmp_ge_u32 s49, s53
    s_cbranch_scc1 WD_241
WF_240:
    s_sleep 1
    ds_read_b32 v28, v17 offset:88
    s_sub_u32 s46, s46, 1
    s_cselect_b32 s46, 0, s46
    s_cbranch_scc1 WD_241
    s_waitcnt lgkmcnt(0)
    v_readfirstlane_b32 s49, v28
    s_cmp_ge_u32 s49, s53
    s_cbranch_scc0 WF_240
WD_241:
    ds_read_b128 v[192:195], v7 offset:10240
    ds_read_b128 v[196:199], v7 offset:10880
    ds_read_b128 v[200:203], v7 offset:11520
    ds_read_b128 v[204:207], v7 offset:12160
    s_waitcnt lgkmcnt(0)
    v_xor_b32 v144, s32, v192
    v_xor_b32 v145, s32, v196
    v_xor_b32 v146, s32, v200
    v_xor_b32 v147, s32, v204
    ds_write_b128 v7, v[144:147] offset:10240
    v_or3_b32 v15, v15, v144, v145
    v_or3_b32 v16, v16, v146, v147
    v_xor_b32 v148, s32, v193
    v_xor_b32 v149, s32, v197
    v_xor_b32 v150, s32, v201
    v_xor_b32 v151, s32, v205
    ds_write_b128 v7, v[148:151] offset:10880
    v_or3_b32 v15, v15, v148, v149
    v_or3_b32 v16, v16, v150, v151
    v_xor_b32 v152, s32, v194
    v_xor_b32 v153, s32, v198
    v_xor_b32 v154, s32, v202
    v_xor_b32 v155, s32, v206
    ds_write_b128 v7, v[152:155] offset:11520
    v_or3_b32 v15, v15, v152, v153
    v_or3_b32 v16, v16, v154, v155
    v_xor_b32 v156, s32, v195
    v_xor_b32 v157, s32, v199
    v_xor_b32 v158, s32, v203
    v_xor_b32 v159, s32, v207
    ds_write_b128 v7, v[156:159] offset:12160
    v_or3_b32 v15, v15, v156, v157
    v_or3_b32 v16, v16, v158, v159
    s_add_u32 s53, s53, 1
    s_cmp_ge_u32 s49, s53
    s_cbranch_scc1 WD_243
WF_242:
    s_sleep 1
    ds_read_b32 v28, v17 offset:88
    s_sub_u32 s46, s46, 1
    s_cselect_b32 s46, 0, s46
    s_cbranch_scc1 WD_243
    s_waitcnt lgkmcnt(0)
    v_readfirstlane_b32 s49, v28
    s_cmp_ge_u32 s49, s53
    s_cbranch_scc0 WF_242
WD_243:
    ds_read_b128 v[208:211], v7 offset:20480
    ds_read_b128 v[212:215], v7 offset:21120
    ds_read_b128 v[216:219], v7 offset:21760
    ds_read_b128 v[220:223], v7 offset:22400
    s_waitcnt lgkmcnt(0)
    v_xor_b32 v128, s32, v208
    v_xor_b32 v129, s32, v212
    v_xor_b32 v130, s32, v216
    v_xor_b32 v131, s32, v220
    ds_write_b128 v7, v[128:131] offset:20480
    v_or3_b32 v15, v15, v128, v129
    v_or3_b32 v16, v16, v130, v131
    v_xor_b32 v132, s32, v209
    v_xor_b32 v133, s32, v213
    v_xor_b32 v134, s32, v217
    v_xor_b32 v135, s32, v221
    ds_write_b128 v7, v[132:135] offset:21120
    v_or3_b32 v15, v15, v132, v133
    v_or3_b32 v16, v16, v134, v135
    v_xor_b32 v136, s32, v210
    v_xor_b32 v137, s32, v214
    v_xor_b32 v138, s32, v218
    v_xor_b32 v139, s32, v222
    ds_write_b128 v7, v[136:139] offset:21760
    v_or3_b32 v15, v15, v136, v137
    v_or3_b32 v16, v16, v138, v139
    v_xor_b32 v140, s32, v211
    v_xor_b32 v141, s32, v215
    v_xor_b32 v142, s32, v219
    v_xor_b32 v143, s32, v223
    ds_write_b128 v7, v[140:143] offset:22400
    v_or3_b32 v15, v15, v140, v141
    v_or3_b32 v16, v16, v142, v143
    s_add_u32 s53, s53, 1
    s_cmp_ge_u32 s49, s53
    s_cbranch_scc1 WD_245
WF_244:
    s_sleep 1
    ds_read_b32 v28, v17 offset:88
    s_sub_u32 s46, s46, 1
    s_cselect_b32 s46, 0, s46
    s_cbranch_scc1 WD_245
    s_waitcnt lgkmcnt(0)
    v_readfirstlane_b32 s49, v28
    s_cmp_ge_u32 s49, s53
    s_cbranch_scc0 WF_244
WD_245:
    ds_read_b128 v[224:227], v7 offset:30720
    ds_read_b128 v[228:231], v7 offset:31360
    ds_read_b128 v[232:235], v7 offset:32000
    ds_read_b128 v[236:239], v7 offset:32640
    s_waitcnt lgkmcnt(0)
    v_xor_b32 v144, s32, v224
    v_xor_b32 v145, s32, v228
    v_xor_b32 v146, s32, v232
    v_xor_b32 v147, s32, v236
    ds_write_b128 v7, v[144:147] offset:30720
    v_or3_b32 v15, v15, v144, v145
    v_or3_b32 v16, v16, v146, v147
    v_xor_b32 v148, s32, v225
    v_xor_b32 v149, s32, v229
    v_xor_b32 v150, s32, v233
    v_xor_b32 v151, s32, v237
    ds_write_b128 v7, v[148:151] offset:31360
    v_or3_b32 v15, v15, v148, v149
    v_or3_b32 v16, v16, v150, v151
    v_xor_b32 v152, s32, v226
    v_xor_b32 v153, s32, v230
    v_xor_b32 v154, s32, v234
    v_xor_b32 v155, s32, v238
    ds_write_b128 v7, v[152:155] offset:32000
    v_or3_b32 v15, v15, v152, v153
    v_or3_b32 v16, v16, v154, v155
    v_xor_b32 v156, s32, v227
    v_xor_b32 v157, s32, v231
    v_xor_b32 v158, s32, v235
    v_xor_b32 v159, s32, v239
    ds_write_b128 v7, v[156:159] offset:32640
    v_or3_b32 v15, v15, v156, v157
    v_or3_b32 v16, v16, v158, v159
    v_or_b32 v15, v15, v16
    v_and_b32 v15, 0x10001, v15
    v_cmp_ne_u32 vcc, 0, v15
    s_lshl_b32 s50, s77, 2
    s_add_u32 s51, s50, 1
    s_cmp_eq_u64 vcc, 0
    s_cselect_b32 s52, 2, 1
    s_add_u32 s52, s52, s50
    v_mov_b32 v28, s52
    ds_write_b32 v19, v28
    v_lshl_add_u32 v29, v1, 2, v17
    s_mov_b64 exec, 7
B2S_236:
    ds_read_b32 v28, v29 offset:32
    s_sub_u32 s46, s46, 1
    s_cselect_b32 s46, 0, s46
    s_cbranch_scc1 B2T_237
    s_waitcnt lgkmcnt(0)
    v_cmp_gt_u32 vcc, s51, v28
    s_cbranch_vccnz B2S_236
B2T_237:
    v_cmp_eq_u32 vcc, s51, v28
    s_mov_b64 exec, -1
    s_sub_u32 s46, s46, 4096
    s_cselect_b32 s46, 0, s46
    s_cbranch_scc1 B2K_235
    s_cbranch_vccz B2K_235
    s_add_u32 s77, s77, 1
    s_mov_b32 s49, 0
    s_branch B2R_234
B2K_235:
    ds_read_b128 v[128:131], v6 offset:0
    ds_read_b128 v[132:135], v6 offset:640
    ds_read_b128 v[140:143], v6 offset:1920
    ds_read_b128 v[144:147], v6 offset:10240
    ds_read_b128 v[148:151], v6 offset:10880
    ds_read_b128 v[156:159], v6 offset:12160
    ds_read_b128 v[160:163], v6 offset:20480
    ds_read_b128 v[164:167], v6 offset:21120
    ds_read_b128 v[172:175], v6 offset:22400
    s_waitcnt lgkmcnt(6)
    v_mfma_f32_16x16x32_bf16 v[176:179], v[140:143], v[32:35], 0
    v_mfma_f32_16x16x32_bf16 v[180:183], v[128:131], v[48:51], 0
    v_mfma_f32_16x16x32_bf16 v[184:187], v[132:135], v[64:67], 0
    ds_read_b128 v[128:131], v6 offset:30720
    ds_read_b128 v[132:135], v6 offset:31360
    ds_read_b128 v[140:143], v6 offset:32640
    s_waitcnt lgkmcnt(6)
    v_mfma_f32_16x16x32_bf16 v[176:179], v[156:159], v[36:39], v[176:179]
    v_mfma_f32_16x16x32_bf16 v[180:183], v[144:147], v[52:55], v[180:183]
    v_mfma_f32_16x16x32_bf16 v[184:187], v[148:151], v[68:71], v[184:187]
    ds_read_b128 v[144:147], v7 offset:0
    ds_read_b128 v[148:151], v7 offset:640
    ds_read_b128 v[156:159], v7 offset:1920
    s_waitcnt lgkmcnt(6)
    v_mfma_f32_16x16x32_bf16 v[176:179], v[172:175], v[40:43], v[176:179]
    v_mfma_f32_16x16x32_bf16 v[180:183], v[160:163], v[56:59], v[180:183]
    v_mfma_f32_16x16x32_bf16 v[184:187], v[164:167], v[72:75], v[184:187]
    ds_read_b128 v[160:163], v7 offset:10240
    ds_read_b128 v[164:167], v7 offset:10880
    ds_read_b128 v[172:175], v7 offset:12160
    s_waitcnt lgkmcnt(6)
    v_mfma_f32_16x16x32_bf16 v[176:179], v[140:143], v[44:47], v[176:179]
    v_mfma_f32_16x16x32_bf16 v[180:183], v[128:131], v[60:63], v[180:183]
    v_mfma_f32_16x16x32_bf16 v[184:187], v[132:135], v[76:79], v[184:187]
    ds_read_b128 v[128:131], v7 offset:20480
    ds_read_b128 v[132:135], v7 offset:21120
    ds_read_b128 v[140:143], v7 offset:22400
    s_waitcnt lgkmcnt(6)
    v_mfma_f32_16x16x32_bf16 v[188:191], v[156:159], v[32:35], 0
    v_mfma_f32_16x16x32_bf16 v[192:195], v[144:147], v[48:51], 0
    v_mfma_f32_16x16x32_bf16 v[196:199], v[148:151], v[64:67], 0
    ds_read_b128 v[144:147], v7 offset:30720
    ds_read_b128 v[148:151], v7 offset:31360
    ds_read_b128 v[156:159], v7 offset:32640
    s_waitcnt lgkmcnt(6)
    v_mfma_f32_16x16x32_bf16 v[188:191], v[172:175], v[36:39], v[188:191]
    v_mfma_f32_16x16x32_bf16 v[192:195], v[160:163], v[52:55], v[192:195]
    v_mfma_f32_16x16x32_bf16 v[196:199], v[164:167], v[68:71], v[196:199]
    ds_read_b128 v[160:163], v8 offset:0
    ds_read_b128 v[164:167], v8 offset:640
    ds_read_b128 v[172:175], v8 offset:1920
    s_waitcnt lgkmcnt(6)
    v_mfma_f32_16x16x32_bf16 v[188:191], v[140:143], v[40:43], v[188:191]
    v_mfma_f32_16x16x32_bf16 v[192:195], v[128:131], v[56:59], v[192:195]
    v_mfma_f32_16x16x32_bf16 v[196:199], v[132:135], v[72:75], v[196:199]
    ds_read_b128 v[128:131], v8 offset:10240
    ds_read_b128 v[132:135], v8 offset:10880
    ds_read_b128 v[140:143], v8 offset:12160
    s_waitcnt lgkmcnt(6)
    v_mfma_f32_16x16x32_bf16 v[188:191], v[156:159], v[44:47], v[188:191]
    v_mfma_f32_16x16x32_bf16 v[192:195], v[144:147], v[60:63], v[192:195]
    v_mfma_f32_16x16x32_bf16 v[196:199], v[148:151], v[76:79], v[196:199]
    ds_read_b128 v[144:147], v8 offset:20480
    ds_read_b128 v[148:151], v8 offset:21120
    ds_read_b128 v[156:159], v8 offset:22400
    s_waitcnt lgkmcnt(6)
    v_mfma_f32_16x16x32_bf16 v[200:203], v[172:175], v[32:35], 0
    v_mfma_f32_16x16x32_bf16 v[204:207], v[160:163], v[48:51], 0
    v_mfma_f32_16x16x32_bf16 v[208:211], v[164:167], v[64:67], 0
    ds_read_b128 v[160:163], v8 offset:30720
    ds_read_b128 v[164:167], v8 offset:31360
    ds_read_b128 v[172:175], v8 offset:32640
    s_waitcnt lgkmcnt(6)
    v_mfma_f32_16x16x32_bf16 v[200:203], v[140:143], v[36:39], v[200:203]
    v_mfma_f32_16x16x32_bf16 v[204:207], v[128:131], v[52:55], v[204:207]
    v_mfma_f32_16x16x32_bf16 v[208:211], v[132:135], v[68:71], v[208:211]
    v_cvt_pk_bf16_f32 v176, v176, v177
    v_cvt_pk_bf16_f32 v177, v178, v179
    v_cvt_pk_bf16_f32 v178, v188, v189
    v_cvt_pk_bf16_f32 v179, v190, v191
    s_nop 1
    v_permlane16_swap_b32 v176, v178
    v_permlane16_swap_b32 v177, v179
    s_nop 1
    buffer_store_dwordx4 v[176:179], v9, s[28:31], s76 offen
    s_waitcnt lgkmcnt(3)
    v_mfma_f32_16x16x32_bf16 v[200:203], v[156:159], v[40:43], v[200:203]
    v_mfma_f32_16x16x32_bf16 v[204:207], v[144:147], v[56:59], v[204:207]
    v_mfma_f32_16x16x32_bf16 v[208:211], v[148:151], v[72:75], v[208:211]
    v_cvt_pk_bf16_f32 v180, v180, v181
    v_cvt_pk_bf16_f32 v181, v182, v183
    v_cvt_pk_bf16_f32 v182, v192, v193
    v_cvt_pk_bf16_f32 v183, v194, v195
    s_nop 1
    v_permlane16_swap_b32 v180, v182
    v_permlane16_swap_b32 v181, v183
    s_nop 1
    buffer_store_dwordx4 v[180:183], v10, s[28:31], s76 offen
    s_waitcnt lgkmcnt(0)
    v_mfma_f32_16x16x32_bf16 v[200:203], v[172:175], v[44:47], v[200:203]
    v_mfma_f32_16x16x32_bf16 v[204:207], v[160:163], v[60:63], v[204:207]
    v_mfma_f32_16x16x32_bf16 v[208:211], v[164:167], v[76:79], v[208:211]
    v_cvt_pk_bf16_f32 v184, v184, v185
    v_cvt_pk_bf16_f32 v185, v186, v187
    v_cvt_pk_bf16_f32 v186, v196, v197
    v_cvt_pk_bf16_f32 v187, v198, v199
    s_nop 1
    v_permlane16_swap_b32 v184, v186
    v_permlane16_swap_b32 v185, v187
    s_nop 1
    buffer_store_dwordx4 v[184:187], v11, s[28:31], s76 offen
    v_cvt_pk_bf16_f32 v200, v200, v201
    v_cvt_pk_bf16_f32 v201, v202, v203
    v_cvt_pk_bf16_f32 v204, v204, v205
    v_cvt_pk_bf16_f32 v205, v206, v207
    v_cvt_pk_bf16_f32 v208, v208, v209
    v_cvt_pk_bf16_f32 v209, v210, v211
    s_mov_b64 exec, s[66:67]
    buffer_store_dwordx2 v[200:201], v12, s[28:31], s76 offen offset:64
    buffer_store_dwordx2 v[204:205], v13, s[28:31], s76 offen offset:64
    buffer_store_dwordx2 v[208:209], v14, s[28:31], s76 offen offset:64
    s_mov_b64 exec, -1
    s_endpgm
B2V_233:
B2R_247:
    v_mov_b32 v15, 0
    v_mov_b32 v16, 0
    s_lshl_b32 s53, s77, 2
    s_sub_u32 s53, s53, 4
    s_add_u32 s53, s53, 1
    s_cmp_ge_u32 s49, s53
    s_cbranch_scc1 WD_252
WF_251:
    s_sleep 1
    ds_read_b32 v28, v17 offset:88
    s_sub_u32 s46, s46, 1
    s_cselect_b32 s46, 0, s46
    s_cbranch_scc1 WD_252
    s_waitcnt lgkmcnt(0)
    v_readfirstlane_b32 s49, v28
    s_cmp_ge_u32 s49, s53
    s_cbranch_scc0 WF_251
WD_252:
    ds_read_b128 v[176:179], v8 offset:0
    ds_read_b128 v[180:183], v8 offset:640
    ds_read_b128 v[184:187], v8 offset:1280
    ds_read_b128 v[188:191], v8 offset:1920
    s_waitcnt lgkmcnt(0)
    v_xor_b32 v128, s32, v176
    v_xor_b32 v129, s32, v180
    v_xor_b32 v130, s32, v184
    v_xor_b32 v131, s32, v188
    ds_write_b128 v8, v[128:131] offset:0
    v_or3_b32 v15, v15, v128, v129
    v_or3_b32 v16, v16, v130, v131
    v_xor_b32 v132, s32, v177
    v_xor_b32 v133, s32, v181
    v_xor_b32 v134, s32, v185
    v_xor_b32 v135, s32, v189
    ds_write_b128 v8, v[132:135] offset:640
    v_or3_b32 v15, v15, v132, v133
    v_or3_b32 v16, v16, v134, v135
    v_xor_b32 v136, s32, v178
    v_xor_b32 v137, s32, v182
    v_xor_b32 v138, s32, v186
    v_xor_b32 v139, s32, v190
    ds_write_b128 v8, v[136:139] offset:1280
    v_or3_b32 v15, v15, v136, v137
    v_or3_b32 v16, v16, v138, v139
    v_xor_b32 v140, s32, v179
    v_xor_b32 v141, s32, v183
    v_xor_b32 v142, s32, v187
    v_xor_b32 v143, s32, v191
    ds_write_b128 v8, v[140:143] offset:1920
    v_or3_b32 v15, v15, v140, v141
    v_or3_b32 v16, v16, v142, v143
    s_add_u32 s53, s53, 1
    s_cmp_ge_u32 s49, s53
    s_cbranch_scc1 WD_254
WF_253:
    s_sleep 1
    ds_read_b32 v28, v17 offset:88
    s_sub_u32 s46, s46, 1
    s_cselect_b32 s46, 0, s46
    s_cbranch_scc1 WD_254
    s_waitcnt lgkmcnt(0)
    v_readfirstlane_b32 s49, v28
    s_cmp_ge_u32 s49, s53
    s_cbranch_scc0 WF_253
WD_254:
    ds_read_b128 v[192:195], v8 offset:10240
    ds_read_b128 v[196:199], v8 offset:10880
    ds_read_b128 v[200:203], v8 offset:11520
    ds_read_b128 v[204:207], v8 offset:12160
    s_waitcnt lgkmcnt(0)
    v_xor_b32 v144, s32, v192
    v_xor_b32 v145, s32, v196
    v_xor_b32 v146, s32, v200
    v_xor_b32 v147, s32, v204
    ds_write_b128 v8, v[144:147] offset:10240
    v_or3_b32 v15, v15, v144, v145
    v_or3_b32 v16, v16, v146, v147
    v_xor_b32 v148, s32, v193
    v_xor_b32 v149, s32, v197
    v_xor_b32 v150, s32, v201
    v_xor_b32 v151, s32, v205
    ds_write_b128 v8, v[148:151] offset:10880
    v_or3_b32 v15, v15, v148, v149
    v_or3_b32 v16, v16, v150, v151
    v_xor_b32 v152, s32, v194
    v_xor_b32 v153, s32, v198
    v_xor_b32 v154, s32, v202
    v_xor_b32 v155, s32, v206
    ds_write_b128 v8, v[152:155] offset:11520
    v_or3_b32 v15, v15, v152, v153
    v_or3_b32 v16, v16, v154, v155
    v_xor_b32 v156, s32, v195
    v_xor_b32 v157, s32, v199
    v_xor_b32 v158, s32, v203
    v_xor_b32 v159, s32, v207
    ds_write_b128 v8, v[156:159] offset:12160
    v_or3_b32 v15, v15, v156, v157
    v_or3_b32 v16, v16, v158, v159
    s_add_u32 s53, s53, 1
    s_cmp_ge_u32 s49, s53
    s_cbranch_scc1 WD_256
WF_255:
    s_sleep 1
    ds_read_b32 v28, v17 offset:88
    s_sub_u32 s46, s46, 1
    s_cselect_b32 s46, 0, s46
    s_cbranch_scc1 WD_256
    s_waitcnt lgkmcnt(0)
    v_readfirstlane_b32 s49, v28
    s_cmp_ge_u32 s49, s53
    s_cbranch_scc0 WF_255
WD_256:
    ds_read_b128 v[208:211], v8 offset:20480
    ds_read_b128 v[212:215], v8 offset:21120
    ds_read_b128 v[216:219], v8 offset:21760
    ds_read_b128 v[220:223], v8 offset:22400
    s_waitcnt lgkmcnt(0)
    v_xor_b32 v128, s32, v208
    v_xor_b32 v129, s32, v212
    v_xor_b32 v130, s32, v216
    v_xor_b32 v131, s32, v220
    ds_write_b128 v8, v[128:131] offset:20480
    v_or3_b32 v15, v15, v128, v129
    v_or3_b32 v16, v16, v130, v131
    v_xor_b32 v132, s32, v209
    v_xor_b32 v133, s32, v213
    v_xor_b32 v134, s32, v217
    v_xor_b32 v135, s32, v221
    ds_write_b128 v8, v[132:135] offset:21120
    v_or3_b32 v15, v15, v132, v133
    v_or3_b32 v16, v16, v134, v135
    v_xor_b32 v136, s32, v210
    v_xor_b32 v137, s32, v214
    v_xor_b32 v138, s32, v218
    v_xor_b32 v139, s32, v222
    ds_write_b128 v8, v[136:139] offset:21760
    v_or3_b32 v15, v15, v136, v137
    v_or3_b32 v16, v16, v138, v139
    v_xor_b32 v140, s32, v211
    v_xor_b32 v141, s32, v215
    v_xor_b32 v142, s32, v219
    v_xor_b32 v143, s32, v223
    ds_write_b128 v8, v[140:143] offset:22400
    v_or3_b32 v15, v15, v140, v141
    v_or3_b32 v16, v16, v142, v143
    s_add_u32 s53, s53, 1
    s_cmp_ge_u32 s49, s53
    s_cbranch_scc1 WD_258
WF_257:
    s_sleep 1
    ds_read_b32 v28, v17 offset:88
    s_sub_u32 s46, s46, 1
    s_cselect_b32 s46, 0, s46
    s_cbranch_scc1 WD_258
    s_waitcnt lgkmcnt(0)
    v_readfirstlane_b32 s49, v28
    s_cmp_ge_u32 s49, s53
    s_cbranch_scc0 WF_257
WD_258:
    ds_read_b128 v[224:227], v8 offset:30720
    ds_read_b128 v[228:231], v8 offset:31360
    ds_read_b128 v[232:235], v8 offset:32000
    ds_read_b128 v[236:239], v8 offset:32640
    s_waitcnt lgkmcnt(0)
    v_xor_b32 v144, s32, v224
    v_xor_b32 v145, s32, v228
    v_xor_b32 v146, s32, v232
    v_xor_b32 v147, s32, v236
    ds_write_b128 v8, v[144:147] offset:30720
    v_or3_b32 v15, v15, v144, v145
    v_or3_b32 v16, v16, v146, v147
    v_xor_b32 v148, s32, v225
    v_xor_b32 v149, s32, v229
    v_xor_b32 v150, s32, v233
    v_xor_b32 v151, s32, v237
    ds_write_b128 v8, v[148:151] offset:31360
    v_or3_b32 v15, v15, v148, v149
    v_or3_b32 v16, v16, v150, v151
    v_xor_b32 v152, s32, v226
    v_xor_b32 v153, s32, v230
    v_xor_b32 v154, s32, v234
    v_xor_b32 v155, s32, v238
    ds_write_b128 v8, v[152:155] offset:32000
    v_or3_b32 v15, v15, v152, v153
    v_or3_b32 v16, v16, v154, v155
    v_xor_b32 v156, s32, v227
    v_xor_b32 v157, s32, v231
    v_xor_b32 v158, s32, v235
    v_xor_b32 v159, s32, v239
    ds_write_b128 v8, v[156:159] offset:32640
    v_or3_b32 v15, v15, v156, v157
    v_or3_b32 v16, v16, v158, v159
    v_or_b32 v15, v15, v16
    v_and_b32 v15, 0x10001, v15
    v_cmp_ne_u32 vcc, 0, v15
    s_lshl_b32 s50, s77, 2
    s_add_u32 s51, s50, 1
    s_cmp_eq_u64 vcc, 0
    s_cselect_b32 s52, 2, 1
    s_add_u32 s52, s52, s50
    v_mov_b32 v28, s52
    ds_write_b32 v19, v28
    v_lshl_add_u32 v29, v1, 2, v17
    s_mov_b64 exec, 7
B2S_249:
    ds_read_b32 v28, v29 offset:32
    s_sub_u32 s46, s46, 1
    s_cselect_b32 s46, 0, s46
    s_cbranch_scc1 B2T_250
    s_waitcnt lgkmcnt(0)
    v_cmp_gt_u32 vcc, s51, v28
    s_cbranch_vccnz B2S_249
B2T_250:
    v_cmp_eq_u32 vcc, s51, v28
    s_mov_b64 exec, -1
    s_sub_u32 s46, s46, 4096
    s_cselect_b32 s46, 0, s46
    s_cbranch_scc1 B2K_248
    s_cbranch_vccz B2K_248
    s_add_u32 s77, s77, 1
    s_sleep 8
    s_mul_i32 s75, s45, 335872
    s_add_u32 s75, s75, 6291456
    s_mov_b32 s50, 8
    s_mov_b32 s51, 108544
RG_259:
    s_mov_b32 m0, s51
    s_add_u32 s51, s51, 1024
    buffer_load_dwordx4 v240, s[36:39], s75 offen sc1 lds
    s_mov_b32 m0, s51
    s_add_u32 s51, s51, 1024
    buffer_load_dwordx4 v241, s[36:39], s75 offen sc1 lds
    s_mov_b32 m0, s51
    s_add_u32 s51, s51, 1024
    buffer_load_dwordx4 v242, s[36:39], s75 offen sc1 lds
    s_mov_b32 m0, s51
    s_add_u32 s51, s51, 1024
    buffer_load_dwordx4 v243, s[36:39], s75 offen sc1 lds
    s_mov_b32 m0, s51
    s_add_u32 s51, s51, 1024
    buffer_load_dwordx4 v244, s[36:39], s75 offen sc1 lds
    s_add_u32 s75, s75, 41984
    s_sub_u32 s50, s50, 1
    s_cmp_lg_u32 s50, 0
    s_cbranch_scc1 RG_259
    s_waitcnt vmcnt(0)
    s_lshl_b32 s50, s77, 2
    v_mov_b32 v28, s50
    ds_write_b32 v17, v28 offset:88
    s_mov_b32 s49, 0
    s_branch B2R_247
B2K_248:
    ds_read_b128 v[136:139], v6 offset:1280
    ds_read_b128 v[140:143], v6 offset:1920
    ds_read_b128 v[152:155], v6 offset:11520
    ds_read_b128 v[156:159], v6 offset:12160
    ds_read_b128 v[168:171], v6 offset:21760
    ds_read_b128 v[172:175], v6 offset:22400
    s_waitcnt lgkmcnt(4)
    v_mfma_f32_16x16x32_bf16 v[176:179], v[136:139], v[32:35], 0
    v_mfma_f32_16x16x32_bf16 v[180:183], v[140:143], v[48:51], 0
    ds_read_b128 v[136:139], v6 offset:32000
    ds_read_b128 v[140:143], v6 offset:32640
    s_waitcnt lgkmcnt(4)
    v_mfma_f32_16x16x32_bf16 v[176:179], v[152:155], v[36:39], v[176:179]
    v_mfma_f32_16x16x32_bf16 v[180:183], v[156:159], v[52:55], v[180:183]
    ds_read_b128 v[152:155], v7 offset:1280
    ds_read_b128 v[156:159], v7 offset:1920
    s_waitcnt lgkmcnt(4)
    v_mfma_f32_16x16x32_bf16 v[176:179], v[168:171], v[40:43], v[176:179]
    v_mfma_f32_16x16x32_bf16 v[180:183], v[172:175], v[56:59], v[180:183]
    ds_read_b128 v[168:171], v7 offset:11520
    ds_read_b128 v[172:175], v7 offset:12160
    s_waitcnt lgkmcnt(4)
    v_mfma_f32_16x16x32_bf16 v[176:179], v[136:139], v[44:47], v[176:179]
    v_mfma_f32_16x16x32_bf16 v[180:183], v[140:143], v[60:63], v[180:183]
    ds_read_b128 v[136:139], v7 offset:21760
    ds_read_b128 v[140:143], v7 offset:22400
    s_waitcnt lgkmcnt(4)
    v_mfma_f32_16x16x32_bf16 v[188:191], v[152:155], v[32:35], 0
    v_mfma_f32_16x16x32_bf16 v[192:195], v[156:159], v[48:51], 0
    ds_read_b128 v[152:155], v7 offset:32000
    ds_read_b128 v[156:159], v7 offset:32640
    s_waitcnt lgkmcnt(4)
    v_mfma_f32_16x16x32_bf16 v[188:191], v[168:171], v[36:39], v[188:191]
    v_mfma_f32_16x16x32_bf16 v[192:195], v[172:175], v[52:55], v[192:195]
    ds_read_b128 v[168:171], v8 offset:1280
    ds_read_b128 v[172:175], v8 offset:1920
    s_waitcnt lgkmcnt(4)
    v_mfma_f32_16x16x32_bf16 v[188:191], v[136:139], v[40:43], v[188:191]
    v_mfma_f32_16x16x32_bf16 v[192:195], v[140:143], v[56:59], v[192:195]
    ds_read_b128 v[136:139], v8 offset:11520
    ds_read_b128 v[140:143], v8 offset:12160
    s_waitcnt lgkmcnt(4)
    v_mfma_f32_16x16x32_bf16 v[188:191], v[152:155], v[44:47], v[188:191]
    v_mfma_f32_16x16x32_bf16 v[192:195], v[156:159], v[60:63], v[192:195]
    ds_read_b128 v[152:155], v8 offset:21760
    ds_read_b128 v[156:159], v8 offset:22400
    s_waitcnt lgkmcnt(4)
    v_mfma_f32_16x16x32_bf16 v[200:203], v[168:171], v[32:35], 0
    v_mfma_f32_16x16x32_bf16 v[204:207], v[172:175], v[48:51], 0
    ds_read_b128 v[168:171], v8 offset:32000
    ds_read_b128 v[172:175], v8 offset:32640
    s_waitcnt lgkmcnt(4)
    v_mfma_f32_16x16x32_bf16 v[200:203], v[136:139], v[36:39], v[200:203]
    v_mfma_f32_16x16x32_bf16 v[204:207], v[140:143], v[52:55], v[204:207]
    s_waitcnt lgkmcnt(2)
    v_mfma_f32_16x16x32_bf16 v[200:203], v[152:155], v[40:43], v[200:203]
    v_mfma_f32_16x16x32_bf16 v[204:207], v[156:159], v[56:59], v[204:207]
    v_cvt_pk_bf16_f32 v176, v176, v177
    v_cvt_pk_bf16_f32 v177, v178, v179
    v_cvt_pk_bf16_f32 v178, v188, v189
    v_cvt_pk_bf16_f32 v179, v190, v191
    s_nop 1
    v_permlane16_swap_b32 v176, v178
    v_permlane16_swap_b32 v177, v179
    s_nop 1
    buffer_store_dwordx4 v[176:179], v9, s[28:31], s76 offen
    s_waitcnt lgkmcnt(0)
    v_mfma_f32_16x16x32_bf16 v[200:203], v[168:171], v[44:47], v[200:203]
    v_mfma_f32_16x16x32_bf16 v[204:207], v[172:175], v[60:63], v[204:207]
    v_cvt_pk_bf16_f32 v180, v180, v181
    v_cvt_pk_bf16_f32 v181, v182, v183
    v_cvt_pk_bf16_f32 v182, v192, v193
    v_cvt_pk_bf16_f32 v183, v194, v195
    s_nop 1
    v_permlane16_swap_b32 v180, v182
    v_permlane16_swap_b32 v181, v183
    s_nop 1
    buffer_store_dwordx4 v[180:183], v10, s[28:31], s76 offen
    v_cvt_pk_bf16_f32 v200, v200, v201
    v_cvt_pk_bf16_f32 v201, v202, v203
    v_cvt_pk_bf16_f32 v204, v204, v205
    v_cvt_pk_bf16_f32 v205, v206, v207
    s_mov_b64 exec, s[66:67]
    buffer_store_dwordx2 v[200:201], v12, s[28:31], s76 offen offset:64
    buffer_store_dwordx2 v[204:205], v13, s[28:31], s76 offen offset:64
    s_mov_b64 exec, -1
    s_endpgm
L_end:
    s_endpgm
.section .rodata,"a"
.p2align 6
.amdhsa_kernel concat_heads__linear_kernel_hedgehog__spectral_fnet__prompt_kernel
  .amdhsa_next_free_vgpr 256
  .amdhsa_next_free_sgpr 102
  .amdhsa_accum_offset 256
  .amdhsa_group_segment_fixed_size 0
  .amdhsa_kernarg_size 96
  .amdhsa_user_sgpr_count 2
  .amdhsa_user_sgpr_kernarg_segment_ptr 1
  .amdhsa_system_sgpr_workgroup_id_x 1
.end_amdhsa_kernel
```
